```python
import torch

def _softmax(x, axis=-1):
    return torch.softmax(x, dim=axis)
def _gelu(x):
    return torch.nn.functional.gelu(x, approximate="tanh")
def _silu(x):
    return torch.nn.functional.silu(x)
def _sigmoid(x):
    return torch.sigmoid(x)
def _layernorm(x, axis=-1, eps=1e-5):
    m = x.mean(dim=axis, keepdim=True)
    v = x.var(dim=axis, keepdim=True, unbiased=False)
    return (x - m) / torch.sqrt(v + eps)
def _scatter_add(tgt, idx, src, axis=0):
    return tgt.clone().index_add_(axis, idx, src)
def _segment_sum(src, seg, n):
    out = torch.zeros((n,) + src.shape[1:], dtype=src.dtype)
    return out.index_add_(0, seg, src)
def _pad(x, pw):
    flat = tuple(v for pair in reversed(pw) for v in pair)
    return torch.nn.functional.pad(x, flat)

kernel_name = 'gated_mix__ssm_conv_s5__softmax_full_mha__prompt'

def setup_inputs():

    _w = (lambda a: (lambda t: t.to(torch.bfloat16) if t.is_floating_point() else t)(torch.as_tensor(a)))
    def _A_setup():
        B, S, D = 1, 2048, 576
        P = D
        Lambda_re = -0.5 * (lambda _x: torch.exp(torch.as_tensor(_x)))((lambda *s: torch.randn(*s, dtype=torch.bfloat16) * 0.4)(P))
        Lambda_im = (lambda *s: torch.randn(*s, dtype=torch.bfloat16) * 0.8)(P) * 1.0
        B_re = (lambda *s: torch.randn(*s, dtype=torch.bfloat16) * 0.8)(P, D) * (D ** -0.5)
        B_im = (lambda *s: torch.randn(*s, dtype=torch.bfloat16) * 0.8)(P, D) * (D ** -0.5)
        C_re = (lambda *s: torch.randn(*s, dtype=torch.bfloat16) * 0.8)(D, P) * (P ** -0.5)
        C_im = (lambda *s: torch.randn(*s, dtype=torch.bfloat16) * 0.8)(D, P) * (P ** -0.5)
        log_dt = (lambda *s: torch.randn(*s, dtype=torch.bfloat16) * 0.4)(P) * 0.3 - 2.0
        Dskip = (lambda *s: torch.randn(*s, dtype=torch.bfloat16) * 0.1)(D)
        return {
            "x": _w((lambda *s: torch.randn(*s, dtype=torch.bfloat16) * 0.05)(B, S, D)),
            "Lambda_re": _w(Lambda_re),
            "Lambda_im": _w(Lambda_im),
            "B_re": _w(B_re),
            "B_im": _w(B_im),
            "C_re": _w(C_re),
            "C_im": _w(C_im),
            "log_dt": _w(log_dt),
            "Dskip": _w(Dskip),
        }
    _A_in = _A_setup()

    def _B_setup():
        B, S, D = 1, 2048, 576
        return {
            "x": _w((lambda *s: torch.randn(*s, dtype=torch.bfloat16) * 0.05)(B, S, D)),
            "wqkv": _w((lambda *s: torch.randn(*s, dtype=torch.bfloat16) * 0.8)(D, 3 * D)),
            "wo": _w((lambda *s: torch.randn(*s, dtype=torch.bfloat16) * 0.05)(D, D)),
        }
    _B_in = _B_setup()

    return {
        "A_x": _A_in["x"],
        "A_Lambda_re": _A_in["Lambda_re"],
        "A_Lambda_im": _A_in["Lambda_im"],
        "A_B_re": _A_in["B_re"],
        "A_B_im": _A_in["B_im"],
        "A_C_re": _A_in["C_re"],
        "A_C_im": _A_in["C_im"],
        "A_log_dt": _A_in["log_dt"],
        "A_Dskip": _A_in["Dskip"],
        "B_x": _B_in["x"],
        "B_wqkv": _B_in["wqkv"],
        "B_wo": _B_in["wo"],
        "gate_w": _w((lambda *s: torch.randn(*s, dtype=torch.bfloat16) * 0.05)(576) * 16.0),
    }

def reference(A_x, A_Lambda_re, A_Lambda_im, A_B_re, A_B_im, A_C_re, A_C_im, A_log_dt, A_Dskip, B_x, B_wqkv, B_wo, gate_w):
    def _A_ref(x, Lambda_re, Lambda_im, B_re, B_im, C_re, C_im, log_dt, Dskip):
        Bsz, L, H = x.shape
        Lam = Lambda_re + 1j * Lambda_im
        Bmat = B_re + 1j * B_im
        Cmat = C_re + 1j * C_im
        dt = torch.exp(log_dt)
        Lam_bar = torch.exp(dt * Lam)
        B_bar = ((Lam_bar - 1.0) / Lam)[:, None] * Bmat
        Bu = torch.einsum("bld,pd->blp", x + 0j, B_bar)
        h = torch.zeros_like(Bu[:, 0, :])
        hs = []
        for t in range(L):
            h = Lam_bar[None, :] * h + Bu[:, t, :]
            hs.append(h)
        hseq = torch.stack(hs, 1)
        y = 2.0 * torch.einsum("blp,dp->bld", hseq, Cmat).real + x * Dskip[None, None, :]
        return y

    def _B_ref(x, wqkv, wo):
        B, S, D = x.shape
        H = 32; Dh = D // H
        qkv = (lambda x, *d: x.permute(*d))((x @ wqkv).reshape(B, S, 3, H, Dh), 2, 0, 3, 1, 4)
        q, k, v = qkv[0], qkv[1], qkv[2]
        scale = Dh ** -0.5
        scores = torch.einsum("bhqd,bhkd->bhqk", q, k) * scale
        p = _softmax(scores, axis=-1)
        o = torch.einsum("bhqk,bhkd->bhqd", p, v)
        return (lambda x, *d: x.permute(*d))(o, 0, 2, 1, 3).reshape(B, S, D) @ wo

    x = A_x
    g = _sigmoid((x * gate_w).sum(-1, keepdims=True))
    a = _A_ref(x, A_Lambda_re, A_Lambda_im, A_B_re, A_B_im, A_C_re, A_C_im, A_log_dt, A_Dskip)
    b = _B_ref(x, B_wqkv, B_wo)
    return g * a + (1 - g) * b
```

```asm
; @launch kernel=k1_kernel grid=(256,1,1) block=(512,1,1) lds=163840
; @launch kernel=k2_kernel grid=(256,1,1) block=(768,1,1) lds=163840
.amdgcn_target "amdgcn-amd-amdhsa--gfx950"
.text
.globl k1_kernel
.p2align 8
.type k1_kernel,@function
k1_kernel:
    s_cmp_ge_u32 s2, 256
    s_cbranch_scc1 K1_END
    s_load_dwordx2 s[8:9], s[0:1], 0
    s_load_dwordx2 s[12:13], s[0:1], 80
    s_load_dwordx2 s[16:17], s[0:1], 24
    s_load_dwordx2 s[20:21], s[0:1], 32
    s_load_dwordx2 s[24:25], s[0:1], 96
    s_load_dwordx2 s[28:29], s[0:1], 120
    v_lshrrev_b32 v1, 6, v0
    v_and_b32 v0, 63, v0
    v_readfirstlane_b32 s3, v1
    s_and_b32 s63, s3, 6
    s_cmp_eq_u32 s63, 2
    s_cbranch_scc0 K1_PFSKIP
    s_getpc_b64 s[60:61]
K1_PFA:
    v_lshlrev_b32 v208, 7, v0
    s_and_b32 s63, s3, 1
    s_lshl_b32 s63, s63, 13
    v_add_u32 v209, s63, v208
    v_mov_b32 v211, s61
    v_add_co_u32 v210, vcc, s60, v209
    v_addc_co_u32 v211, vcc, 0, v211, vcc
    global_load_dword v214, v[210:211], off
    s_lshr_b32 s62, s2, 2
    s_and_b32 s62, s62, -2
    s_and_b32 s63, s3, 1
    s_or_b32 s63, s63, s62
    s_and_b32 s63, s63, 7
    s_lshl_b32 s63, s63, 13
    s_add_u32 s63, s63, k2_kernel-K1_PFA
    v_add_u32 v209, s63, v208
    v_min_u32 v209, (TEXT_END-K1_PFA)-4, v209
    v_mov_b32 v213, s61
    v_add_co_u32 v212, vcc, s60, v209
    v_addc_co_u32 v213, vcc, 0, v213, vcc
    global_load_dword v215, v[212:213], off
K1_PFSKIP:
    s_mov_b32 s10, 2359296
    s_mov_b32 s11, 0x00020000
    s_mov_b32 s14, 1990656
    s_mov_b32 s15, 0x00020000
    s_mov_b32 s18, 663552
    s_mov_b32 s19, 0x00020000
    s_mov_b32 s22, 663552
    s_mov_b32 s23, 0x00020000
    s_mov_b32 s26, 1152
    s_mov_b32 s27, 0x00020000
    s_mov_b32 s30, 33554432
    s_mov_b32 s31, 0x00020000
    s_and_b32 s4, s2, 7
    s_lshr_b32 s5, s2, 3
    s_and_b32 s6, s4, 1
    s_lshl_b32 s6, s6, 3
    s_and_b32 s7, s5, 7
    s_add_u32 s6, s6, s7
    s_lshr_b32 s7, s4, 1
    s_lshl_b32 s7, s7, 2
    s_lshr_b32 s5, s5, 3
    s_add_u32 s7, s7, s5
    s_waitcnt lgkmcnt(0)
    s_cmp_lt_u32 s3, 4
    s_cbranch_scc1 K1_CONS
    s_cmp_eq_u32 s3, 5
    s_cbranch_scc1 K1_L1
    s_cmp_eq_u32 s3, 6
    s_cbranch_scc1 K1_L2
    s_cmp_eq_u32 s3, 7
    s_cbranch_scc1 K1_L3
K1_L0:
    s_cmp_lt_u32 s2, 5
    s_cbranch_scc0 K1_NOZ
    s_lshl_b32 s46, s2, 6
    v_add_u32 v9, s46, v0
    v_lshlrev_b32 v9, 7, v9
    v_add_u32 v9, 16232448, v9
    v_mov_b32 v10, 0
    buffer_store_dword v10, v9, s[28:31], 0 offen nt
K1_NOZ:
    v_lshrrev_b32 v9, 3, v0
    v_and_b32 v10, 7, v0
    v_xor_b32 v10, v10, v9
    v_lshlrev_b32 v8, 4, v10
    s_lshl_b32 s46, s6, 7
    s_add_u32 s46, s46, 0
    v_add_u32 v10, s46, v9
    v_mul_u32_u24 v10, 1152, v10
    v_add_u32 v1, v10, v8
    v_xor_b32 v2, 64, v1
    s_mul_i32 s46, s7, 36
    v_add_u32 v10, s46, v9
    v_mul_u32_u24 v10, 1152, v10
    v_add_u32 v7, v10, v8
    s_mul_i32 s46, s7, 216
    s_and_b32 s47, s7, 1
    s_lshl_b32 s47, s47, 3
    s_sub_u32 s46, s46, s47
    v_mov_b32 v10, v0
    v_mul_u32_u24 v11, 4682, v10
    v_lshrrev_b32 v11, 16, v11
    v_mul_u32_u24 v12, 14, v11
    v_sub_u32 v10, v10, v12
    v_and_b32 v12, 4, v11
    v_and_b32 v13, 8, v11
    v_and_b32 v11, 0xfffffff3, v11
    v_lshl_or_b32 v11, v12, 1, v11
    v_lshrrev_b32 v13, 1, v13
    v_or_b32 v11, v11, v13
    v_mul_u32_u24 v11, 3456, v11
    v_lshl_add_u32 v11, v10, 4, v11
    v_add_u32 v3, s46, v11
    v_add_u32 v10, 64, v0
    v_mul_u32_u24 v11, 4682, v10
    v_lshrrev_b32 v11, 16, v11
    v_mul_u32_u24 v12, 14, v11
    v_sub_u32 v10, v10, v12
    v_and_b32 v12, 4, v11
    v_and_b32 v13, 8, v11
    v_and_b32 v11, 0xfffffff3, v11
    v_lshl_or_b32 v11, v12, 1, v11
    v_lshrrev_b32 v13, 1, v13
    v_or_b32 v11, v11, v13
    v_mul_u32_u24 v11, 3456, v11
    v_lshl_add_u32 v11, v10, 4, v11
    v_add_u32 v4, s46, v11
    v_add_u32 v10, 128, v0
    v_mul_u32_u24 v11, 4682, v10
    v_lshrrev_b32 v11, 16, v11
    v_mul_u32_u24 v12, 14, v11
    v_sub_u32 v10, v10, v12
    v_and_b32 v12, 4, v11
    v_and_b32 v13, 8, v11
    v_and_b32 v11, 0xfffffff3, v11
    v_lshl_or_b32 v11, v12, 1, v11
    v_lshrrev_b32 v13, 1, v13
    v_or_b32 v11, v11, v13
    v_mul_u32_u24 v11, 3456, v11
    v_lshl_add_u32 v11, v10, 4, v11
    v_add_u32 v5, s46, v11
    v_add_u32 v10, 192, v0
    v_mul_u32_u24 v11, 4682, v10
    v_lshrrev_b32 v11, 16, v11
    v_mul_u32_u24 v12, 14, v11
    v_sub_u32 v10, v10, v12
    v_and_b32 v12, 4, v11
    v_and_b32 v13, 8, v11
    v_and_b32 v11, 0xfffffff3, v11
    v_lshl_or_b32 v11, v12, 1, v11
    v_lshrrev_b32 v13, 1, v13
    v_or_b32 v11, v11, v13
    v_mul_u32_u24 v11, 3456, v11
    v_lshl_add_u32 v11, v10, 4, v11
    v_add_u32 v6, s46, v11
    s_mov_b32 s40, 0
    s_add_u32 s46, s6, s7
    s_mul_i32 s47, s46, 21846
    s_lshr_b32 s47, s47, 16
    s_mul_i32 s47, s47, 3
    s_sub_u32 s46, s46, s47
    s_mul_i32 s46, s46, 3
    s_lshl_b32 s41, s46, 7
    s_mul_i32 s42, s46, 221184
    s_mov_b32 s44, 0
K1_L0_PRO:
    s_add_u32 m0, s40, 0
    s_add_u32 s45, s41, 0
    buffer_load_dwordx4 v1, s[8:11], s45 offen lds
    s_add_u32 m0, s40, 1024
    s_add_u32 s45, s41, 9216
    buffer_load_dwordx4 v1, s[8:11], s45 offen lds
    s_add_u32 m0, s40, 2048
    s_add_u32 s45, s41, 18432
    buffer_load_dwordx4 v2, s[8:11], s45 offen lds
    s_add_u32 m0, s40, 3072
    s_add_u32 s45, s41, 27648
    buffer_load_dwordx4 v2, s[8:11], s45 offen lds
    s_add_u32 m0, s40, 16384
    s_nop 0
    buffer_load_dwordx4 v3, s[12:15], s42 offen lds
    s_add_u32 m0, s40, 17408
    s_nop 0
    buffer_load_dwordx4 v4, s[12:15], s42 offen lds
    s_add_u32 m0, s40, 18432
    s_nop 0
    buffer_load_dwordx4 v5, s[12:15], s42 offen lds
    s_add_u32 m0, s40, 19456
    s_nop 0
    buffer_load_dwordx4 v6, s[12:15], s42 offen lds
    s_add_u32 m0, s40, 30720
    s_add_u32 s45, s41, 0
    buffer_load_dwordx4 v7, s[16:19], s45 offen lds
    s_add_u32 m0, s40, 31744
    s_add_u32 s45, s41, 0
    buffer_load_dwordx4 v7, s[20:23], s45 offen lds
    s_add_u32 s41, s41, 128
    s_add_u32 s42, s42, 221184
    s_cmp_eq_u32 s41, 1152
    s_cselect_b32 s41, 0, s41
    s_cselect_b32 s42, 0, s42
    s_add_u32 s40, s40, 40960
    s_cmp_eq_u32 s40, 163840
    s_cselect_b32 s40, 0, s40
    s_add_u32 s44, s44, 1
    s_cmp_lt_u32 s44, 2
    s_cbranch_scc1 K1_L0_PRO
K1_L0_LOOP:
    s_waitcnt vmcnt(10)
K1_L0_LW:
    s_barrier
    s_add_u32 m0, s40, 0
    s_add_u32 s45, s41, 0
    buffer_load_dwordx4 v1, s[8:11], s45 offen lds
    s_add_u32 m0, s40, 1024
    s_add_u32 s45, s41, 9216
    buffer_load_dwordx4 v1, s[8:11], s45 offen lds
    s_add_u32 m0, s40, 2048
    s_add_u32 s45, s41, 18432
    buffer_load_dwordx4 v2, s[8:11], s45 offen lds
    s_add_u32 m0, s40, 3072
    s_add_u32 s45, s41, 27648
    buffer_load_dwordx4 v2, s[8:11], s45 offen lds
    s_add_u32 m0, s40, 16384
    s_nop 0
    buffer_load_dwordx4 v3, s[12:15], s42 offen lds
    s_add_u32 m0, s40, 17408
    s_nop 0
    buffer_load_dwordx4 v4, s[12:15], s42 offen lds
    s_add_u32 m0, s40, 18432
    s_nop 0
    buffer_load_dwordx4 v5, s[12:15], s42 offen lds
    s_add_u32 m0, s40, 19456
    s_nop 0
    buffer_load_dwordx4 v6, s[12:15], s42 offen lds
    s_add_u32 m0, s40, 30720
    s_add_u32 s45, s41, 0
    buffer_load_dwordx4 v7, s[16:19], s45 offen lds
    s_add_u32 m0, s40, 31744
    s_add_u32 s45, s41, 0
    buffer_load_dwordx4 v7, s[20:23], s45 offen lds
    s_add_u32 s41, s41, 128
    s_add_u32 s42, s42, 221184
    s_cmp_eq_u32 s41, 1152
    s_cselect_b32 s41, 0, s41
    s_cselect_b32 s42, 0, s42
    s_add_u32 s40, s40, 40960
    s_cmp_eq_u32 s40, 163840
    s_cselect_b32 s40, 0, s40
    s_add_u32 s44, s44, 1
    s_cmp_lt_u32 s44, 9
    s_cbranch_scc1 K1_L0_LOOP
    s_waitcnt vmcnt(10)
    s_barrier
    s_waitcnt vmcnt(0)
    s_barrier
    s_endpgm
K1_L1:
    v_lshrrev_b32 v9, 3, v0
    v_and_b32 v10, 7, v0
    v_xor_b32 v10, v10, v9
    v_lshlrev_b32 v8, 4, v10
    s_lshl_b32 s46, s6, 7
    s_add_u32 s46, s46, 32
    v_add_u32 v10, s46, v9
    v_mul_u32_u24 v10, 1152, v10
    v_add_u32 v1, v10, v8
    v_xor_b32 v2, 64, v1
    s_mul_i32 s46, s7, 36
    v_add_u32 v10, s46, v9
    v_mul_u32_u24 v10, 1152, v10
    v_add_u32 v7, v10, v8
    s_mul_i32 s46, s7, 216
    s_and_b32 s47, s7, 1
    s_lshl_b32 s47, s47, 3
    s_sub_u32 s46, s46, s47
    v_add_u32 v10, 256, v0
    v_mul_u32_u24 v11, 4682, v10
    v_lshrrev_b32 v11, 16, v11
    v_mul_u32_u24 v12, 14, v11
    v_sub_u32 v10, v10, v12
    v_and_b32 v12, 4, v11
    v_and_b32 v13, 8, v11
    v_and_b32 v11, 0xfffffff3, v11
    v_lshl_or_b32 v11, v12, 1, v11
    v_lshrrev_b32 v13, 1, v13
    v_or_b32 v11, v11, v13
    v_mul_u32_u24 v11, 3456, v11
    v_lshl_add_u32 v11, v10, 4, v11
    v_add_u32 v3, s46, v11
    v_add_u32 v10, 320, v0
    v_mul_u32_u24 v11, 4682, v10
    v_lshrrev_b32 v11, 16, v11
    v_mul_u32_u24 v12, 14, v11
    v_sub_u32 v10, v10, v12
    v_and_b32 v12, 4, v11
    v_and_b32 v13, 8, v11
    v_and_b32 v11, 0xfffffff3, v11
    v_lshl_or_b32 v11, v12, 1, v11
    v_lshrrev_b32 v13, 1, v13
    v_or_b32 v11, v11, v13
    v_mul_u32_u24 v11, 3456, v11
    v_lshl_add_u32 v11, v10, 4, v11
    v_add_u32 v4, s46, v11
    v_add_u32 v10, 384, v0
    v_mul_u32_u24 v11, 4682, v10
    v_lshrrev_b32 v11, 16, v11
    v_mul_u32_u24 v12, 14, v11
    v_sub_u32 v10, v10, v12
    v_and_b32 v12, 4, v11
    v_and_b32 v13, 8, v11
    v_and_b32 v11, 0xfffffff3, v11
    v_lshl_or_b32 v11, v12, 1, v11
    v_lshrrev_b32 v13, 1, v13
    v_or_b32 v11, v11, v13
    v_mul_u32_u24 v11, 3456, v11
    v_lshl_add_u32 v11, v10, 4, v11
    v_add_u32 v5, s46, v11
    v_add_u32 v10, 448, v0
    v_mul_u32_u24 v11, 4682, v10
    v_lshrrev_b32 v11, 16, v11
    v_mul_u32_u24 v12, 14, v11
    v_sub_u32 v10, v10, v12
    v_and_b32 v12, 4, v11
    v_and_b32 v13, 8, v11
    v_and_b32 v11, 0xfffffff3, v11
    v_lshl_or_b32 v11, v12, 1, v11
    v_lshrrev_b32 v13, 1, v13
    v_or_b32 v11, v11, v13
    v_mul_u32_u24 v11, 3456, v11
    v_lshl_add_u32 v11, v10, 4, v11
    v_add_u32 v6, s46, v11
    s_mov_b32 s40, 0
    s_add_u32 s46, s6, s7
    s_mul_i32 s47, s46, 21846
    s_lshr_b32 s47, s47, 16
    s_mul_i32 s47, s47, 3
    s_sub_u32 s46, s46, s47
    s_mul_i32 s46, s46, 3
    s_lshl_b32 s41, s46, 7
    s_mul_i32 s42, s46, 221184
    s_mov_b32 s44, 0
K1_L1_PRO:
    s_add_u32 m0, s40, 4096
    s_add_u32 s45, s41, 0
    buffer_load_dwordx4 v1, s[8:11], s45 offen lds
    s_add_u32 m0, s40, 5120
    s_add_u32 s45, s41, 9216
    buffer_load_dwordx4 v1, s[8:11], s45 offen lds
    s_add_u32 m0, s40, 6144
    s_add_u32 s45, s41, 18432
    buffer_load_dwordx4 v2, s[8:11], s45 offen lds
    s_add_u32 m0, s40, 7168
    s_add_u32 s45, s41, 27648
    buffer_load_dwordx4 v2, s[8:11], s45 offen lds
    s_add_u32 m0, s40, 20480
    s_nop 0
    buffer_load_dwordx4 v3, s[12:15], s42 offen lds
    s_add_u32 m0, s40, 21504
    s_nop 0
    buffer_load_dwordx4 v4, s[12:15], s42 offen lds
    s_add_u32 m0, s40, 22528
    s_nop 0
    buffer_load_dwordx4 v5, s[12:15], s42 offen lds
    s_add_u32 m0, s40, 23552
    s_nop 0
    buffer_load_dwordx4 v6, s[12:15], s42 offen lds
    s_add_u32 m0, s40, 32768
    s_add_u32 s45, s41, 9216
    buffer_load_dwordx4 v7, s[16:19], s45 offen lds
    s_add_u32 m0, s40, 33792
    s_add_u32 s45, s41, 9216
    buffer_load_dwordx4 v7, s[20:23], s45 offen lds
    s_add_u32 s41, s41, 128
    s_add_u32 s42, s42, 221184
    s_cmp_eq_u32 s41, 1152
    s_cselect_b32 s41, 0, s41
    s_cselect_b32 s42, 0, s42
    s_add_u32 s40, s40, 40960
    s_cmp_eq_u32 s40, 163840
    s_cselect_b32 s40, 0, s40
    s_add_u32 s44, s44, 1
    s_cmp_lt_u32 s44, 2
    s_cbranch_scc1 K1_L1_PRO
K1_L1_LOOP:
    s_waitcnt vmcnt(10)
K1_L1_LW:
    s_barrier
    s_add_u32 m0, s40, 4096
    s_add_u32 s45, s41, 0
    buffer_load_dwordx4 v1, s[8:11], s45 offen lds
    s_add_u32 m0, s40, 5120
    s_add_u32 s45, s41, 9216
    buffer_load_dwordx4 v1, s[8:11], s45 offen lds
    s_add_u32 m0, s40, 6144
    s_add_u32 s45, s41, 18432
    buffer_load_dwordx4 v2, s[8:11], s45 offen lds
    s_add_u32 m0, s40, 7168
    s_add_u32 s45, s41, 27648
    buffer_load_dwordx4 v2, s[8:11], s45 offen lds
    s_add_u32 m0, s40, 20480
    s_nop 0
    buffer_load_dwordx4 v3, s[12:15], s42 offen lds
    s_add_u32 m0, s40, 21504
    s_nop 0
    buffer_load_dwordx4 v4, s[12:15], s42 offen lds
    s_add_u32 m0, s40, 22528
    s_nop 0
    buffer_load_dwordx4 v5, s[12:15], s42 offen lds
    s_add_u32 m0, s40, 23552
    s_nop 0
    buffer_load_dwordx4 v6, s[12:15], s42 offen lds
    s_add_u32 m0, s40, 32768
    s_add_u32 s45, s41, 9216
    buffer_load_dwordx4 v7, s[16:19], s45 offen lds
    s_add_u32 m0, s40, 33792
    s_add_u32 s45, s41, 9216
    buffer_load_dwordx4 v7, s[20:23], s45 offen lds
    s_add_u32 s41, s41, 128
    s_add_u32 s42, s42, 221184
    s_cmp_eq_u32 s41, 1152
    s_cselect_b32 s41, 0, s41
    s_cselect_b32 s42, 0, s42
    s_add_u32 s40, s40, 40960
    s_cmp_eq_u32 s40, 163840
    s_cselect_b32 s40, 0, s40
    s_add_u32 s44, s44, 1
    s_cmp_lt_u32 s44, 9
    s_cbranch_scc1 K1_L1_LOOP
    s_waitcnt vmcnt(10)
    s_barrier
    s_waitcnt vmcnt(0)
    s_barrier
    s_endpgm
K1_L2:
    v_lshrrev_b32 v9, 3, v0
    v_and_b32 v10, 7, v0
    v_xor_b32 v10, v10, v9
    v_lshlrev_b32 v8, 4, v10
    s_lshl_b32 s46, s6, 7
    s_add_u32 s46, s46, 64
    v_add_u32 v10, s46, v9
    v_mul_u32_u24 v10, 1152, v10
    v_add_u32 v1, v10, v8
    v_xor_b32 v2, 64, v1
    s_mul_i32 s46, s7, 36
    v_add_u32 v10, s46, v9
    v_mul_u32_u24 v10, 1152, v10
    v_add_u32 v7, v10, v8
    s_mul_i32 s46, s7, 216
    s_and_b32 s47, s7, 1
    s_lshl_b32 s47, s47, 3
    s_sub_u32 s46, s46, s47
    v_add_u32 v10, 512, v0
    v_mul_u32_u24 v11, 4682, v10
    v_lshrrev_b32 v11, 16, v11
    v_mul_u32_u24 v12, 14, v11
    v_sub_u32 v10, v10, v12
    v_and_b32 v12, 4, v11
    v_and_b32 v13, 8, v11
    v_and_b32 v11, 0xfffffff3, v11
    v_lshl_or_b32 v11, v12, 1, v11
    v_lshrrev_b32 v13, 1, v13
    v_or_b32 v11, v11, v13
    v_mul_u32_u24 v11, 3456, v11
    v_lshl_add_u32 v11, v10, 4, v11
    v_add_u32 v3, s46, v11
    v_add_u32 v10, 576, v0
    v_mul_u32_u24 v11, 4682, v10
    v_lshrrev_b32 v11, 16, v11
    v_mul_u32_u24 v12, 14, v11
    v_sub_u32 v10, v10, v12
    v_and_b32 v12, 4, v11
    v_and_b32 v13, 8, v11
    v_and_b32 v11, 0xfffffff3, v11
    v_lshl_or_b32 v11, v12, 1, v11
    v_lshrrev_b32 v13, 1, v13
    v_or_b32 v11, v11, v13
    v_mul_u32_u24 v11, 3456, v11
    v_lshl_add_u32 v11, v10, 4, v11
    v_add_u32 v4, s46, v11
    v_add_u32 v10, 640, v0
    v_mul_u32_u24 v11, 4682, v10
    v_lshrrev_b32 v11, 16, v11
    v_mul_u32_u24 v12, 14, v11
    v_sub_u32 v10, v10, v12
    v_and_b32 v12, 4, v11
    v_and_b32 v13, 8, v11
    v_and_b32 v11, 0xfffffff3, v11
    v_lshl_or_b32 v11, v12, 1, v11
    v_lshrrev_b32 v13, 1, v13
    v_or_b32 v11, v11, v13
    v_mul_u32_u24 v11, 3456, v11
    v_lshl_add_u32 v11, v10, 4, v11
    v_add_u32 v5, s46, v11
    s_mov_b32 s40, 0
    s_add_u32 s46, s6, s7
    s_mul_i32 s47, s46, 21846
    s_lshr_b32 s47, s47, 16
    s_mul_i32 s47, s47, 3
    s_sub_u32 s46, s46, s47
    s_mul_i32 s46, s46, 3
    s_lshl_b32 s41, s46, 7
    s_mul_i32 s42, s46, 221184
    s_mov_b32 s44, 0
K1_L2_PRO:
    s_add_u32 m0, s40, 8192
    s_add_u32 s45, s41, 0
    buffer_load_dwordx4 v1, s[8:11], s45 offen lds
    s_add_u32 m0, s40, 9216
    s_add_u32 s45, s41, 9216
    buffer_load_dwordx4 v1, s[8:11], s45 offen lds
    s_add_u32 m0, s40, 10240
    s_add_u32 s45, s41, 18432
    buffer_load_dwordx4 v2, s[8:11], s45 offen lds
    s_add_u32 m0, s40, 11264
    s_add_u32 s45, s41, 27648
    buffer_load_dwordx4 v2, s[8:11], s45 offen lds
    s_add_u32 m0, s40, 24576
    s_nop 0
    buffer_load_dwordx4 v3, s[12:15], s42 offen lds
    s_add_u32 m0, s40, 25600
    s_nop 0
    buffer_load_dwordx4 v4, s[12:15], s42 offen lds
    s_add_u32 m0, s40, 26624
    s_nop 0
    buffer_load_dwordx4 v5, s[12:15], s42 offen lds
    s_add_u32 m0, s40, 34816
    s_add_u32 s45, s41, 18432
    buffer_load_dwordx4 v7, s[16:19], s45 offen lds
    s_add_u32 m0, s40, 35840
    s_add_u32 s45, s41, 18432
    buffer_load_dwordx4 v7, s[20:23], s45 offen lds
    s_mov_b32 exec_hi, 0
    s_add_u32 m0, s40, 38912
    s_add_u32 s45, s41, 36864
    buffer_load_dwordx4 v7, s[16:19], s45 offen lds
    s_mov_b32 exec_hi, -1
    s_add_u32 s41, s41, 128
    s_add_u32 s42, s42, 221184
    s_cmp_eq_u32 s41, 1152
    s_cselect_b32 s41, 0, s41
    s_cselect_b32 s42, 0, s42
    s_add_u32 s40, s40, 40960
    s_cmp_eq_u32 s40, 163840
    s_cselect_b32 s40, 0, s40
    s_add_u32 s44, s44, 1
    s_cmp_lt_u32 s44, 2
    s_cbranch_scc1 K1_L2_PRO
K1_L2_LOOP:
    s_waitcnt vmcnt(10)
K1_L2_LW:
    s_barrier
    s_add_u32 m0, s40, 8192
    s_add_u32 s45, s41, 0
    buffer_load_dwordx4 v1, s[8:11], s45 offen lds
    s_add_u32 m0, s40, 9216
    s_add_u32 s45, s41, 9216
    buffer_load_dwordx4 v1, s[8:11], s45 offen lds
    s_add_u32 m0, s40, 10240
    s_add_u32 s45, s41, 18432
    buffer_load_dwordx4 v2, s[8:11], s45 offen lds
    s_add_u32 m0, s40, 11264
    s_add_u32 s45, s41, 27648
    buffer_load_dwordx4 v2, s[8:11], s45 offen lds
    s_add_u32 m0, s40, 24576
    s_nop 0
    buffer_load_dwordx4 v3, s[12:15], s42 offen lds
    s_add_u32 m0, s40, 25600
    s_nop 0
    buffer_load_dwordx4 v4, s[12:15], s42 offen lds
    s_add_u32 m0, s40, 26624
    s_nop 0
    buffer_load_dwordx4 v5, s[12:15], s42 offen lds
    s_add_u32 m0, s40, 34816
    s_add_u32 s45, s41, 18432
    buffer_load_dwordx4 v7, s[16:19], s45 offen lds
    s_add_u32 m0, s40, 35840
    s_add_u32 s45, s41, 18432
    buffer_load_dwordx4 v7, s[20:23], s45 offen lds
    s_mov_b32 exec_hi, 0
    s_add_u32 m0, s40, 38912
    s_add_u32 s45, s41, 36864
    buffer_load_dwordx4 v7, s[16:19], s45 offen lds
    s_mov_b32 exec_hi, -1
    s_add_u32 s41, s41, 128
    s_add_u32 s42, s42, 221184
    s_cmp_eq_u32 s41, 1152
    s_cselect_b32 s41, 0, s41
    s_cselect_b32 s42, 0, s42
    s_add_u32 s40, s40, 40960
    s_cmp_eq_u32 s40, 163840
    s_cselect_b32 s40, 0, s40
    s_add_u32 s44, s44, 1
    s_cmp_lt_u32 s44, 9
    s_cbranch_scc1 K1_L2_LOOP
    s_waitcnt vmcnt(10)
    s_barrier
    s_waitcnt vmcnt(0)
    s_barrier
    s_endpgm
K1_L3:
    v_lshrrev_b32 v9, 3, v0
    v_and_b32 v10, 7, v0
    v_xor_b32 v10, v10, v9
    v_lshlrev_b32 v8, 4, v10
    s_lshl_b32 s46, s6, 7
    s_add_u32 s46, s46, 96
    v_add_u32 v10, s46, v9
    v_mul_u32_u24 v10, 1152, v10
    v_add_u32 v1, v10, v8
    v_xor_b32 v2, 64, v1
    s_mul_i32 s46, s7, 36
    v_add_u32 v10, s46, v9
    v_mul_u32_u24 v10, 1152, v10
    v_add_u32 v7, v10, v8
    s_mul_i32 s46, s7, 216
    s_and_b32 s47, s7, 1
    s_lshl_b32 s47, s47, 3
    s_sub_u32 s46, s46, s47
    v_add_u32 v10, 704, v0
    v_mul_u32_u24 v11, 4682, v10
    v_lshrrev_b32 v11, 16, v11
    v_mul_u32_u24 v12, 14, v11
    v_sub_u32 v10, v10, v12
    v_and_b32 v12, 4, v11
    v_and_b32 v13, 8, v11
    v_and_b32 v11, 0xfffffff3, v11
    v_lshl_or_b32 v11, v12, 1, v11
    v_lshrrev_b32 v13, 1, v13
    v_or_b32 v11, v11, v13
    v_mul_u32_u24 v11, 3456, v11
    v_lshl_add_u32 v11, v10, 4, v11
    v_add_u32 v3, s46, v11
    v_add_u32 v10, 768, v0
    v_mul_u32_u24 v11, 4682, v10
    v_lshrrev_b32 v11, 16, v11
    v_mul_u32_u24 v12, 14, v11
    v_sub_u32 v10, v10, v12
    v_and_b32 v12, 4, v11
    v_and_b32 v13, 8, v11
    v_and_b32 v11, 0xfffffff3, v11
    v_lshl_or_b32 v11, v12, 1, v11
    v_lshrrev_b32 v13, 1, v13
    v_or_b32 v11, v11, v13
    v_mul_u32_u24 v11, 3456, v11
    v_lshl_add_u32 v11, v10, 4, v11
    v_add_u32 v4, s46, v11
    v_add_u32 v10, 832, v0
    v_mul_u32_u24 v11, 4682, v10
    v_lshrrev_b32 v11, 16, v11
    v_mul_u32_u24 v12, 14, v11
    v_sub_u32 v10, v10, v12
    v_and_b32 v12, 4, v11
    v_and_b32 v13, 8, v11
    v_and_b32 v11, 0xfffffff3, v11
    v_lshl_or_b32 v11, v12, 1, v11
    v_lshrrev_b32 v13, 1, v13
    v_or_b32 v11, v11, v13
    v_mul_u32_u24 v11, 3456, v11
    v_lshl_add_u32 v11, v10, 4, v11
    v_add_u32 v5, s46, v11
    s_mov_b32 s40, 0
    s_add_u32 s46, s6, s7
    s_mul_i32 s47, s46, 21846
    s_lshr_b32 s47, s47, 16
    s_mul_i32 s47, s47, 3
    s_sub_u32 s46, s46, s47
    s_mul_i32 s46, s46, 3
    s_lshl_b32 s41, s46, 7
    s_mul_i32 s42, s46, 221184
    s_mov_b32 s44, 0
K1_L3_PRO:
    s_add_u32 m0, s40, 12288
    s_add_u32 s45, s41, 0
    buffer_load_dwordx4 v1, s[8:11], s45 offen lds
    s_add_u32 m0, s40, 13312
    s_add_u32 s45, s41, 9216
    buffer_load_dwordx4 v1, s[8:11], s45 offen lds
    s_add_u32 m0, s40, 14336
    s_add_u32 s45, s41, 18432
    buffer_load_dwordx4 v2, s[8:11], s45 offen lds
    s_add_u32 m0, s40, 15360
    s_add_u32 s45, s41, 27648
    buffer_load_dwordx4 v2, s[8:11], s45 offen lds
    s_add_u32 m0, s40, 27648
    s_nop 0
    buffer_load_dwordx4 v3, s[12:15], s42 offen lds
    s_add_u32 m0, s40, 28672
    s_nop 0
    buffer_load_dwordx4 v4, s[12:15], s42 offen lds
    s_add_u32 m0, s40, 29696
    s_nop 0
    buffer_load_dwordx4 v5, s[12:15], s42 offen lds
    s_add_u32 m0, s40, 36864
    s_add_u32 s45, s41, 27648
    buffer_load_dwordx4 v7, s[16:19], s45 offen lds
    s_add_u32 m0, s40, 37888
    s_add_u32 s45, s41, 27648
    buffer_load_dwordx4 v7, s[20:23], s45 offen lds
    s_mov_b32 exec_hi, 0
    s_add_u32 m0, s40, 39936
    s_add_u32 s45, s41, 36864
    buffer_load_dwordx4 v7, s[20:23], s45 offen lds
    s_mov_b32 exec_lo, 0
    s_mov_b32 exec_hi, 0xff
    s_add_u32 m0, s40, 38912
    s_nop 0
    buffer_load_dwordx4 v8, s[24:27], s41 offen lds
    s_mov_b32 exec_lo, -1
    s_mov_b32 exec_hi, -1
    s_add_u32 s41, s41, 128
    s_add_u32 s42, s42, 221184
    s_cmp_eq_u32 s41, 1152
    s_cselect_b32 s41, 0, s41
    s_cselect_b32 s42, 0, s42
    s_add_u32 s40, s40, 40960
    s_cmp_eq_u32 s40, 163840
    s_cselect_b32 s40, 0, s40
    s_add_u32 s44, s44, 1
    s_cmp_lt_u32 s44, 2
    s_cbranch_scc1 K1_L3_PRO
K1_L3_LOOP:
    s_waitcnt vmcnt(11)
K1_L3_LW:
    s_barrier
    s_add_u32 m0, s40, 12288
    s_add_u32 s45, s41, 0
    buffer_load_dwordx4 v1, s[8:11], s45 offen lds
    s_add_u32 m0, s40, 13312
    s_add_u32 s45, s41, 9216
    buffer_load_dwordx4 v1, s[8:11], s45 offen lds
    s_add_u32 m0, s40, 14336
    s_add_u32 s45, s41, 18432
    buffer_load_dwordx4 v2, s[8:11], s45 offen lds
    s_add_u32 m0, s40, 15360
    s_add_u32 s45, s41, 27648
    buffer_load_dwordx4 v2, s[8:11], s45 offen lds
    s_add_u32 m0, s40, 27648
    s_nop 0
    buffer_load_dwordx4 v3, s[12:15], s42 offen lds
    s_add_u32 m0, s40, 28672
    s_nop 0
    buffer_load_dwordx4 v4, s[12:15], s42 offen lds
    s_add_u32 m0, s40, 29696
    s_nop 0
    buffer_load_dwordx4 v5, s[12:15], s42 offen lds
    s_add_u32 m0, s40, 36864
    s_add_u32 s45, s41, 27648
    buffer_load_dwordx4 v7, s[16:19], s45 offen lds
    s_add_u32 m0, s40, 37888
    s_add_u32 s45, s41, 27648
    buffer_load_dwordx4 v7, s[20:23], s45 offen lds
    s_mov_b32 exec_hi, 0
    s_add_u32 m0, s40, 39936
    s_add_u32 s45, s41, 36864
    buffer_load_dwordx4 v7, s[20:23], s45 offen lds
    s_mov_b32 exec_lo, 0
    s_mov_b32 exec_hi, 0xff
    s_add_u32 m0, s40, 38912
    s_nop 0
    buffer_load_dwordx4 v8, s[24:27], s41 offen lds
    s_mov_b32 exec_lo, -1
    s_mov_b32 exec_hi, -1
    s_add_u32 s41, s41, 128
    s_add_u32 s42, s42, 221184
    s_cmp_eq_u32 s41, 1152
    s_cselect_b32 s41, 0, s41
    s_cselect_b32 s42, 0, s42
    s_add_u32 s40, s40, 40960
    s_cmp_eq_u32 s40, 163840
    s_cselect_b32 s40, 0, s40
    s_add_u32 s44, s44, 1
    s_cmp_lt_u32 s44, 9
    s_cbranch_scc1 K1_L3_LOOP
    s_waitcnt vmcnt(11)
    s_barrier
    s_waitcnt vmcnt(0)
    s_barrier
    s_endpgm
K1_CONS:
    s_mov_b32 s8, s28
    s_mov_b32 s9, s29
    s_mov_b32 s10, s30
    s_mov_b32 s11, s31
    s_and_b32 s5, s3, 1
    s_cmp_ge_u32 s3, 2
    s_cbranch_scc1 K1_ROLE_X
K1_ROLE_T:
    v_lshrrev_b32 v12, 4, v0
    v_and_b32 v13, 3, v0
    v_xor_b32 v12, v12, v13
    v_lshlrev_b32 v12, 4, v12
    v_bfe_u32 v13, v0, 2, 1
    v_lshl_add_u32 v14, v13, 6, v12
    v_and_b32 v15, 15, v0
    s_lshl_b32 s46, s5, 6
    v_add_u32 v15, s46, v15
    v_lshl_add_u32 v2, v15, 7, v14
    v_xor_b32 v3, 64, v2
    v_lshrrev_b32 v12, 4, v0
    v_lshrrev_b32 v13, 1, v12
    v_lshlrev_b32 v13, 4, v13
    v_and_b32 v12, 1, v12
    v_lshl_add_u32 v13, v12, 2, v13
    v_bfe_u32 v12, v0, 2, 2
    v_add_u32 v13, v13, v12
    v_mul_u32_u24 v13, 224, v13
    s_and_b32 s46, s7, 1
    s_lshl_b32 s46, s46, 3
    s_add_u32 s46, s46, 16384
    v_add_u32 v4, s46, v13
    v_and_b32 v13, 3, v0
    v_lshl_add_u32 v4, v13, 3, v4
    v_mov_b32 v16, 0
    v_mov_b32 v17, 0
    v_mov_b32 v18, 0
    v_mov_b32 v19, 0
    v_mov_b32 v20, 0
    v_mov_b32 v21, 0
    v_mov_b32 v22, 0
    v_mov_b32 v23, 0
    v_mov_b32 v24, 0
    v_mov_b32 v25, 0
    v_mov_b32 v26, 0
    v_mov_b32 v27, 0
    v_mov_b32 v28, 0
    v_mov_b32 v29, 0
    v_mov_b32 v30, 0
    v_mov_b32 v31, 0
    v_mov_b32 v32, 0
    v_mov_b32 v33, 0
    v_mov_b32 v34, 0
    v_mov_b32 v35, 0
    v_mov_b32 v36, 0
    v_mov_b32 v37, 0
    v_mov_b32 v38, 0
    v_mov_b32 v39, 0
    v_mov_b32 v40, 0
    v_mov_b32 v41, 0
    v_mov_b32 v42, 0
    v_mov_b32 v43, 0
    v_mov_b32 v44, 0
    v_mov_b32 v45, 0
    v_mov_b32 v46, 0
    v_mov_b32 v47, 0
    v_mov_b32 v48, 0
    v_mov_b32 v49, 0
    v_mov_b32 v50, 0
    v_mov_b32 v51, 0
    v_mov_b32 v52, 0
    v_mov_b32 v53, 0
    v_mov_b32 v54, 0
    v_mov_b32 v55, 0
    v_mov_b32 v56, 0
    v_mov_b32 v57, 0
    v_mov_b32 v58, 0
    v_mov_b32 v59, 0
    v_mov_b32 v60, 0
    v_mov_b32 v61, 0
    v_mov_b32 v62, 0
    v_mov_b32 v63, 0
    v_mov_b32 v64, 0
    v_mov_b32 v65, 0
    v_mov_b32 v66, 0
    v_mov_b32 v67, 0
    v_mov_b32 v68, 0
    v_mov_b32 v69, 0
    v_mov_b32 v70, 0
    v_mov_b32 v71, 0
    v_mov_b32 v72, 0
    v_mov_b32 v73, 0
    v_mov_b32 v74, 0
    v_mov_b32 v75, 0
    v_mov_b32 v76, 0
    v_mov_b32 v77, 0
    v_mov_b32 v78, 0
    v_mov_b32 v79, 0
    v_mov_b32 v80, 0
    v_mov_b32 v81, 0
    v_mov_b32 v82, 0
    v_mov_b32 v83, 0
    v_mov_b32 v84, 0
    v_mov_b32 v85, 0
    v_mov_b32 v86, 0
    v_mov_b32 v87, 0
    v_mov_b32 v88, 0
    v_mov_b32 v89, 0
    v_mov_b32 v90, 0
    v_mov_b32 v91, 0
    v_mov_b32 v92, 0
    v_mov_b32 v93, 0
    v_mov_b32 v94, 0
    v_mov_b32 v95, 0
    v_mov_b32 v96, 0
    v_mov_b32 v97, 0
    v_mov_b32 v98, 0
    v_mov_b32 v99, 0
    v_mov_b32 v100, 0
    v_mov_b32 v101, 0
    v_mov_b32 v102, 0
    v_mov_b32 v103, 0
    v_mov_b32 v104, 0
    v_mov_b32 v105, 0
    v_mov_b32 v106, 0
    v_mov_b32 v107, 0
    v_mov_b32 v108, 0
    v_mov_b32 v109, 0
    v_mov_b32 v110, 0
    v_mov_b32 v111, 0
    v_lshrrev_b32 v12, 4, v0
    v_lshlrev_b32 v12, 2, v12
    v_and_b32 v13, 15, v0
    v_sub_u32 v12, v13, v12
    v_mov_b32 v13, 0x3f80
    v_mov_b32 v14, 0x3f800000
    v_cmp_eq_u32 vcc, 0, v12
    s_nop 1
    v_cndmask_b32 v192, 0, v13, vcc
    v_cmp_eq_u32 vcc, 1, v12
    s_nop 1
    v_cndmask_b32 v192, v192, v14, vcc
    v_cmp_eq_u32 vcc, 2, v12
    s_nop 1
    v_cndmask_b32 v193, 0, v13, vcc
    v_cmp_eq_u32 vcc, 3, v12
    s_nop 1
    v_cndmask_b32 v193, v193, v14, vcc
    s_barrier
    v_mov_b32 v7, v2
    v_mov_b32 v8, v3
    v_mov_b32 v9, v4
    s_mov_b32 s21, 40960
    s_mov_b32 s20, 0
    ds_read_b128 v[112:115], v7 offset:0
    ds_read_b128 v[116:119], v8 offset:2048
    ds_read_b128 v[120:123], v7 offset:4096
    ds_read_b128 v[124:127], v8 offset:6144
    ds_read_b64_tr_b16 v[128:129], v9 offset:0
    ds_read_b64_tr_b16 v[130:131], v9 offset:1792
    ds_read_b64_tr_b16 v[132:133], v9 offset:40
    ds_read_b64_tr_b16 v[134:135], v9 offset:1832
    ds_read_b64_tr_b16 v[136:137], v9 offset:72
    ds_read_b64_tr_b16 v[138:139], v9 offset:1864
    ds_read_b64_tr_b16 v[140:141], v9 offset:112
    ds_read_b64_tr_b16 v[142:143], v9 offset:1904
    ds_read_b64_tr_b16 v[144:145], v9 offset:144
    ds_read_b64_tr_b16 v[146:147], v9 offset:1936
    ds_read_b64_tr_b16 v[148:149], v9 offset:184
    ds_read_b64_tr_b16 v[150:151], v9 offset:1976
K1_T_LOOP:
    s_waitcnt lgkmcnt(0)
    v_mfma_f32_16x16x32_bf16 v[16:19], v[128:131], v[112:115], v[16:19]
    ds_read_b128 v[152:155], v8 offset:0
    v_mfma_f32_16x16x32_bf16 v[20:23], v[128:131], v[116:119], v[20:23]
    ds_read_b128 v[156:159], v7 offset:2048
    v_mfma_f32_16x16x32_bf16 v[24:27], v[128:131], v[120:123], v[24:27]
    ds_read_b128 v[160:163], v8 offset:4096
    v_mfma_f32_16x16x32_bf16 v[28:31], v[128:131], v[124:127], v[28:31]
    ds_read_b128 v[164:167], v7 offset:6144
    v_mfma_f32_16x16x32_bf16 v[32:35], v[132:135], v[112:115], v[32:35]
    ds_read_b64_tr_b16 v[168:169], v9 offset:7168
    v_mfma_f32_16x16x32_bf16 v[36:39], v[132:135], v[116:119], v[36:39]
    ds_read_b64_tr_b16 v[170:171], v9 offset:8960
    v_mfma_f32_16x16x32_bf16 v[40:43], v[132:135], v[120:123], v[40:43]
    ds_read_b64_tr_b16 v[172:173], v9 offset:7208
    v_mfma_f32_16x16x32_bf16 v[44:47], v[132:135], v[124:127], v[44:47]
    ds_read_b64_tr_b16 v[174:175], v9 offset:9000
    v_mfma_f32_16x16x32_bf16 v[48:51], v[136:139], v[112:115], v[48:51]
    ds_read_b64_tr_b16 v[176:177], v9 offset:7240
    v_mfma_f32_16x16x32_bf16 v[52:55], v[136:139], v[116:119], v[52:55]
    ds_read_b64_tr_b16 v[178:179], v9 offset:9032
    v_mfma_f32_16x16x32_bf16 v[56:59], v[136:139], v[120:123], v[56:59]
    ds_read_b64_tr_b16 v[180:181], v9 offset:7280
    v_mfma_f32_16x16x32_bf16 v[60:63], v[136:139], v[124:127], v[60:63]
    ds_read_b64_tr_b16 v[182:183], v9 offset:9072
    v_mfma_f32_16x16x32_bf16 v[64:67], v[140:143], v[112:115], v[64:67]
    ds_read_b64_tr_b16 v[184:185], v9 offset:7312
    v_mfma_f32_16x16x32_bf16 v[68:71], v[140:143], v[116:119], v[68:71]
    ds_read_b64_tr_b16 v[186:187], v9 offset:9104
    v_mfma_f32_16x16x32_bf16 v[72:75], v[140:143], v[120:123], v[72:75]
    ds_read_b64_tr_b16 v[188:189], v9 offset:7352
    v_mfma_f32_16x16x32_bf16 v[76:79], v[140:143], v[124:127], v[76:79]
    ds_read_b64_tr_b16 v[190:191], v9 offset:9144
    v_mfma_f32_16x16x32_bf16 v[80:83], v[144:147], v[112:115], v[80:83]
    v_mfma_f32_16x16x32_bf16 v[84:87], v[144:147], v[116:119], v[84:87]
    v_mfma_f32_16x16x32_bf16 v[88:91], v[144:147], v[120:123], v[88:91]
    v_mfma_f32_16x16x32_bf16 v[92:95], v[144:147], v[124:127], v[92:95]
    v_mfma_f32_16x16x32_bf16 v[96:99], v[148:151], v[112:115], v[96:99]
    v_mfma_f32_16x16x32_bf16 v[100:103], v[148:151], v[116:119], v[100:103]
    v_mfma_f32_16x16x32_bf16 v[104:107], v[148:151], v[120:123], v[104:107]
    v_mfma_f32_16x16x32_bf16 v[108:111], v[148:151], v[124:127], v[108:111]
    s_waitcnt lgkmcnt(0)
    v_mfma_f32_16x16x32_bf16 v[16:19], v[168:171], v[152:155], v[16:19]
    v_mfma_f32_16x16x32_bf16 v[20:23], v[168:171], v[156:159], v[20:23]
    s_cmp_eq_u32 s20, 8
    s_cbranch_scc1 K1_T_NOBAR
    s_barrier
K1_T_NOBAR:
    v_add_u32 v7, s21, v2
    v_add_u32 v8, s21, v3
    v_add_u32 v9, s21, v4
    s_add_u32 s21, s21, 40960
    s_cmp_eq_u32 s21, 163840
    s_cselect_b32 s21, 0, s21
    v_mfma_f32_16x16x32_bf16 v[24:27], v[168:171], v[160:163], v[24:27]
    ds_read_b128 v[112:115], v7 offset:0
    v_mfma_f32_16x16x32_bf16 v[28:31], v[168:171], v[164:167], v[28:31]
    ds_read_b128 v[116:119], v8 offset:2048
    v_mfma_f32_16x16x32_bf16 v[32:35], v[172:175], v[152:155], v[32:35]
    ds_read_b128 v[120:123], v7 offset:4096
    v_mfma_f32_16x16x32_bf16 v[36:39], v[172:175], v[156:159], v[36:39]
    ds_read_b128 v[124:127], v8 offset:6144
    v_mfma_f32_16x16x32_bf16 v[40:43], v[172:175], v[160:163], v[40:43]
    ds_read_b64_tr_b16 v[128:129], v9 offset:0
    v_mfma_f32_16x16x32_bf16 v[44:47], v[172:175], v[164:167], v[44:47]
    ds_read_b64_tr_b16 v[130:131], v9 offset:1792
    v_mfma_f32_16x16x32_bf16 v[48:51], v[176:179], v[152:155], v[48:51]
    ds_read_b64_tr_b16 v[132:133], v9 offset:40
    v_mfma_f32_16x16x32_bf16 v[52:55], v[176:179], v[156:159], v[52:55]
    ds_read_b64_tr_b16 v[134:135], v9 offset:1832
    v_mfma_f32_16x16x32_bf16 v[56:59], v[176:179], v[160:163], v[56:59]
    ds_read_b64_tr_b16 v[136:137], v9 offset:72
    v_mfma_f32_16x16x32_bf16 v[60:63], v[176:179], v[164:167], v[60:63]
    ds_read_b64_tr_b16 v[138:139], v9 offset:1864
    v_mfma_f32_16x16x32_bf16 v[64:67], v[180:183], v[152:155], v[64:67]
    ds_read_b64_tr_b16 v[140:141], v9 offset:112
    v_mfma_f32_16x16x32_bf16 v[68:71], v[180:183], v[156:159], v[68:71]
    ds_read_b64_tr_b16 v[142:143], v9 offset:1904
    v_mfma_f32_16x16x32_bf16 v[72:75], v[180:183], v[160:163], v[72:75]
    ds_read_b64_tr_b16 v[144:145], v9 offset:144
    v_mfma_f32_16x16x32_bf16 v[76:79], v[180:183], v[164:167], v[76:79]
    ds_read_b64_tr_b16 v[146:147], v9 offset:1936
    v_mfma_f32_16x16x32_bf16 v[80:83], v[184:187], v[152:155], v[80:83]
    ds_read_b64_tr_b16 v[148:149], v9 offset:184
    v_mfma_f32_16x16x32_bf16 v[84:87], v[184:187], v[156:159], v[84:87]
    ds_read_b64_tr_b16 v[150:151], v9 offset:1976
    v_mfma_f32_16x16x32_bf16 v[88:91], v[184:187], v[160:163], v[88:91]
    v_mfma_f32_16x16x32_bf16 v[92:95], v[184:187], v[164:167], v[92:95]
    v_mfma_f32_16x16x32_bf16 v[96:99], v[188:191], v[152:155], v[96:99]
    v_mfma_f32_16x16x32_bf16 v[100:103], v[188:191], v[156:159], v[100:103]
    v_mfma_f32_16x16x32_bf16 v[104:107], v[188:191], v[160:163], v[104:107]
    v_mfma_f32_16x16x32_bf16 v[108:111], v[188:191], v[164:167], v[108:111]
    s_add_u32 s20, s20, 1
    s_cmp_lt_u32 s20, 9
    s_cbranch_scc1 K1_T_LOOP
    s_waitcnt vmcnt(0) lgkmcnt(0)
    v_lshlrev_b32 v2, 4, v0
    v_lshrrev_b32 v3, 4, v0
    v_mul_u32_u24 v3, 304, v3
    v_and_b32 v4, 15, v0
    v_lshl_add_u32 v3, v4, 4, v3
    v_add_u32 v3, 1152, v3
    s_lshl_b32 s30, s6, 2
    s_lshl_b32 s31, s5, 1
    s_add_u32 s30, s30, s31
    s_mul_i32 s31, s7, 3
    s_and_b32 s32, s31, 15
    s_lshl_b32 s32, s32, 7
    s_add_u32 s32, s32, s30
    s_cmp_ge_u32 s31, 32
    s_cbranch_scc1 K1_TV0
    s_cmp_ge_u32 s31, 16
    s_mov_b32 s33, 1152
    s_cselect_b32 s33, 2368, s33
    s_cselect_b32 s34, 2359296, 0
    s_cselect_b32 s35, 1.0, 0x3eae1a93
    s_mul_i32 s36, s32, s33
    s_add_u32 s36, s36, s34
    s_mul_i32 s37, s33, 63
    v_mul_f32 v16, s35, v16
    v_mul_f32 v17, s35, v17
    v_mul_f32 v18, s35, v18
    v_mul_f32 v19, s35, v19
    v_mul_f32 v20, s35, v20
    v_mul_f32 v21, s35, v21
    v_mul_f32 v22, s35, v22
    v_mul_f32 v23, s35, v23
    v_cvt_pk_bf16_f32 v112, v16, v17
    v_cvt_pk_bf16_f32 v113, v18, v19
    v_cvt_pk_bf16_f32 v114, v20, v21
    v_cvt_pk_bf16_f32 v115, v22, v23
    s_nop 1
    v_permlane16_swap_b32 v112, v114
    v_permlane16_swap_b32 v113, v115
    buffer_store_dwordx4 v[112:115], v2, s[8:11], s36 offen nt
    s_add_u32 s36, s36, s33
    v_mul_f32 v24, s35, v24
    v_mul_f32 v25, s35, v25
    v_mul_f32 v26, s35, v26
    v_mul_f32 v27, s35, v27
    v_mul_f32 v28, s35, v28
    v_mul_f32 v29, s35, v29
    v_mul_f32 v30, s35, v30
    v_mul_f32 v31, s35, v31
    v_cvt_pk_bf16_f32 v116, v24, v25
    v_cvt_pk_bf16_f32 v117, v26, v27
    v_cvt_pk_bf16_f32 v118, v28, v29
    v_cvt_pk_bf16_f32 v119, v30, v31
    s_nop 1
    v_permlane16_swap_b32 v116, v118
    v_permlane16_swap_b32 v117, v119
    buffer_store_dwordx4 v[116:119], v2, s[8:11], s36 offen nt
    s_add_u32 s36, s36, s37
    v_mul_f32 v32, s35, v32
    v_mul_f32 v33, s35, v33
    v_mul_f32 v34, s35, v34
    v_mul_f32 v35, s35, v35
    v_mul_f32 v36, s35, v36
    v_mul_f32 v37, s35, v37
    v_mul_f32 v38, s35, v38
    v_mul_f32 v39, s35, v39
    v_cvt_pk_bf16_f32 v112, v32, v33
    v_cvt_pk_bf16_f32 v113, v34, v35
    v_cvt_pk_bf16_f32 v114, v36, v37
    v_cvt_pk_bf16_f32 v115, v38, v39
    s_nop 1
    v_permlane16_swap_b32 v112, v114
    v_permlane16_swap_b32 v113, v115
    buffer_store_dwordx4 v[112:115], v2, s[8:11], s36 offen nt
    s_add_u32 s36, s36, s33
    v_mul_f32 v40, s35, v40
    v_mul_f32 v41, s35, v41
    v_mul_f32 v42, s35, v42
    v_mul_f32 v43, s35, v43
    v_mul_f32 v44, s35, v44
    v_mul_f32 v45, s35, v45
    v_mul_f32 v46, s35, v46
    v_mul_f32 v47, s35, v47
    v_cvt_pk_bf16_f32 v116, v40, v41
    v_cvt_pk_bf16_f32 v117, v42, v43
    v_cvt_pk_bf16_f32 v118, v44, v45
    v_cvt_pk_bf16_f32 v119, v46, v47
    s_nop 1
    v_permlane16_swap_b32 v116, v118
    v_permlane16_swap_b32 v117, v119
    buffer_store_dwordx4 v[116:119], v2, s[8:11], s36 offen nt
    s_branch K1_TN0
K1_TV0:
    s_mul_i32 s36, s32, 2368
    s_add_u32 s36, s36, 2359296
    v_cvt_pk_bf16_f32 v136, v16, v17
    v_cvt_pk_bf16_f32 v137, v18, v19
    v_cvt_pk_bf16_f32 v138, v20, v21
    v_cvt_pk_bf16_f32 v139, v22, v23
    s_nop 1
    v_mfma_f32_16x16x16_bf16 v[120:123], v[136:137], v[192:193], 0
    v_mfma_f32_16x16x16_bf16 v[124:127], v[138:139], v[192:193], 0
    s_nop 7
    v_cvt_pk_bf16_f32 v112, v120, v121
    v_cvt_pk_bf16_f32 v113, v122, v123
    v_cvt_pk_bf16_f32 v114, v124, v125
    v_cvt_pk_bf16_f32 v115, v126, v127
    s_nop 1
    v_permlane32_swap_b32 v112, v114
    v_permlane32_swap_b32 v113, v115
    buffer_store_dwordx4 v[112:115], v3, s[8:11], s36 offen nt
    s_add_u32 s36, s36, 2368
    v_cvt_pk_bf16_f32 v140, v24, v25
    v_cvt_pk_bf16_f32 v141, v26, v27
    v_cvt_pk_bf16_f32 v142, v28, v29
    v_cvt_pk_bf16_f32 v143, v30, v31
    s_nop 1
    v_mfma_f32_16x16x16_bf16 v[128:131], v[140:141], v[192:193], 0
    v_mfma_f32_16x16x16_bf16 v[132:135], v[142:143], v[192:193], 0
    s_nop 7
    v_cvt_pk_bf16_f32 v116, v128, v129
    v_cvt_pk_bf16_f32 v117, v130, v131
    v_cvt_pk_bf16_f32 v118, v132, v133
    v_cvt_pk_bf16_f32 v119, v134, v135
    s_nop 1
    v_permlane32_swap_b32 v116, v118
    v_permlane32_swap_b32 v117, v119
    buffer_store_dwordx4 v[116:119], v3, s[8:11], s36 offen nt
    s_add_u32 s36, s36, 149184
    v_cvt_pk_bf16_f32 v136, v32, v33
    v_cvt_pk_bf16_f32 v137, v34, v35
    v_cvt_pk_bf16_f32 v138, v36, v37
    v_cvt_pk_bf16_f32 v139, v38, v39
    s_nop 1
    v_mfma_f32_16x16x16_bf16 v[120:123], v[136:137], v[192:193], 0
    v_mfma_f32_16x16x16_bf16 v[124:127], v[138:139], v[192:193], 0
    s_nop 7
    v_cvt_pk_bf16_f32 v112, v120, v121
    v_cvt_pk_bf16_f32 v113, v122, v123
    v_cvt_pk_bf16_f32 v114, v124, v125
    v_cvt_pk_bf16_f32 v115, v126, v127
    s_nop 1
    v_permlane32_swap_b32 v112, v114
    v_permlane32_swap_b32 v113, v115
    buffer_store_dwordx4 v[112:115], v3, s[8:11], s36 offen nt
    s_add_u32 s36, s36, 2368
    v_cvt_pk_bf16_f32 v140, v40, v41
    v_cvt_pk_bf16_f32 v141, v42, v43
    v_cvt_pk_bf16_f32 v142, v44, v45
    v_cvt_pk_bf16_f32 v143, v46, v47
    s_nop 1
    v_mfma_f32_16x16x16_bf16 v[128:131], v[140:141], v[192:193], 0
    v_mfma_f32_16x16x16_bf16 v[132:135], v[142:143], v[192:193], 0
    s_nop 7
    v_cvt_pk_bf16_f32 v116, v128, v129
    v_cvt_pk_bf16_f32 v117, v130, v131
    v_cvt_pk_bf16_f32 v118, v132, v133
    v_cvt_pk_bf16_f32 v119, v134, v135
    s_nop 1
    v_permlane32_swap_b32 v116, v118
    v_permlane32_swap_b32 v117, v119
    buffer_store_dwordx4 v[116:119], v3, s[8:11], s36 offen nt
K1_TN0:
    s_add_u32 s31, s31, 1
    s_and_b32 s32, s31, 15
    s_lshl_b32 s32, s32, 7
    s_add_u32 s32, s32, s30
    s_cmp_ge_u32 s31, 32
    s_cbranch_scc1 K1_TV1
    s_cmp_ge_u32 s31, 16
    s_mov_b32 s33, 1152
    s_cselect_b32 s33, 2368, s33
    s_cselect_b32 s34, 2359296, 0
    s_cselect_b32 s35, 1.0, 0x3eae1a93
    s_mul_i32 s36, s32, s33
    s_add_u32 s36, s36, s34
    s_mul_i32 s37, s33, 63
    v_mul_f32 v48, s35, v48
    v_mul_f32 v49, s35, v49
    v_mul_f32 v50, s35, v50
    v_mul_f32 v51, s35, v51
    v_mul_f32 v52, s35, v52
    v_mul_f32 v53, s35, v53
    v_mul_f32 v54, s35, v54
    v_mul_f32 v55, s35, v55
    v_cvt_pk_bf16_f32 v112, v48, v49
    v_cvt_pk_bf16_f32 v113, v50, v51
    v_cvt_pk_bf16_f32 v114, v52, v53
    v_cvt_pk_bf16_f32 v115, v54, v55
    s_nop 1
    v_permlane16_swap_b32 v112, v114
    v_permlane16_swap_b32 v113, v115
    buffer_store_dwordx4 v[112:115], v2, s[8:11], s36 offen nt
    s_add_u32 s36, s36, s33
    v_mul_f32 v56, s35, v56
    v_mul_f32 v57, s35, v57
    v_mul_f32 v58, s35, v58
    v_mul_f32 v59, s35, v59
    v_mul_f32 v60, s35, v60
    v_mul_f32 v61, s35, v61
    v_mul_f32 v62, s35, v62
    v_mul_f32 v63, s35, v63
    v_cvt_pk_bf16_f32 v116, v56, v57
    v_cvt_pk_bf16_f32 v117, v58, v59
    v_cvt_pk_bf16_f32 v118, v60, v61
    v_cvt_pk_bf16_f32 v119, v62, v63
    s_nop 1
    v_permlane16_swap_b32 v116, v118
    v_permlane16_swap_b32 v117, v119
    buffer_store_dwordx4 v[116:119], v2, s[8:11], s36 offen nt
    s_add_u32 s36, s36, s37
    v_mul_f32 v64, s35, v64
    v_mul_f32 v65, s35, v65
    v_mul_f32 v66, s35, v66
    v_mul_f32 v67, s35, v67
    v_mul_f32 v68, s35, v68
    v_mul_f32 v69, s35, v69
    v_mul_f32 v70, s35, v70
    v_mul_f32 v71, s35, v71
    v_cvt_pk_bf16_f32 v112, v64, v65
    v_cvt_pk_bf16_f32 v113, v66, v67
    v_cvt_pk_bf16_f32 v114, v68, v69
    v_cvt_pk_bf16_f32 v115, v70, v71
    s_nop 1
    v_permlane16_swap_b32 v112, v114
    v_permlane16_swap_b32 v113, v115
    buffer_store_dwordx4 v[112:115], v2, s[8:11], s36 offen nt
    s_add_u32 s36, s36, s33
    v_mul_f32 v72, s35, v72
    v_mul_f32 v73, s35, v73
    v_mul_f32 v74, s35, v74
    v_mul_f32 v75, s35, v75
    v_mul_f32 v76, s35, v76
    v_mul_f32 v77, s35, v77
    v_mul_f32 v78, s35, v78
    v_mul_f32 v79, s35, v79
    v_cvt_pk_bf16_f32 v116, v72, v73
    v_cvt_pk_bf16_f32 v117, v74, v75
    v_cvt_pk_bf16_f32 v118, v76, v77
    v_cvt_pk_bf16_f32 v119, v78, v79
    s_nop 1
    v_permlane16_swap_b32 v116, v118
    v_permlane16_swap_b32 v117, v119
    buffer_store_dwordx4 v[116:119], v2, s[8:11], s36 offen nt
    s_branch K1_TN1
K1_TV1:
    s_mul_i32 s36, s32, 2368
    s_add_u32 s36, s36, 2359296
    v_cvt_pk_bf16_f32 v136, v48, v49
    v_cvt_pk_bf16_f32 v137, v50, v51
    v_cvt_pk_bf16_f32 v138, v52, v53
    v_cvt_pk_bf16_f32 v139, v54, v55
    s_nop 1
    v_mfma_f32_16x16x16_bf16 v[120:123], v[136:137], v[192:193], 0
    v_mfma_f32_16x16x16_bf16 v[124:127], v[138:139], v[192:193], 0
    s_nop 7
    v_cvt_pk_bf16_f32 v112, v120, v121
    v_cvt_pk_bf16_f32 v113, v122, v123
    v_cvt_pk_bf16_f32 v114, v124, v125
    v_cvt_pk_bf16_f32 v115, v126, v127
    s_nop 1
    v_permlane32_swap_b32 v112, v114
    v_permlane32_swap_b32 v113, v115
    buffer_store_dwordx4 v[112:115], v3, s[8:11], s36 offen nt
    s_add_u32 s36, s36, 2368
    v_cvt_pk_bf16_f32 v140, v56, v57
    v_cvt_pk_bf16_f32 v141, v58, v59
    v_cvt_pk_bf16_f32 v142, v60, v61
    v_cvt_pk_bf16_f32 v143, v62, v63
    s_nop 1
    v_mfma_f32_16x16x16_bf16 v[128:131], v[140:141], v[192:193], 0
    v_mfma_f32_16x16x16_bf16 v[132:135], v[142:143], v[192:193], 0
    s_nop 7
    v_cvt_pk_bf16_f32 v116, v128, v129
    v_cvt_pk_bf16_f32 v117, v130, v131
    v_cvt_pk_bf16_f32 v118, v132, v133
    v_cvt_pk_bf16_f32 v119, v134, v135
    s_nop 1
    v_permlane32_swap_b32 v116, v118
    v_permlane32_swap_b32 v117, v119
    buffer_store_dwordx4 v[116:119], v3, s[8:11], s36 offen nt
    s_add_u32 s36, s36, 149184
    v_cvt_pk_bf16_f32 v136, v64, v65
    v_cvt_pk_bf16_f32 v137, v66, v67
    v_cvt_pk_bf16_f32 v138, v68, v69
    v_cvt_pk_bf16_f32 v139, v70, v71
    s_nop 1
    v_mfma_f32_16x16x16_bf16 v[120:123], v[136:137], v[192:193], 0
    v_mfma_f32_16x16x16_bf16 v[124:127], v[138:139], v[192:193], 0
    s_nop 7
    v_cvt_pk_bf16_f32 v112, v120, v121
    v_cvt_pk_bf16_f32 v113, v122, v123
    v_cvt_pk_bf16_f32 v114, v124, v125
    v_cvt_pk_bf16_f32 v115, v126, v127
    s_nop 1
    v_permlane32_swap_b32 v112, v114
    v_permlane32_swap_b32 v113, v115
    buffer_store_dwordx4 v[112:115], v3, s[8:11], s36 offen nt
    s_add_u32 s36, s36, 2368
    v_cvt_pk_bf16_f32 v140, v72, v73
    v_cvt_pk_bf16_f32 v141, v74, v75
    v_cvt_pk_bf16_f32 v142, v76, v77
    v_cvt_pk_bf16_f32 v143, v78, v79
    s_nop 1
    v_mfma_f32_16x16x16_bf16 v[128:131], v[140:141], v[192:193], 0
    v_mfma_f32_16x16x16_bf16 v[132:135], v[142:143], v[192:193], 0
    s_nop 7
    v_cvt_pk_bf16_f32 v116, v128, v129
    v_cvt_pk_bf16_f32 v117, v130, v131
    v_cvt_pk_bf16_f32 v118, v132, v133
    v_cvt_pk_bf16_f32 v119, v134, v135
    s_nop 1
    v_permlane32_swap_b32 v116, v118
    v_permlane32_swap_b32 v117, v119
    buffer_store_dwordx4 v[116:119], v3, s[8:11], s36 offen nt
K1_TN1:
    s_add_u32 s31, s31, 1
    s_and_b32 s32, s31, 15
    s_lshl_b32 s32, s32, 7
    s_add_u32 s32, s32, s30
    s_cmp_ge_u32 s31, 32
    s_cbranch_scc1 K1_TV2
    s_cmp_ge_u32 s31, 16
    s_mov_b32 s33, 1152
    s_cselect_b32 s33, 2368, s33
    s_cselect_b32 s34, 2359296, 0
    s_cselect_b32 s35, 1.0, 0x3eae1a93
    s_mul_i32 s36, s32, s33
    s_add_u32 s36, s36, s34
    s_mul_i32 s37, s33, 63
    v_mul_f32 v80, s35, v80
    v_mul_f32 v81, s35, v81
    v_mul_f32 v82, s35, v82
    v_mul_f32 v83, s35, v83
    v_mul_f32 v84, s35, v84
    v_mul_f32 v85, s35, v85
    v_mul_f32 v86, s35, v86
    v_mul_f32 v87, s35, v87
    v_cvt_pk_bf16_f32 v112, v80, v81
    v_cvt_pk_bf16_f32 v113, v82, v83
    v_cvt_pk_bf16_f32 v114, v84, v85
    v_cvt_pk_bf16_f32 v115, v86, v87
    s_nop 1
    v_permlane16_swap_b32 v112, v114
    v_permlane16_swap_b32 v113, v115
    buffer_store_dwordx4 v[112:115], v2, s[8:11], s36 offen nt
    s_add_u32 s36, s36, s33
    v_mul_f32 v88, s35, v88
    v_mul_f32 v89, s35, v89
    v_mul_f32 v90, s35, v90
    v_mul_f32 v91, s35, v91
    v_mul_f32 v92, s35, v92
    v_mul_f32 v93, s35, v93
    v_mul_f32 v94, s35, v94
    v_mul_f32 v95, s35, v95
    v_cvt_pk_bf16_f32 v116, v88, v89
    v_cvt_pk_bf16_f32 v117, v90, v91
    v_cvt_pk_bf16_f32 v118, v92, v93
    v_cvt_pk_bf16_f32 v119, v94, v95
    s_nop 1
    v_permlane16_swap_b32 v116, v118
    v_permlane16_swap_b32 v117, v119
    buffer_store_dwordx4 v[116:119], v2, s[8:11], s36 offen nt
    s_add_u32 s36, s36, s37
    v_mul_f32 v96, s35, v96
    v_mul_f32 v97, s35, v97
    v_mul_f32 v98, s35, v98
    v_mul_f32 v99, s35, v99
    v_mul_f32 v100, s35, v100
    v_mul_f32 v101, s35, v101
    v_mul_f32 v102, s35, v102
    v_mul_f32 v103, s35, v103
    v_cvt_pk_bf16_f32 v112, v96, v97
    v_cvt_pk_bf16_f32 v113, v98, v99
    v_cvt_pk_bf16_f32 v114, v100, v101
    v_cvt_pk_bf16_f32 v115, v102, v103
    s_nop 1
    v_permlane16_swap_b32 v112, v114
    v_permlane16_swap_b32 v113, v115
    buffer_store_dwordx4 v[112:115], v2, s[8:11], s36 offen nt
    s_add_u32 s36, s36, s33
    v_mul_f32 v104, s35, v104
    v_mul_f32 v105, s35, v105
    v_mul_f32 v106, s35, v106
    v_mul_f32 v107, s35, v107
    v_mul_f32 v108, s35, v108
    v_mul_f32 v109, s35, v109
    v_mul_f32 v110, s35, v110
    v_mul_f32 v111, s35, v111
    v_cvt_pk_bf16_f32 v116, v104, v105
    v_cvt_pk_bf16_f32 v117, v106, v107
    v_cvt_pk_bf16_f32 v118, v108, v109
    v_cvt_pk_bf16_f32 v119, v110, v111
    s_nop 1
    v_permlane16_swap_b32 v116, v118
    v_permlane16_swap_b32 v117, v119
    buffer_store_dwordx4 v[116:119], v2, s[8:11], s36 offen nt
    s_branch K1_TN2
K1_TV2:
    s_mul_i32 s36, s32, 2368
    s_add_u32 s36, s36, 2359296
    v_cvt_pk_bf16_f32 v136, v80, v81
    v_cvt_pk_bf16_f32 v137, v82, v83
    v_cvt_pk_bf16_f32 v138, v84, v85
    v_cvt_pk_bf16_f32 v139, v86, v87
    s_nop 1
    v_mfma_f32_16x16x16_bf16 v[120:123], v[136:137], v[192:193], 0
    v_mfma_f32_16x16x16_bf16 v[124:127], v[138:139], v[192:193], 0
    s_nop 7
    v_cvt_pk_bf16_f32 v112, v120, v121
    v_cvt_pk_bf16_f32 v113, v122, v123
    v_cvt_pk_bf16_f32 v114, v124, v125
    v_cvt_pk_bf16_f32 v115, v126, v127
    s_nop 1
    v_permlane32_swap_b32 v112, v114
    v_permlane32_swap_b32 v113, v115
    buffer_store_dwordx4 v[112:115], v3, s[8:11], s36 offen nt
    s_add_u32 s36, s36, 2368
    v_cvt_pk_bf16_f32 v140, v88, v89
    v_cvt_pk_bf16_f32 v141, v90, v91
    v_cvt_pk_bf16_f32 v142, v92, v93
    v_cvt_pk_bf16_f32 v143, v94, v95
    s_nop 1
    v_mfma_f32_16x16x16_bf16 v[128:131], v[140:141], v[192:193], 0
    v_mfma_f32_16x16x16_bf16 v[132:135], v[142:143], v[192:193], 0
    s_nop 7
    v_cvt_pk_bf16_f32 v116, v128, v129
    v_cvt_pk_bf16_f32 v117, v130, v131
    v_cvt_pk_bf16_f32 v118, v132, v133
    v_cvt_pk_bf16_f32 v119, v134, v135
    s_nop 1
    v_permlane32_swap_b32 v116, v118
    v_permlane32_swap_b32 v117, v119
    buffer_store_dwordx4 v[116:119], v3, s[8:11], s36 offen nt
    s_add_u32 s36, s36, 149184
    v_cvt_pk_bf16_f32 v136, v96, v97
    v_cvt_pk_bf16_f32 v137, v98, v99
    v_cvt_pk_bf16_f32 v138, v100, v101
    v_cvt_pk_bf16_f32 v139, v102, v103
    s_nop 1
    v_mfma_f32_16x16x16_bf16 v[120:123], v[136:137], v[192:193], 0
    v_mfma_f32_16x16x16_bf16 v[124:127], v[138:139], v[192:193], 0
    s_nop 7
    v_cvt_pk_bf16_f32 v112, v120, v121
    v_cvt_pk_bf16_f32 v113, v122, v123
    v_cvt_pk_bf16_f32 v114, v124, v125
    v_cvt_pk_bf16_f32 v115, v126, v127
    s_nop 1
    v_permlane32_swap_b32 v112, v114
    v_permlane32_swap_b32 v113, v115
    buffer_store_dwordx4 v[112:115], v3, s[8:11], s36 offen nt
    s_add_u32 s36, s36, 2368
    v_cvt_pk_bf16_f32 v140, v104, v105
    v_cvt_pk_bf16_f32 v141, v106, v107
    v_cvt_pk_bf16_f32 v142, v108, v109
    v_cvt_pk_bf16_f32 v143, v110, v111
    s_nop 1
    v_mfma_f32_16x16x16_bf16 v[128:131], v[140:141], v[192:193], 0
    v_mfma_f32_16x16x16_bf16 v[132:135], v[142:143], v[192:193], 0
    s_nop 7
    v_cvt_pk_bf16_f32 v116, v128, v129
    v_cvt_pk_bf16_f32 v117, v130, v131
    v_cvt_pk_bf16_f32 v118, v132, v133
    v_cvt_pk_bf16_f32 v119, v134, v135
    s_nop 1
    v_permlane32_swap_b32 v116, v118
    v_permlane32_swap_b32 v117, v119
    buffer_store_dwordx4 v[116:119], v3, s[8:11], s36 offen nt
K1_TN2:
    s_endpgm
K1_ROLE_X:
    s_load_dwordx2 s[12:13], s[0:1], 8
    s_load_dwordx2 s[16:17], s[0:1], 16
    s_load_dwordx2 s[20:21], s[0:1], 56
    s_mov_b32 s14, 1152
    s_mov_b32 s15, 0x00020000
    s_mov_b32 s18, 1152
    s_mov_b32 s19, 0x00020000
    s_mov_b32 s22, 1152
    s_mov_b32 s23, 0x00020000
    s_mul_i32 s24, s7, 36
    v_add_u32 v15, s24, v0
    v_lshlrev_b32 v15, 1, v15
    s_waitcnt lgkmcnt(0)
    buffer_load_ushort v112, v15, s[12:15], 0 offen
    buffer_load_ushort v113, v15, s[16:19], 0 offen
    buffer_load_ushort v114, v15, s[20:23], 0 offen
    v_lshrrev_b32 v12, 4, v0
    v_and_b32 v13, 3, v0
    v_xor_b32 v12, v12, v13
    v_lshlrev_b32 v12, 4, v12
    v_bfe_u32 v13, v0, 2, 1
    v_lshl_add_u32 v14, v13, 6, v12
    v_bfe_u32 v12, v0, 2, 2
    v_lshlrev_b32 v12, 4, v12
    v_and_b32 v13, 3, v0
    v_add_u32 v12, v12, v13
    s_lshl_b32 s46, s5, 6
    v_add_u32 v12, s46, v12
    v_lshl_add_u32 v2, v12, 7, v14
    v_xor_b32 v3, 64, v2
    v_and_b32 v12, 15, v0
    v_lshl_add_u32 v5, v12, 7, v14
    v_add_u32 v5, 30720, v5
    v_xor_b32 v6, 64, v5
    v_lshrrev_b32 v12, 4, v0
    v_lshrrev_b32 v13, 1, v12
    v_lshlrev_b32 v13, 4, v13
    v_and_b32 v12, 1, v12
    v_lshl_add_u32 v13, v12, 2, v13
    v_bfe_u32 v12, v0, 2, 2
    v_add_u32 v13, v13, v12
    v_mul_u32_u24 v13, 224, v13
    s_and_b32 s46, s7, 1
    s_lshl_b32 s46, s46, 3
    s_add_u32 s46, s46, 16384
    v_add_u32 v4, s46, v13
    v_and_b32 v13, 3, v0
    v_min_u32 v13, 2, v13
    v_mul_u32_u24 v13, 72, v13
    v_add3_u32 v4, v4, v13, 32
    v_mov_b32 v16, 0
    v_mov_b32 v17, 0
    v_mov_b32 v18, 0
    v_mov_b32 v19, 0
    v_mov_b32 v20, 0
    v_mov_b32 v21, 0
    v_mov_b32 v22, 0
    v_mov_b32 v23, 0
    v_mov_b32 v24, 0
    v_mov_b32 v25, 0
    v_mov_b32 v26, 0
    v_mov_b32 v27, 0
    v_mov_b32 v28, 0
    v_mov_b32 v29, 0
    v_mov_b32 v30, 0
    v_mov_b32 v31, 0
    v_mov_b32 v32, 0
    v_mov_b32 v33, 0
    v_mov_b32 v34, 0
    v_mov_b32 v35, 0
    v_mov_b32 v36, 0
    v_mov_b32 v37, 0
    v_mov_b32 v38, 0
    v_mov_b32 v39, 0
    v_mov_b32 v40, 0
    v_mov_b32 v41, 0
    v_mov_b32 v42, 0
    v_mov_b32 v43, 0
    v_mov_b32 v44, 0
    v_mov_b32 v45, 0
    v_mov_b32 v46, 0
    v_mov_b32 v47, 0
    v_mov_b32 v48, 0
    v_mov_b32 v49, 0
    v_mov_b32 v50, 0
    v_mov_b32 v51, 0
    v_mov_b32 v52, 0
    v_mov_b32 v53, 0
    v_mov_b32 v54, 0
    v_mov_b32 v55, 0
    v_mov_b32 v56, 0
    v_mov_b32 v57, 0
    v_mov_b32 v58, 0
    v_mov_b32 v59, 0
    v_mov_b32 v60, 0
    v_mov_b32 v61, 0
    v_mov_b32 v62, 0
    v_mov_b32 v63, 0
    v_mov_b32 v64, 0
    v_mov_b32 v65, 0
    v_mov_b32 v66, 0
    v_mov_b32 v67, 0
    v_mov_b32 v68, 0
    v_mov_b32 v69, 0
    v_mov_b32 v70, 0
    v_mov_b32 v71, 0
    v_mov_b32 v72, 0
    v_mov_b32 v73, 0
    v_mov_b32 v74, 0
    v_mov_b32 v75, 0
    v_mov_b32 v76, 0
    v_mov_b32 v77, 0
    v_mov_b32 v78, 0
    v_mov_b32 v79, 0
    v_mov_b32 v80, 0
    v_mov_b32 v81, 0
    v_mov_b32 v82, 0
    v_mov_b32 v83, 0
    v_mov_b32 v84, 0
    v_mov_b32 v85, 0
    v_mov_b32 v86, 0
    v_mov_b32 v87, 0
    v_mov_b32 v88, 0
    v_mov_b32 v89, 0
    v_mov_b32 v90, 0
    v_mov_b32 v91, 0
    v_mov_b32 v92, 0
    v_mov_b32 v93, 0
    v_mov_b32 v94, 0
    v_mov_b32 v95, 0
    v_mov_b32 v96, 0
    v_mov_b32 v97, 0
    v_mov_b32 v98, 0
    v_mov_b32 v99, 0
    v_mov_b32 v100, 0
    v_mov_b32 v101, 0
    v_mov_b32 v102, 0
    v_mov_b32 v103, 0
    v_mov_b32 v104, 0
    v_mov_b32 v105, 0
    v_mov_b32 v106, 0
    v_mov_b32 v107, 0
    v_mov_b32 v108, 0
    v_mov_b32 v109, 0
    v_mov_b32 v110, 0
    v_mov_b32 v111, 0
    v_lshrrev_b32 v12, 4, v0
    v_lshlrev_b32 v12, 2, v12
    v_and_b32 v13, 15, v0
    v_sub_u32 v12, v13, v12
    v_mov_b32 v13, 0x3f80
    v_mov_b32 v14, 0x3f800000
    v_cmp_eq_u32 vcc, 0, v12
    s_nop 1
    v_cndmask_b32 v192, 0, v13, vcc
    v_cmp_eq_u32 vcc, 1, v12
    s_nop 1
    v_cndmask_b32 v192, v192, v14, vcc
    v_cmp_eq_u32 vcc, 2, v12
    s_nop 1
    v_cndmask_b32 v193, 0, v13, vcc
    v_cmp_eq_u32 vcc, 3, v12
    s_nop 1
    v_cndmask_b32 v193, v193, v14, vcc
    s_waitcnt vmcnt(0)
    v_lshlrev_b32 v112, 16, v112
    v_lshlrev_b32 v113, 16, v113
    v_lshlrev_b32 v114, 16, v114
    v_mul_f32 v120, 0x3fb8aa3b, v114
    v_exp_f32 v120, v120
    s_nop 0
    v_cvt_pk_bf16_f32 v120, v120, v120
    v_lshlrev_b32 v120, 16, v120
    v_mul_f32 v121, v120, v112
    v_mul_f32 v122, v120, v113
    v_mul_f32 v121, 0x3fb8aa3b, v121
    v_mul_f32 v122, 0.15915494, v122
    v_exp_f32 v121, v121
    v_fract_f32 v122, v122
    v_cos_f32 v123, v122
    v_sin_f32 v122, v122
    s_nop 0
    v_mul_f32 v116, v121, v123
    v_mul_f32 v117, v121, v122
    v_add_f32 v118, -1.0, v116
    v_mul_f32 v120, v112, v112
    v_fmac_f32 v120, v113, v113
    v_rcp_f32 v120, v120
    v_mul_f32 v121, v118, v112
    v_fmac_f32 v121, v117, v113
    v_mul_f32 v122, v117, v112
    v_fma_f32 v122, -v118, v113, v122
    v_mul_f32 v118, v121, v120
    v_mul_f32 v119, v122, v120
    s_or_b32 s24, s6, s5
    s_cmp_lg_u32 s24, 0
    s_cbranch_scc1 K1_NOLAM
    v_lshlrev_b32 v15, 2, v15
    v_add_f32 v118, v118, v118
    v_add_f32 v119, v119, v119
    s_mov_b32 s24, 12533760
    s_mov_b32 s25, 12538368
    v_lshrrev_b32 v12, 2, v15
    v_bfe_u32 v13, v12, 2, 2
    v_mul_u32_u24 v13, 1152, v13
    v_lshrrev_b32 v14, 4, v12
    v_lshl_add_u32 v13, v14, 4, v13
    v_bfe_u32 v14, v12, 1, 1
    v_lshl_add_u32 v13, v14, 3, v13
    s_mov_b32 exec_hi, 0xf
    buffer_store_dwordx2 v[116:117], v15, s[8:11], s24 offen nt
    buffer_store_dwordx2 v[118:119], v13, s[8:11], s25 offen nt
    s_mov_b32 exec_hi, -1
K1_NOLAM:
    v_and_b32 v12, 7, v0
    v_lshlrev_b32 v12, 2, v12
    v_add_u32 v13, 0, v12
    ds_bpermute_b32 v196, v13, v116
    ds_bpermute_b32 v201, v13, v117
    v_add_u32 v13, 32, v12
    ds_bpermute_b32 v197, v13, v116
    ds_bpermute_b32 v202, v13, v117
    v_add_u32 v13, 64, v12
    ds_bpermute_b32 v198, v13, v116
    ds_bpermute_b32 v203, v13, v117
    v_add_u32 v13, 96, v12
    ds_bpermute_b32 v199, v13, v116
    ds_bpermute_b32 v204, v13, v117
    v_add_u32 v13, 128, v12
    ds_bpermute_b32 v200, v13, v116
    ds_bpermute_b32 v205, v13, v117
    v_and_b32 v12, 8, v0
    v_lshlrev_b32 v12, 28, v12
    v_xor_b32 v12, 0x80000000, v12
    s_waitcnt lgkmcnt(0)
    v_xor_b32 v201, v12, v201
    v_xor_b32 v202, v12, v202
    v_xor_b32 v203, v12, v203
    v_xor_b32 v204, v12, v204
    v_xor_b32 v205, v12, v205
    s_barrier
    v_mov_b32 v7, v2
    v_mov_b32 v8, v3
    v_mov_b32 v9, v4
    v_mov_b32 v10, v5
    v_mov_b32 v11, v6
    s_mov_b32 s21, 40960
    s_mov_b32 s20, 0
    ds_read_b128 v[112:115], v7 offset:0
    ds_read_b128 v[116:119], v8 offset:512
    ds_read_b128 v[120:123], v7 offset:1024
    ds_read_b128 v[124:127], v8 offset:1536
    ds_read_b64_tr_b16 v[128:129], v9 offset:0
    ds_read_b64_tr_b16 v[130:131], v9 offset:1792
    ds_read_b128 v[132:135], v10 offset:0
    ds_read_b128 v[136:139], v10 offset:2048
    ds_read_b128 v[140:143], v10 offset:4096
    ds_read_b128 v[144:147], v10 offset:6144
    ds_read_b128 v[148:151], v10 offset:8192
K1_X_LOOP:
    s_waitcnt lgkmcnt(0)
    v_mfma_f32_16x16x32_bf16 v[16:19], v[128:131], v[112:115], v[16:19]
    ds_read_b128 v[152:155], v8 offset:0
    v_mfma_f32_16x16x32_bf16 v[20:23], v[128:131], v[116:119], v[20:23]
    ds_read_b128 v[156:159], v7 offset:512
    v_mfma_f32_16x16x32_bf16 v[24:27], v[128:131], v[120:123], v[24:27]
    ds_read_b128 v[160:163], v8 offset:1024
    v_mfma_f32_16x16x32_bf16 v[28:31], v[128:131], v[124:127], v[28:31]
    ds_read_b128 v[164:167], v7 offset:1536
    v_mfma_f32_16x16x32_bf16 v[32:35], v[112:115], v[132:135], v[32:35]
    ds_read_b64_tr_b16 v[168:169], v9 offset:7168
    v_mfma_f32_16x16x32_bf16 v[36:39], v[116:119], v[132:135], v[36:39]
    ds_read_b64_tr_b16 v[170:171], v9 offset:8960
    v_mfma_f32_16x16x32_bf16 v[40:43], v[120:123], v[132:135], v[40:43]
    ds_read_b128 v[172:175], v11 offset:0
    v_mfma_f32_16x16x32_bf16 v[44:47], v[124:127], v[132:135], v[44:47]
    ds_read_b128 v[176:179], v11 offset:2048
    v_mfma_f32_16x16x32_bf16 v[48:51], v[112:115], v[136:139], v[48:51]
    ds_read_b128 v[180:183], v11 offset:4096
    v_mfma_f32_16x16x32_bf16 v[52:55], v[116:119], v[136:139], v[52:55]
    ds_read_b128 v[184:187], v11 offset:6144
    v_mfma_f32_16x16x32_bf16 v[56:59], v[120:123], v[136:139], v[56:59]
    ds_read_b128 v[188:191], v11 offset:8192
    v_mfma_f32_16x16x32_bf16 v[60:63], v[124:127], v[136:139], v[60:63]
    v_mfma_f32_16x16x32_bf16 v[64:67], v[112:115], v[140:143], v[64:67]
    v_mfma_f32_16x16x32_bf16 v[68:71], v[116:119], v[140:143], v[68:71]
    v_mfma_f32_16x16x32_bf16 v[72:75], v[120:123], v[140:143], v[72:75]
    v_mfma_f32_16x16x32_bf16 v[76:79], v[124:127], v[140:143], v[76:79]
    v_mfma_f32_16x16x32_bf16 v[80:83], v[112:115], v[144:147], v[80:83]
    v_mfma_f32_16x16x32_bf16 v[84:87], v[116:119], v[144:147], v[84:87]
    v_mfma_f32_16x16x32_bf16 v[88:91], v[120:123], v[144:147], v[88:91]
    v_mfma_f32_16x16x32_bf16 v[92:95], v[124:127], v[144:147], v[92:95]
    v_mfma_f32_16x16x32_bf16 v[96:99], v[112:115], v[148:151], v[96:99]
    v_mfma_f32_16x16x32_bf16 v[100:103], v[116:119], v[148:151], v[100:103]
    v_mfma_f32_16x16x32_bf16 v[104:107], v[120:123], v[148:151], v[104:107]
    v_mfma_f32_16x16x32_bf16 v[108:111], v[124:127], v[148:151], v[108:111]
    s_waitcnt lgkmcnt(0)
    v_mfma_f32_16x16x32_bf16 v[16:19], v[168:171], v[152:155], v[16:19]
    v_mfma_f32_16x16x32_bf16 v[20:23], v[168:171], v[156:159], v[20:23]
    s_cmp_eq_u32 s20, 8
    s_cbranch_scc1 K1_X_NOBAR
    s_barrier
K1_X_NOBAR:
    v_add_u32 v7, s21, v2
    v_add_u32 v8, s21, v3
    v_add_u32 v9, s21, v4
    v_add_u32 v10, s21, v5
    v_add_u32 v11, s21, v6
    s_add_u32 s21, s21, 40960
    s_cmp_eq_u32 s21, 163840
    s_cselect_b32 s21, 0, s21
    v_mfma_f32_16x16x32_bf16 v[24:27], v[168:171], v[160:163], v[24:27]
    ds_read_b128 v[112:115], v7 offset:0
    v_mfma_f32_16x16x32_bf16 v[28:31], v[168:171], v[164:167], v[28:31]
    ds_read_b128 v[116:119], v8 offset:512
    v_mfma_f32_16x16x32_bf16 v[32:35], v[152:155], v[172:175], v[32:35]
    ds_read_b128 v[120:123], v7 offset:1024
    v_mfma_f32_16x16x32_bf16 v[36:39], v[156:159], v[172:175], v[36:39]
    ds_read_b128 v[124:127], v8 offset:1536
    v_mfma_f32_16x16x32_bf16 v[40:43], v[160:163], v[172:175], v[40:43]
    ds_read_b64_tr_b16 v[128:129], v9 offset:0
    v_mfma_f32_16x16x32_bf16 v[44:47], v[164:167], v[172:175], v[44:47]
    ds_read_b64_tr_b16 v[130:131], v9 offset:1792
    v_mfma_f32_16x16x32_bf16 v[48:51], v[152:155], v[176:179], v[48:51]
    ds_read_b128 v[132:135], v10 offset:0
    v_mfma_f32_16x16x32_bf16 v[52:55], v[156:159], v[176:179], v[52:55]
    ds_read_b128 v[136:139], v10 offset:2048
    v_mfma_f32_16x16x32_bf16 v[56:59], v[160:163], v[176:179], v[56:59]
    ds_read_b128 v[140:143], v10 offset:4096
    v_mfma_f32_16x16x32_bf16 v[60:63], v[164:167], v[176:179], v[60:63]
    ds_read_b128 v[144:147], v10 offset:6144
    v_mfma_f32_16x16x32_bf16 v[64:67], v[152:155], v[180:183], v[64:67]
    ds_read_b128 v[148:151], v10 offset:8192
    v_mfma_f32_16x16x32_bf16 v[68:71], v[156:159], v[180:183], v[68:71]
    v_mfma_f32_16x16x32_bf16 v[72:75], v[160:163], v[180:183], v[72:75]
    v_mfma_f32_16x16x32_bf16 v[76:79], v[164:167], v[180:183], v[76:79]
    v_mfma_f32_16x16x32_bf16 v[80:83], v[152:155], v[184:187], v[80:83]
    v_mfma_f32_16x16x32_bf16 v[84:87], v[156:159], v[184:187], v[84:87]
    v_mfma_f32_16x16x32_bf16 v[88:91], v[160:163], v[184:187], v[88:91]
    v_mfma_f32_16x16x32_bf16 v[92:95], v[164:167], v[184:187], v[92:95]
    v_mfma_f32_16x16x32_bf16 v[96:99], v[152:155], v[188:191], v[96:99]
    v_mfma_f32_16x16x32_bf16 v[100:103], v[156:159], v[188:191], v[100:103]
    v_mfma_f32_16x16x32_bf16 v[104:107], v[160:163], v[188:191], v[104:107]
    v_mfma_f32_16x16x32_bf16 v[108:111], v[164:167], v[188:191], v[108:111]
    s_add_u32 s20, s20, 1
    s_cmp_lt_u32 s20, 9
    s_cbranch_scc1 K1_X_LOOP
    s_waitcnt vmcnt(0) lgkmcnt(0)
    s_nop 7
    s_lshl_b32 s30, s6, 1
    s_add_u32 s30, s30, s5
    v_and_b32 v12, 7, v0
    v_bfe_u32 v13, v0, 3, 1
    v_lshrrev_b32 v14, 4, v0
    v_lshlrev_b32 v2, 7, v12
    v_mul_u32_u24 v15, 73728, v13
    v_add_u32 v2, v2, v15
    v_lshl_add_u32 v2, v14, 5, v2
    v_lshlrev_b32 v3, 5, v12
    v_lshl_add_u32 v3, v13, 2, v3
    v_lshl_add_u32 v3, v14, 3, v3
    s_mul_i32 s31, s30, 147456
    s_mul_i32 s32, s7, 4608
    s_add_u32 s31, s31, s32
    s_add_u32 s31, s31, 7217152
    s_mul_i32 s33, s30, 18432
    s_mul_i32 s32, s7, 1152
    s_add_u32 s33, s33, s32
    s_add_u32 s33, s33, 11935744
    v_cvt_pk_bf16_f32 v112, v32, v33
    v_cvt_pk_bf16_f32 v113, v34, v35
    v_cvt_pk_bf16_f32 v114, v36, v37
    v_cvt_pk_bf16_f32 v115, v38, v39
    v_cvt_pk_bf16_f32 v116, v40, v41
    v_cvt_pk_bf16_f32 v117, v42, v43
    v_cvt_pk_bf16_f32 v118, v44, v45
    v_cvt_pk_bf16_f32 v119, v46, v47
    buffer_store_dwordx4 v[112:115], v2, s[8:11], s31 offen offset:0 nt
    buffer_store_dwordx4 v[116:119], v2, s[8:11], s31 offen offset:16 nt
    s_add_u32 s31, s31, 1024
    v_cvt_pk_bf16_f32 v120, v48, v49
    v_cvt_pk_bf16_f32 v121, v50, v51
    v_cvt_pk_bf16_f32 v122, v52, v53
    v_cvt_pk_bf16_f32 v123, v54, v55
    v_cvt_pk_bf16_f32 v124, v56, v57
    v_cvt_pk_bf16_f32 v125, v58, v59
    v_cvt_pk_bf16_f32 v126, v60, v61
    v_cvt_pk_bf16_f32 v127, v62, v63
    buffer_store_dwordx4 v[120:123], v2, s[8:11], s31 offen offset:0 nt
    buffer_store_dwordx4 v[124:127], v2, s[8:11], s31 offen offset:16 nt
    s_add_u32 s31, s31, 1024
    v_cvt_pk_bf16_f32 v112, v64, v65
    v_cvt_pk_bf16_f32 v113, v66, v67
    v_cvt_pk_bf16_f32 v114, v68, v69
    v_cvt_pk_bf16_f32 v115, v70, v71
    v_cvt_pk_bf16_f32 v116, v72, v73
    v_cvt_pk_bf16_f32 v117, v74, v75
    v_cvt_pk_bf16_f32 v118, v76, v77
    v_cvt_pk_bf16_f32 v119, v78, v79
    buffer_store_dwordx4 v[112:115], v2, s[8:11], s31 offen offset:0 nt
    buffer_store_dwordx4 v[116:119], v2, s[8:11], s31 offen offset:16 nt
    s_add_u32 s31, s31, 1024
    v_cvt_pk_bf16_f32 v120, v80, v81
    v_cvt_pk_bf16_f32 v121, v82, v83
    v_cvt_pk_bf16_f32 v122, v84, v85
    v_cvt_pk_bf16_f32 v123, v86, v87
    v_cvt_pk_bf16_f32 v124, v88, v89
    v_cvt_pk_bf16_f32 v125, v90, v91
    v_cvt_pk_bf16_f32 v126, v92, v93
    v_cvt_pk_bf16_f32 v127, v94, v95
    buffer_store_dwordx4 v[120:123], v2, s[8:11], s31 offen offset:0 nt
    buffer_store_dwordx4 v[124:127], v2, s[8:11], s31 offen offset:16 nt
    s_add_u32 s31, s31, 1024
    v_cvt_pk_bf16_f32 v112, v96, v97
    v_cvt_pk_bf16_f32 v113, v98, v99
    v_cvt_pk_bf16_f32 v114, v100, v101
    v_cvt_pk_bf16_f32 v115, v102, v103
    v_cvt_pk_bf16_f32 v116, v104, v105
    v_cvt_pk_bf16_f32 v117, v106, v107
    v_cvt_pk_bf16_f32 v118, v108, v109
    v_cvt_pk_bf16_f32 v119, v110, v111
    s_mov_b32 exec_lo, 0x0f0f0f0f
    s_mov_b32 exec_hi, 0x0f0f0f0f
    buffer_store_dwordx4 v[112:115], v2, s[8:11], s31 offen offset:0 nt
    buffer_store_dwordx4 v[116:119], v2, s[8:11], s31 offen offset:16 nt
    s_mov_b32 exec_lo, -1
    s_mov_b32 exec_hi, -1
    s_cmp_lg_u32 s7, 0
    s_cbranch_scc1 K1_NOG
    s_lshl_b32 s34, s5, 8
    s_add_u32 s34, s34, 40960
    v_lshlrev_b32 v12, 6, v14
    v_add_u32 v12, s34, v12
    s_mov_b32 exec_lo, 0x00100010
    s_mov_b32 exec_hi, 0x00100010
    ds_write_b128 v12, v[96:99] offset:0
    ds_write_b128 v12, v[100:103] offset:16
    ds_write_b128 v12, v[104:107] offset:32
    ds_write_b128 v12, v[108:111] offset:48
    s_mov_b32 exec_lo, -1
    s_mov_b32 exec_hi, -1
    v_lshlrev_b32 v12, 2, v0
    v_add_u32 v13, s34, v12
    s_waitcnt lgkmcnt(0)
    ds_read_b32 v13, v13
    s_waitcnt lgkmcnt(0)
    v_mul_f32 v13, 0xbfb8aa3b, v13
    v_exp_f32 v13, v13
    s_nop 0
    v_add_f32 v13, 1.0, v13
    v_rcp_f32 v13, v13
    s_lshl_b32 s34, s30, 8
    s_add_u32 s34, s34, 12525568
    buffer_store_dword v13, v12, s[8:11], s34 offen nt
K1_NOG:
    v_fmac_f32 v33, v196, v32
    v_fmac_f32 v49, v197, v48
    v_fmac_f32 v65, v198, v64
    v_fmac_f32 v81, v199, v80
    v_fmac_f32 v97, v200, v96
    v_fmac_f32_dpp v33, v32, v201 row_ror:8 row_mask:0xf bank_mask:0xf
    v_fmac_f32_dpp v49, v48, v202 row_ror:8 row_mask:0xf bank_mask:0xf
    v_fmac_f32_dpp v65, v64, v203 row_ror:8 row_mask:0xf bank_mask:0xf
    v_fmac_f32_dpp v81, v80, v204 row_ror:8 row_mask:0xf bank_mask:0xf
    v_fmac_f32_dpp v97, v96, v205 row_ror:8 row_mask:0xf bank_mask:0xf
    v_fmac_f32 v34, v196, v33
    v_fmac_f32 v50, v197, v49
    v_fmac_f32 v66, v198, v65
    v_fmac_f32 v82, v199, v81
    v_fmac_f32 v98, v200, v97
    v_fmac_f32_dpp v34, v33, v201 row_ror:8 row_mask:0xf bank_mask:0xf
    v_fmac_f32_dpp v50, v49, v202 row_ror:8 row_mask:0xf bank_mask:0xf
    v_fmac_f32_dpp v66, v65, v203 row_ror:8 row_mask:0xf bank_mask:0xf
    v_fmac_f32_dpp v82, v81, v204 row_ror:8 row_mask:0xf bank_mask:0xf
    v_fmac_f32_dpp v98, v97, v205 row_ror:8 row_mask:0xf bank_mask:0xf
    v_fmac_f32 v35, v196, v34
    v_fmac_f32 v51, v197, v50
    v_fmac_f32 v67, v198, v66
    v_fmac_f32 v83, v199, v82
    v_fmac_f32 v99, v200, v98
    v_fmac_f32_dpp v35, v34, v201 row_ror:8 row_mask:0xf bank_mask:0xf
    v_fmac_f32_dpp v51, v50, v202 row_ror:8 row_mask:0xf bank_mask:0xf
    v_fmac_f32_dpp v67, v66, v203 row_ror:8 row_mask:0xf bank_mask:0xf
    v_fmac_f32_dpp v83, v82, v204 row_ror:8 row_mask:0xf bank_mask:0xf
    v_fmac_f32_dpp v99, v98, v205 row_ror:8 row_mask:0xf bank_mask:0xf
    v_fmac_f32 v36, v196, v35
    v_fmac_f32 v52, v197, v51
    v_fmac_f32 v68, v198, v67
    v_fmac_f32 v84, v199, v83
    v_fmac_f32 v100, v200, v99
    v_fmac_f32_dpp v36, v35, v201 row_ror:8 row_mask:0xf bank_mask:0xf
    v_fmac_f32_dpp v52, v51, v202 row_ror:8 row_mask:0xf bank_mask:0xf
    v_fmac_f32_dpp v68, v67, v203 row_ror:8 row_mask:0xf bank_mask:0xf
    v_fmac_f32_dpp v84, v83, v204 row_ror:8 row_mask:0xf bank_mask:0xf
    v_fmac_f32_dpp v100, v99, v205 row_ror:8 row_mask:0xf bank_mask:0xf
    v_fmac_f32 v37, v196, v36
    v_fmac_f32 v53, v197, v52
    v_fmac_f32 v69, v198, v68
    v_fmac_f32 v85, v199, v84
    v_fmac_f32 v101, v200, v100
    v_fmac_f32_dpp v37, v36, v201 row_ror:8 row_mask:0xf bank_mask:0xf
    v_fmac_f32_dpp v53, v52, v202 row_ror:8 row_mask:0xf bank_mask:0xf
    v_fmac_f32_dpp v69, v68, v203 row_ror:8 row_mask:0xf bank_mask:0xf
    v_fmac_f32_dpp v85, v84, v204 row_ror:8 row_mask:0xf bank_mask:0xf
    v_fmac_f32_dpp v101, v100, v205 row_ror:8 row_mask:0xf bank_mask:0xf
    v_fmac_f32 v38, v196, v37
    v_fmac_f32 v54, v197, v53
    v_fmac_f32 v70, v198, v69
    v_fmac_f32 v86, v199, v85
    v_fmac_f32 v102, v200, v101
    v_fmac_f32_dpp v38, v37, v201 row_ror:8 row_mask:0xf bank_mask:0xf
    v_fmac_f32_dpp v54, v53, v202 row_ror:8 row_mask:0xf bank_mask:0xf
    v_fmac_f32_dpp v70, v69, v203 row_ror:8 row_mask:0xf bank_mask:0xf
    v_fmac_f32_dpp v86, v85, v204 row_ror:8 row_mask:0xf bank_mask:0xf
    v_fmac_f32_dpp v102, v101, v205 row_ror:8 row_mask:0xf bank_mask:0xf
    v_fmac_f32 v39, v196, v38
    v_fmac_f32 v55, v197, v54
    v_fmac_f32 v71, v198, v70
    v_fmac_f32 v87, v199, v86
    v_fmac_f32 v103, v200, v102
    v_fmac_f32_dpp v39, v38, v201 row_ror:8 row_mask:0xf bank_mask:0xf
    v_fmac_f32_dpp v55, v54, v202 row_ror:8 row_mask:0xf bank_mask:0xf
    v_fmac_f32_dpp v71, v70, v203 row_ror:8 row_mask:0xf bank_mask:0xf
    v_fmac_f32_dpp v87, v86, v204 row_ror:8 row_mask:0xf bank_mask:0xf
    v_fmac_f32_dpp v103, v102, v205 row_ror:8 row_mask:0xf bank_mask:0xf
    v_fmac_f32 v40, v196, v39
    v_fmac_f32 v56, v197, v55
    v_fmac_f32 v72, v198, v71
    v_fmac_f32 v88, v199, v87
    v_fmac_f32 v104, v200, v103
    v_fmac_f32_dpp v40, v39, v201 row_ror:8 row_mask:0xf bank_mask:0xf
    v_fmac_f32_dpp v56, v55, v202 row_ror:8 row_mask:0xf bank_mask:0xf
    v_fmac_f32_dpp v72, v71, v203 row_ror:8 row_mask:0xf bank_mask:0xf
    v_fmac_f32_dpp v88, v87, v204 row_ror:8 row_mask:0xf bank_mask:0xf
    v_fmac_f32_dpp v104, v103, v205 row_ror:8 row_mask:0xf bank_mask:0xf
    v_fmac_f32 v41, v196, v40
    v_fmac_f32 v57, v197, v56
    v_fmac_f32 v73, v198, v72
    v_fmac_f32 v89, v199, v88
    v_fmac_f32 v105, v200, v104
    v_fmac_f32_dpp v41, v40, v201 row_ror:8 row_mask:0xf bank_mask:0xf
    v_fmac_f32_dpp v57, v56, v202 row_ror:8 row_mask:0xf bank_mask:0xf
    v_fmac_f32_dpp v73, v72, v203 row_ror:8 row_mask:0xf bank_mask:0xf
    v_fmac_f32_dpp v89, v88, v204 row_ror:8 row_mask:0xf bank_mask:0xf
    v_fmac_f32_dpp v105, v104, v205 row_ror:8 row_mask:0xf bank_mask:0xf
    v_fmac_f32 v42, v196, v41
    v_fmac_f32 v58, v197, v57
    v_fmac_f32 v74, v198, v73
    v_fmac_f32 v90, v199, v89
    v_fmac_f32 v106, v200, v105
    v_fmac_f32_dpp v42, v41, v201 row_ror:8 row_mask:0xf bank_mask:0xf
    v_fmac_f32_dpp v58, v57, v202 row_ror:8 row_mask:0xf bank_mask:0xf
    v_fmac_f32_dpp v74, v73, v203 row_ror:8 row_mask:0xf bank_mask:0xf
    v_fmac_f32_dpp v90, v89, v204 row_ror:8 row_mask:0xf bank_mask:0xf
    v_fmac_f32_dpp v106, v105, v205 row_ror:8 row_mask:0xf bank_mask:0xf
    v_fmac_f32 v43, v196, v42
    v_fmac_f32 v59, v197, v58
    v_fmac_f32 v75, v198, v74
    v_fmac_f32 v91, v199, v90
    v_fmac_f32 v107, v200, v106
    v_fmac_f32_dpp v43, v42, v201 row_ror:8 row_mask:0xf bank_mask:0xf
    v_fmac_f32_dpp v59, v58, v202 row_ror:8 row_mask:0xf bank_mask:0xf
    v_fmac_f32_dpp v75, v74, v203 row_ror:8 row_mask:0xf bank_mask:0xf
    v_fmac_f32_dpp v91, v90, v204 row_ror:8 row_mask:0xf bank_mask:0xf
    v_fmac_f32_dpp v107, v106, v205 row_ror:8 row_mask:0xf bank_mask:0xf
    v_fmac_f32 v44, v196, v43
    v_fmac_f32 v60, v197, v59
    v_fmac_f32 v76, v198, v75
    v_fmac_f32 v92, v199, v91
    v_fmac_f32 v108, v200, v107
    v_fmac_f32_dpp v44, v43, v201 row_ror:8 row_mask:0xf bank_mask:0xf
    v_fmac_f32_dpp v60, v59, v202 row_ror:8 row_mask:0xf bank_mask:0xf
    v_fmac_f32_dpp v76, v75, v203 row_ror:8 row_mask:0xf bank_mask:0xf
    v_fmac_f32_dpp v92, v91, v204 row_ror:8 row_mask:0xf bank_mask:0xf
    v_fmac_f32_dpp v108, v107, v205 row_ror:8 row_mask:0xf bank_mask:0xf
    v_fmac_f32 v45, v196, v44
    v_fmac_f32 v61, v197, v60
    v_fmac_f32 v77, v198, v76
    v_fmac_f32 v93, v199, v92
    v_fmac_f32 v109, v200, v108
    v_fmac_f32_dpp v45, v44, v201 row_ror:8 row_mask:0xf bank_mask:0xf
    v_fmac_f32_dpp v61, v60, v202 row_ror:8 row_mask:0xf bank_mask:0xf
    v_fmac_f32_dpp v77, v76, v203 row_ror:8 row_mask:0xf bank_mask:0xf
    v_fmac_f32_dpp v93, v92, v204 row_ror:8 row_mask:0xf bank_mask:0xf
    v_fmac_f32_dpp v109, v108, v205 row_ror:8 row_mask:0xf bank_mask:0xf
    v_fmac_f32 v46, v196, v45
    v_fmac_f32 v62, v197, v61
    v_fmac_f32 v78, v198, v77
    v_fmac_f32 v94, v199, v93
    v_fmac_f32 v110, v200, v109
    v_fmac_f32_dpp v46, v45, v201 row_ror:8 row_mask:0xf bank_mask:0xf
    v_fmac_f32_dpp v62, v61, v202 row_ror:8 row_mask:0xf bank_mask:0xf
    v_fmac_f32_dpp v78, v77, v203 row_ror:8 row_mask:0xf bank_mask:0xf
    v_fmac_f32_dpp v94, v93, v204 row_ror:8 row_mask:0xf bank_mask:0xf
    v_fmac_f32_dpp v110, v109, v205 row_ror:8 row_mask:0xf bank_mask:0xf
    v_fmac_f32 v47, v196, v46
    v_fmac_f32 v63, v197, v62
    v_fmac_f32 v79, v198, v78
    v_fmac_f32 v95, v199, v94
    v_fmac_f32 v111, v200, v110
    v_fmac_f32_dpp v47, v46, v201 row_ror:8 row_mask:0xf bank_mask:0xf
    v_fmac_f32_dpp v63, v62, v202 row_ror:8 row_mask:0xf bank_mask:0xf
    v_fmac_f32_dpp v79, v78, v203 row_ror:8 row_mask:0xf bank_mask:0xf
    v_fmac_f32_dpp v95, v94, v204 row_ror:8 row_mask:0xf bank_mask:0xf
    v_fmac_f32_dpp v111, v110, v205 row_ror:8 row_mask:0xf bank_mask:0xf
    buffer_store_dword v47, v3, s[8:11], s33 offen offset:0 nt
    buffer_store_dword v63, v3, s[8:11], s33 offen offset:256 nt
    buffer_store_dword v79, v3, s[8:11], s33 offen offset:512 nt
    buffer_store_dword v95, v3, s[8:11], s33 offen offset:768 nt
    s_mov_b32 exec_lo, 0x0f0f0f0f
    s_mov_b32 exec_hi, 0x0f0f0f0f
    buffer_store_dword v111, v3, s[8:11], s33 offen offset:1024 nt
    s_mov_b32 exec_lo, -1
    s_mov_b32 exec_hi, -1
    s_lshl_b32 s30, s6, 2
    s_lshl_b32 s31, s5, 1
    s_add_u32 s30, s30, s31
    s_mul_i32 s31, s7, 3
    v_add_u32 v2, s31, v14
    v_and_b32 v3, 15, v2
    v_lshlrev_b32 v3, 7, v3
    v_bfe_u32 v4, v0, 3, 1
    v_add3_u32 v3, v3, v4, s30
    v_cmp_gt_u32 vcc, 16, v2
    v_mov_b32 v5, 2368
    v_mov_b32 v6, 1152
    v_cndmask_b32 v5, v5, v6, vcc
    v_mov_b32 v6, 2360320
    v_mov_b32 v7, 1024
    v_cndmask_b32 v6, v6, v7, vcc
    v_mov_b32 v7, 0x3eae1a93
    v_cndmask_b32 v7, 1.0, v7, vcc
    v_mul_lo_u32 v3, v3, v5
    v_add_u32 v3, v3, v6
    v_bfe_u32 v4, v0, 2, 1
    v_lshlrev_b32 v4, 4, v4
    v_and_b32 v6, 3, v0
    v_add_u32 v4, v4, v6
    v_lshl_add_u32 v3, v4, 2, v3
    v_lshl_add_u32 v4, v5, 6, v3
    v_cmp_gt_u32 vcc, 32, v2
    v_cmp_gt_u32 s[36:37], 48, v0
    s_and_b64 s[36:37], s[36:37], vcc
    v_mul_f32 v112, v7, v16
    v_mul_f32 v113, v7, v17
    v_mul_f32 v114, v7, v18
    v_mul_f32 v115, v7, v19
    v_cvt_pk_bf16_f32 v128, v112, v113
    v_cvt_pk_bf16_f32 v129, v114, v115
    v_mul_f32 v116, v7, v20
    v_mul_f32 v117, v7, v21
    v_mul_f32 v118, v7, v22
    v_mul_f32 v119, v7, v23
    v_cvt_pk_bf16_f32 v130, v116, v117
    v_cvt_pk_bf16_f32 v131, v118, v119
    v_mul_f32 v120, v7, v24
    v_mul_f32 v121, v7, v25
    v_mul_f32 v122, v7, v26
    v_mul_f32 v123, v7, v27
    v_cvt_pk_bf16_f32 v132, v120, v121
    v_cvt_pk_bf16_f32 v133, v122, v123
    v_mul_f32 v124, v7, v28
    v_mul_f32 v125, v7, v29
    v_mul_f32 v126, v7, v30
    v_mul_f32 v127, v7, v31
    v_cvt_pk_bf16_f32 v134, v124, v125
    v_cvt_pk_bf16_f32 v135, v126, v127
    s_mov_b64 exec, s[36:37]
    s_cbranch_execz K1_NOQK
    buffer_store_dword v128, v3, s[8:11], 0 offen offset:0 nt
    buffer_store_dword v129, v4, s[8:11], 0 offen offset:0 nt
    buffer_store_dword v130, v3, s[8:11], 0 offen offset:16 nt
    buffer_store_dword v131, v4, s[8:11], 0 offen offset:16 nt
    buffer_store_dword v132, v3, s[8:11], 0 offen offset:32 nt
    buffer_store_dword v133, v4, s[8:11], 0 offen offset:32 nt
    buffer_store_dword v134, v3, s[8:11], 0 offen offset:48 nt
    buffer_store_dword v135, v4, s[8:11], 0 offen offset:48 nt
K1_NOQK:
    s_mov_b64 exec, -1
    s_add_u32 s32, s31, 2
    s_cmp_lt_u32 s32, 32
    s_cbranch_scc1 K1_XEND
    v_mfma_f32_16x16x16_bf16 v[136:139], v[128:129], v[192:193], 0
    v_mfma_f32_16x16x16_bf16 v[140:143], v[130:131], v[192:193], 0
    v_mfma_f32_16x16x16_bf16 v[144:147], v[132:133], v[192:193], 0
    v_mfma_f32_16x16x16_bf16 v[148:151], v[134:135], v[192:193], 0
    v_and_b32 v12, 15, v0
    v_lshrrev_b32 v13, 2, v12
    v_add_u32 v2, s31, v13
    v_and_b32 v3, 15, v2
    v_lshlrev_b32 v3, 7, v3
    v_bfe_u32 v4, v0, 1, 1
    v_lshl_add_u32 v3, v4, 6, v3
    v_lshrrev_b32 v4, 5, v0
    v_add3_u32 v3, v3, v4, s30
    v_mul_u32_u24 v3, 2368, v3
    v_bfe_u32 v4, v0, 4, 1
    v_mul_u32_u24 v4, 608, v4
    v_and_b32 v5, 1, v0
    v_lshl_add_u32 v4, v5, 4, v4
    v_add_u32 v3, v3, v4
    v_add_u32 v3, 2360704, v3
    v_cmp_le_u32 vcc, 32, v2
    v_cmp_gt_u32 s[36:37], 12, v12
    s_and_b64 s[36:37], s[36:37], vcc
    v_mov_b32 v120, 0x3f803f80
    v_mov_b32 v121, 0x3f803f80
    v_mov_b32 v122, 0x3f803f80
    v_mov_b32 v123, 0x3f803f80
    v_cvt_pk_bf16_f32 v112, v136, v137
    v_cvt_pk_bf16_f32 v113, v138, v139
    v_cvt_pk_bf16_f32 v114, v144, v145
    v_cvt_pk_bf16_f32 v115, v146, v147
    v_cvt_pk_bf16_f32 v116, v140, v141
    v_cvt_pk_bf16_f32 v117, v142, v143
    v_cvt_pk_bf16_f32 v118, v148, v149
    v_cvt_pk_bf16_f32 v119, v150, v151
    s_mov_b64 exec, s[36:37]
    buffer_store_dwordx4 v[112:115], v3, s[8:11], 0 offen nt
    buffer_store_dwordx4 v[116:119], v3, s[8:11], 0 offen offset:304 nt
    s_and_b32 exec_lo, exec_lo, 0x55555555
    s_and_b32 exec_hi, exec_hi, 0x55555555
    buffer_store_dwordx4 v[120:123], v3, s[8:11], 0 offen offset:32 nt
    buffer_store_dwordx4 v[120:123], v3, s[8:11], 0 offen offset:336 nt
K1_XEND:
    s_endpgm
K1_END:
    s_endpgm
.globl k2_kernel
.p2align 8
.type k2_kernel,@function
k2_kernel:
    s_cmp_ge_u32 s2, 256
    s_cbranch_scc1 K2_END
    s_load_dwordx2 s[8:9], s[0:1], 120
    s_load_dwordx2 s[12:13], s[0:1], 120
    s_load_dwordx2 s[16:17], s[0:1], 40
    s_load_dwordx2 s[24:25], s[0:1], 48
    v_lshrrev_b32 v1, 6, v0
    v_and_b32 v0, 63, v0
    v_readfirstlane_b32 s3, v1
    s_cmp_ge_u32 s3, 10
    s_cbranch_scc0 K2_PFSKIP
    s_lshr_b32 s62, s2, 2
    s_and_b32 s62, s62, -2
    s_and_b32 s63, s3, 1
    s_or_b32 s63, s63, s62
    s_and_b32 s63, s63, 7
    s_lshl_b32 s63, s63, 13
    s_getpc_b64 s[60:61]
K2_PFA:
    v_lshlrev_b32 v166, 7, v0
    v_add_u32 v166, s63, v166
    v_min_u32 v166, (TEXT_END-K2_PFA)-4, v166
    v_mov_b32 v155, s61
    v_add_co_u32 v154, vcc, s60, v166
    v_addc_co_u32 v155, vcc, 0, v155, vcc
    global_load_dword v166, v[154:155], off
K2_PFSKIP:
    s_mov_b32 s10, 33554432
    s_mov_b32 s11, 0x00020000
    s_mov_b32 s14, 589824
    s_mov_b32 s15, 0x00020000
    s_mov_b32 s18, 663552
    s_mov_b32 s19, 0x00020000
    s_mov_b32 s26, 663552
    s_mov_b32 s27, 0x00020000
    s_and_b32 s4, s2, 7
    s_lshl_b32 s4, s4, 2
    s_lshr_b32 s5, s2, 3
    s_and_b32 s6, s5, 3
    s_add_u32 s4, s4, s6
    s_lshr_b32 s5, s2, 5
    s_lshl_b32 s5, s5, 3
    s_add_u32 s5, s5, s3
    s_lshl_b32 s6, s4, 6
    s_add_u32 s6, s6, s5
    s_mul_i32 s6, s6, 1152
    s_cmp_ge_u32 s3, 8
    s_cbranch_scc1 K2_HELP
    v_lshlrev_b32 v1, 4, v0
    v_and_b32 v12, 31, v0
    v_lshlrev_b32 v2, 2, v12
    v_add_u32 v2, 1024, v2
    v_lshlrev_b32 v3, 4, v12
    v_lshrrev_b32 v13, 5, v0
    v_mul_u32_u24 v13, 304, v13
    v_add_u32 v3, v3, v13
    v_add_u32 v3, 1152, v3
    v_mov_b32 v13, 0x30000
    v_cmp_gt_u32 vcc, 19, v12
    s_nop 1
    v_cndmask_b32 v3, v13, v3, vcc
    v_cmp_gt_u32 vcc, 32, v0
    s_nop 1
    v_cndmask_b32 v2, v13, v2, vcc
    v_lshlrev_b32 v11, 4, v0
    v_lshlrev_b32 v14, 2, v12
    s_lshl_b32 s36, s5, 7
    s_add_u32 s36, s36, 12525568
    s_waitcnt lgkmcnt(0)
    buffer_load_dwordx4 v[4:7], v11, s[8:11], s6 offen
    buffer_load_dword v8, v14, s[8:11], s6 offen offset:1024
    buffer_load_dword v10, v14, s[8:11], s36 offen
    v_mov_b32 v120, 163616
    v_mov_b32 v121, 1
    s_cmp_lt_u32 s3, 4
    s_cbranch_scc1 K2_CADDR
    s_branch K2_NOC
K2_CADDR:
    s_and_b32 s40, s3, 1
    s_lshr_b32 s41, s3, 1
    v_lshrrev_b32 v112, 4, v0
    v_bfe_u32 v113, v0, 2, 2
    v_and_b32 v114, 3, v0
    v_lshrrev_b32 v115, 1, v112
    v_lshlrev_b32 v115, 4, v115
    v_and_b32 v116, 1, v112
    v_lshl_add_u32 v117, v116, 2, v113
    v_add_u32 v118, v115, v117
    v_and_b32 v117, 6, v117
    s_lshl_b32 s46, s40, 2
    v_xor_b32 v117, s46, v117
    v_lshrrev_b32 v119, 1, v114
    v_add_u32 v117, v117, v119
    v_lshlrev_b32 v117, 4, v117
    v_lshl_add_u32 v117, v118, 7, v117
    v_and_b32 v119, 1, v114
    v_lshl_add_u32 v128, v119, 3, v117
    v_xor_b32 v129, 32, v128
    v_and_b32 v117, 15, v0
    v_and_b32 v118, 3, v0
    v_xor_b32 v118, v112, v118
    v_lshlrev_b32 v118, 4, v118
    v_bfe_u32 v119, v0, 2, 1
    v_lshl_add_u32 v118, v119, 6, v118
    v_lshl_add_u32 v118, v117, 7, v118
    s_mul_i32 s46, s41, 6144
    s_add_u32 s46, s46, 8192
    v_add_u32 v130, s46, v118
    v_xor_b32 v131, 64, v130
    s_lshl_b32 s46, s40, 9
    v_lshlrev_b32 v118, 4, v117
    v_lshl_add_u32 v118, v112, 10, v118
    v_add_u32 v132, s46, v118
    v_lshl_add_u32 v115, v116, 3, v115
    v_lshl_add_u32 v115, v113, 1, v115
    v_mul_u32_u24 v115, 144, v115
    v_lshl_add_u32 v115, v114, 3, v115
    s_mul_i32 s46, s41, 96
    s_add_u32 s46, s46, 69632
    v_add_u32 v133, s46, v115
    s_lshl_b32 s46, s4, 6
    s_lshl_b32 s47, s40, 5
    s_add_u32 s46, s46, s47
    v_add_u32 v118, s46, v117
    v_lshlrev_b32 v137, 2, v118
    v_add_u32 v117, s47, v117
    v_mul_u32_u24 v117, 304, v117
    v_lshl_add_u32 v117, v112, 4, v117
    s_mul_i32 s46, s41, 192
    s_add_u32 s46, s46, 0
    v_add_u32 v134, s46, v117
    s_mov_b32 s36, 12525568
    buffer_load_dword v135, v137, s[8:11], s36 offen
    buffer_load_dword v136, v137, s[8:11], s36 offen offset:64
K2_NOC:
    s_lshr_b32 s36, s5, 1
    s_lshl_b32 s36, s36, 10
    s_and_b32 s37, s2, 7
    s_lshl_b32 s37, s37, 7
    s_add_u32 s36, s36, s37
    s_add_u32 s38, s36, 16240640
    v_mov_b32 v9, 0
    v_mov_b32 v97, 0
    v_mov_b32 v101, 0
    v_mov_b32 v64, 0
    v_mov_b32 v65, 0
    v_mov_b32 v66, 0
    v_mov_b32 v67, 0
    v_mov_b32 v68, 0
    v_mov_b32 v69, 0
    v_mov_b32 v70, 0
    v_mov_b32 v71, 0
    v_mov_b32 v72, 0
    v_mov_b32 v73, 0
    v_mov_b32 v74, 0
    v_mov_b32 v75, 0
    v_mov_b32 v76, 0
    v_mov_b32 v77, 0
    v_mov_b32 v78, 0
    v_mov_b32 v79, 0
    s_waitcnt vmcnt(0)
    v_cmp_gt_u32 vcc, 32, v0
    s_nop 1
    v_cndmask_b32 v8, 0, v8, vcc
    s_barrier
    ds_read_b128 v[88:91], v1
    ds_read_b32 v96, v2
    s_waitcnt lgkmcnt(0)
    v_mfma_f32_32x32x16_bf16 v[32:47], v[88:91], v[4:7], 0
    v_mfma_f32_32x32x8_bf16 v[32:47], v[96:97], v[8:9], v[32:47]
    ds_read_b128 v[92:95], v1 offset:2368
    ds_read_b32 v100, v2 offset:2368
    ds_read_b128 v[104:107], v3
    ds_read_b128 v[108:111], v3 offset:608
    s_mov_b32 s21, 0
    s_nop 6
    s_cmp_ge_u32 s3, 4
    s_cbranch_scc1 K2B_LOOP
K2A_LOOP:
    s_sub_u32 s34, s21, 1
    s_cmp_lt_u32 s34, 2
    s_cbranch_scc0 K2A_NOB
    s_barrier
K2A_NOB:
    s_waitcnt lgkmcnt(2)
    v_mfma_f32_32x32x16_bf16 v[48:63], v[92:95], v[4:7], 0
    v_exp_f32 v32, v32
    v_exp_f32 v33, v33
    v_exp_f32 v34, v34
    v_exp_f32 v35, v35
    v_exp_f32 v36, v36
    v_exp_f32 v37, v37
    v_exp_f32 v38, v38
    v_exp_f32 v39, v39
    v_mfma_f32_32x32x8_bf16 v[48:63], v[100:101], v[8:9], v[48:63]
    v_cvt_pk_bf16_f32 v80, v32, v33
    v_cvt_pk_bf16_f32 v81, v34, v35
    v_cvt_pk_bf16_f32 v82, v36, v37
    v_cvt_pk_bf16_f32 v83, v38, v39
    ds_read_b128 v[88:91], v1 offset:4736
    ds_read_b32 v96, v2 offset:4736
    s_waitcnt lgkmcnt(3)
    v_mfma_f32_32x32x16_bf16 v[64:79], v[104:107], v[80:83], v[64:79]
    v_exp_f32 v40, v40
    v_exp_f32 v41, v41
    v_exp_f32 v42, v42
    v_exp_f32 v43, v43
    v_exp_f32 v44, v44
    v_exp_f32 v45, v45
    v_exp_f32 v46, v46
    v_exp_f32 v47, v47
    v_cvt_pk_bf16_f32 v84, v40, v41
    v_cvt_pk_bf16_f32 v85, v42, v43
    v_cvt_pk_bf16_f32 v86, v44, v45
    v_cvt_pk_bf16_f32 v87, v46, v47
    ds_read_b128 v[104:107], v3 offset:2368
    s_waitcnt lgkmcnt(3)
    v_mfma_f32_32x32x16_bf16 v[64:79], v[108:111], v[84:87], v[64:79]
    ds_read_b128 v[108:111], v3 offset:2976
    s_waitcnt lgkmcnt(2)
    v_mfma_f32_32x32x16_bf16 v[32:47], v[88:91], v[4:7], 0
    v_exp_f32 v48, v48
    v_exp_f32 v49, v49
    v_exp_f32 v50, v50
    v_exp_f32 v51, v51
    v_exp_f32 v52, v52
    v_exp_f32 v53, v53
    v_exp_f32 v54, v54
    v_exp_f32 v55, v55
    v_mfma_f32_32x32x8_bf16 v[32:47], v[96:97], v[8:9], v[32:47]
    v_cvt_pk_bf16_f32 v80, v48, v49
    v_cvt_pk_bf16_f32 v81, v50, v51
    v_cvt_pk_bf16_f32 v82, v52, v53
    v_cvt_pk_bf16_f32 v83, v54, v55
    ds_read_b128 v[92:95], v1 offset:7104
    ds_read_b32 v100, v2 offset:7104
    s_waitcnt lgkmcnt(3)
    v_mfma_f32_32x32x16_bf16 v[64:79], v[104:107], v[80:83], v[64:79]
    v_exp_f32 v56, v56
    v_exp_f32 v57, v57
    v_exp_f32 v58, v58
    v_exp_f32 v59, v59
    v_exp_f32 v60, v60
    v_exp_f32 v61, v61
    v_exp_f32 v62, v62
    v_exp_f32 v63, v63
    v_cvt_pk_bf16_f32 v84, v56, v57
    v_cvt_pk_bf16_f32 v85, v58, v59
    v_cvt_pk_bf16_f32 v86, v60, v61
    v_cvt_pk_bf16_f32 v87, v62, v63
    ds_read_b128 v[104:107], v3 offset:4736
    s_waitcnt lgkmcnt(3)
    v_mfma_f32_32x32x16_bf16 v[64:79], v[108:111], v[84:87], v[64:79]
    ds_read_b128 v[108:111], v3 offset:5344
    s_waitcnt lgkmcnt(2)
    v_mfma_f32_32x32x16_bf16 v[48:63], v[92:95], v[4:7], 0
    v_exp_f32 v32, v32
    v_exp_f32 v33, v33
    v_exp_f32 v34, v34
    v_exp_f32 v35, v35
    v_exp_f32 v36, v36
    v_exp_f32 v37, v37
    v_exp_f32 v38, v38
    v_exp_f32 v39, v39
    v_mfma_f32_32x32x8_bf16 v[48:63], v[100:101], v[8:9], v[48:63]
    v_cvt_pk_bf16_f32 v80, v32, v33
    v_cvt_pk_bf16_f32 v81, v34, v35
    v_cvt_pk_bf16_f32 v82, v36, v37
    v_cvt_pk_bf16_f32 v83, v38, v39
    ds_read_b128 v[88:91], v1 offset:9472
    ds_read_b32 v96, v2 offset:9472
    s_waitcnt lgkmcnt(3)
    v_mfma_f32_32x32x16_bf16 v[64:79], v[104:107], v[80:83], v[64:79]
    v_exp_f32 v40, v40
    v_exp_f32 v41, v41
    v_exp_f32 v42, v42
    v_exp_f32 v43, v43
    v_exp_f32 v44, v44
    v_exp_f32 v45, v45
    v_exp_f32 v46, v46
    v_exp_f32 v47, v47
    v_cvt_pk_bf16_f32 v84, v40, v41
    v_cvt_pk_bf16_f32 v85, v42, v43
    v_cvt_pk_bf16_f32 v86, v44, v45
    v_cvt_pk_bf16_f32 v87, v46, v47
    ds_read_b128 v[104:107], v3 offset:7104
    s_waitcnt lgkmcnt(3)
    v_mfma_f32_32x32x16_bf16 v[64:79], v[108:111], v[84:87], v[64:79]
    ds_read_b128 v[108:111], v3 offset:7712
    s_waitcnt lgkmcnt(2)
    v_mfma_f32_32x32x16_bf16 v[32:47], v[88:91], v[4:7], 0
    v_exp_f32 v48, v48
    v_exp_f32 v49, v49
    v_exp_f32 v50, v50
    v_exp_f32 v51, v51
    v_exp_f32 v52, v52
    v_exp_f32 v53, v53
    v_exp_f32 v54, v54
    v_exp_f32 v55, v55
    v_mfma_f32_32x32x8_bf16 v[32:47], v[96:97], v[8:9], v[32:47]
    v_cvt_pk_bf16_f32 v80, v48, v49
    v_cvt_pk_bf16_f32 v81, v50, v51
    v_cvt_pk_bf16_f32 v82, v52, v53
    v_cvt_pk_bf16_f32 v83, v54, v55
    ds_read_b128 v[92:95], v1 offset:11840
    ds_read_b32 v100, v2 offset:11840
    s_waitcnt lgkmcnt(3)
    v_mfma_f32_32x32x16_bf16 v[64:79], v[104:107], v[80:83], v[64:79]
    v_exp_f32 v56, v56
    v_exp_f32 v57, v57
    v_exp_f32 v58, v58
    v_exp_f32 v59, v59
    v_exp_f32 v60, v60
    v_exp_f32 v61, v61
    v_exp_f32 v62, v62
    v_exp_f32 v63, v63
    v_cvt_pk_bf16_f32 v84, v56, v57
    v_cvt_pk_bf16_f32 v85, v58, v59
    v_cvt_pk_bf16_f32 v86, v60, v61
    v_cvt_pk_bf16_f32 v87, v62, v63
    ds_read_b128 v[104:107], v3 offset:9472
    s_waitcnt lgkmcnt(3)
    v_mfma_f32_32x32x16_bf16 v[64:79], v[108:111], v[84:87], v[64:79]
    ds_read_b128 v[108:111], v3 offset:10080
    s_waitcnt lgkmcnt(2)
    v_mfma_f32_32x32x16_bf16 v[48:63], v[92:95], v[4:7], 0
    v_exp_f32 v32, v32
    v_exp_f32 v33, v33
    v_exp_f32 v34, v34
    v_exp_f32 v35, v35
    v_exp_f32 v36, v36
    v_exp_f32 v37, v37
    v_exp_f32 v38, v38
    v_exp_f32 v39, v39
    v_mfma_f32_32x32x8_bf16 v[48:63], v[100:101], v[8:9], v[48:63]
    v_cvt_pk_bf16_f32 v80, v32, v33
    v_cvt_pk_bf16_f32 v81, v34, v35
    v_cvt_pk_bf16_f32 v82, v36, v37
    v_cvt_pk_bf16_f32 v83, v38, v39
    ds_read_b128 v[88:91], v1 offset:14208
    ds_read_b32 v96, v2 offset:14208
    s_waitcnt lgkmcnt(3)
    v_mfma_f32_32x32x16_bf16 v[64:79], v[104:107], v[80:83], v[64:79]
    v_exp_f32 v40, v40
    v_exp_f32 v41, v41
    v_exp_f32 v42, v42
    v_exp_f32 v43, v43
    v_exp_f32 v44, v44
    v_exp_f32 v45, v45
    v_exp_f32 v46, v46
    v_exp_f32 v47, v47
    v_cvt_pk_bf16_f32 v84, v40, v41
    v_cvt_pk_bf16_f32 v85, v42, v43
    v_cvt_pk_bf16_f32 v86, v44, v45
    v_cvt_pk_bf16_f32 v87, v46, v47
    ds_read_b128 v[104:107], v3 offset:11840
    s_waitcnt lgkmcnt(3)
    v_mfma_f32_32x32x16_bf16 v[64:79], v[108:111], v[84:87], v[64:79]
    ds_read_b128 v[108:111], v3 offset:12448
    s_waitcnt lgkmcnt(2)
    v_mfma_f32_32x32x16_bf16 v[32:47], v[88:91], v[4:7], 0
    v_exp_f32 v48, v48
    v_exp_f32 v49, v49
    v_exp_f32 v50, v50
    v_exp_f32 v51, v51
    v_exp_f32 v52, v52
    v_exp_f32 v53, v53
    v_exp_f32 v54, v54
    v_exp_f32 v55, v55
    v_mfma_f32_32x32x8_bf16 v[32:47], v[96:97], v[8:9], v[32:47]
    v_cvt_pk_bf16_f32 v80, v48, v49
    v_cvt_pk_bf16_f32 v81, v50, v51
    v_cvt_pk_bf16_f32 v82, v52, v53
    v_cvt_pk_bf16_f32 v83, v54, v55
    ds_read_b128 v[92:95], v1 offset:16576
    ds_read_b32 v100, v2 offset:16576
    s_waitcnt lgkmcnt(3)
    v_mfma_f32_32x32x16_bf16 v[64:79], v[104:107], v[80:83], v[64:79]
    v_exp_f32 v56, v56
    v_exp_f32 v57, v57
    v_exp_f32 v58, v58
    v_exp_f32 v59, v59
    v_exp_f32 v60, v60
    v_exp_f32 v61, v61
    v_exp_f32 v62, v62
    v_exp_f32 v63, v63
    v_cvt_pk_bf16_f32 v84, v56, v57
    v_cvt_pk_bf16_f32 v85, v58, v59
    v_cvt_pk_bf16_f32 v86, v60, v61
    v_cvt_pk_bf16_f32 v87, v62, v63
    ds_read_b128 v[104:107], v3 offset:14208
    s_waitcnt lgkmcnt(3)
    v_mfma_f32_32x32x16_bf16 v[64:79], v[108:111], v[84:87], v[64:79]
    ds_read_b128 v[108:111], v3 offset:14816
    s_waitcnt lgkmcnt(2)
    v_mfma_f32_32x32x16_bf16 v[48:63], v[92:95], v[4:7], 0
    v_exp_f32 v32, v32
    v_exp_f32 v33, v33
    v_exp_f32 v34, v34
    v_exp_f32 v35, v35
    v_exp_f32 v36, v36
    v_exp_f32 v37, v37
    v_exp_f32 v38, v38
    v_exp_f32 v39, v39
    v_mfma_f32_32x32x8_bf16 v[48:63], v[100:101], v[8:9], v[48:63]
    v_cvt_pk_bf16_f32 v80, v32, v33
    v_cvt_pk_bf16_f32 v81, v34, v35
    v_cvt_pk_bf16_f32 v82, v36, v37
    v_cvt_pk_bf16_f32 v83, v38, v39
    ds_read_b128 v[88:91], v1 offset:18944
    ds_read_b32 v96, v2 offset:18944
    s_waitcnt lgkmcnt(3)
    v_mfma_f32_32x32x16_bf16 v[64:79], v[104:107], v[80:83], v[64:79]
    v_exp_f32 v40, v40
    v_exp_f32 v41, v41
    v_exp_f32 v42, v42
    v_exp_f32 v43, v43
    v_exp_f32 v44, v44
    v_exp_f32 v45, v45
    v_exp_f32 v46, v46
    v_exp_f32 v47, v47
    v_cvt_pk_bf16_f32 v84, v40, v41
    v_cvt_pk_bf16_f32 v85, v42, v43
    v_cvt_pk_bf16_f32 v86, v44, v45
    v_cvt_pk_bf16_f32 v87, v46, v47
    ds_read_b128 v[104:107], v3 offset:16576
    s_waitcnt lgkmcnt(3)
    v_mfma_f32_32x32x16_bf16 v[64:79], v[108:111], v[84:87], v[64:79]
    ds_read_b128 v[108:111], v3 offset:17184
    s_waitcnt lgkmcnt(2)
    v_mfma_f32_32x32x16_bf16 v[32:47], v[88:91], v[4:7], 0
    v_exp_f32 v48, v48
    v_exp_f32 v49, v49
    v_exp_f32 v50, v50
    v_exp_f32 v51, v51
    v_exp_f32 v52, v52
    v_exp_f32 v53, v53
    v_exp_f32 v54, v54
    v_exp_f32 v55, v55
    v_mfma_f32_32x32x8_bf16 v[32:47], v[96:97], v[8:9], v[32:47]
    v_cvt_pk_bf16_f32 v80, v48, v49
    v_cvt_pk_bf16_f32 v81, v50, v51
    v_cvt_pk_bf16_f32 v82, v52, v53
    v_cvt_pk_bf16_f32 v83, v54, v55
    ds_read_b128 v[92:95], v1 offset:21312
    ds_read_b32 v100, v2 offset:21312
    s_waitcnt lgkmcnt(3)
    v_mfma_f32_32x32x16_bf16 v[64:79], v[104:107], v[80:83], v[64:79]
    v_exp_f32 v56, v56
    v_exp_f32 v57, v57
    v_exp_f32 v58, v58
    v_exp_f32 v59, v59
    v_exp_f32 v60, v60
    v_exp_f32 v61, v61
    v_exp_f32 v62, v62
    v_exp_f32 v63, v63
    v_cvt_pk_bf16_f32 v84, v56, v57
    v_cvt_pk_bf16_f32 v85, v58, v59
    v_cvt_pk_bf16_f32 v86, v60, v61
    v_cvt_pk_bf16_f32 v87, v62, v63
    ds_read_b128 v[104:107], v3 offset:18944
    s_waitcnt lgkmcnt(3)
    v_mfma_f32_32x32x16_bf16 v[64:79], v[108:111], v[84:87], v[64:79]
    ds_read_b128 v[108:111], v3 offset:19552
    v_add_u32 v1, 18944, v1
    v_add_u32 v2, 18944, v2
    v_add_u32 v3, 18944, v3
    s_add_u32 s21, s21, 1
    s_mov_b64 exec, 1
    ds_add_u32 v120, v121
    s_mov_b64 exec, -1
    v_add_u32 v120, 4, v120
    s_cmp_lt_u32 s21, 8
    s_cbranch_scc1 K2A_LOOP
    s_branch K2_DONE
K2B_LOOP:
    s_sub_u32 s34, s21, 1
    s_cmp_lt_u32 s34, 2
    s_cbranch_scc0 K2B_NOB
    s_barrier
K2B_NOB:
    s_setprio 1
    s_waitcnt lgkmcnt(2)
    v_mfma_f32_32x32x16_bf16 v[48:63], v[92:95], v[4:7], 0
    v_exp_f32 v32, v32
    v_exp_f32 v33, v33
    v_exp_f32 v34, v34
    v_exp_f32 v35, v35
    v_exp_f32 v36, v36
    v_exp_f32 v37, v37
    v_exp_f32 v38, v38
    v_exp_f32 v39, v39
    v_mfma_f32_32x32x8_bf16 v[48:63], v[100:101], v[8:9], v[48:63]
    v_cvt_pk_bf16_f32 v80, v32, v33
    v_cvt_pk_bf16_f32 v81, v34, v35
    v_cvt_pk_bf16_f32 v82, v36, v37
    v_cvt_pk_bf16_f32 v83, v38, v39
    ds_read_b128 v[88:91], v1 offset:4736
    ds_read_b32 v96, v2 offset:4736
    s_waitcnt lgkmcnt(3)
    v_mfma_f32_32x32x16_bf16 v[64:79], v[104:107], v[80:83], v[64:79]
    v_exp_f32 v40, v40
    v_exp_f32 v41, v41
    v_exp_f32 v42, v42
    v_exp_f32 v43, v43
    v_exp_f32 v44, v44
    v_exp_f32 v45, v45
    v_exp_f32 v46, v46
    v_exp_f32 v47, v47
    v_cvt_pk_bf16_f32 v84, v40, v41
    v_cvt_pk_bf16_f32 v85, v42, v43
    v_cvt_pk_bf16_f32 v86, v44, v45
    v_cvt_pk_bf16_f32 v87, v46, v47
    ds_read_b128 v[104:107], v3 offset:2368
    s_waitcnt lgkmcnt(3)
    v_mfma_f32_32x32x16_bf16 v[64:79], v[108:111], v[84:87], v[64:79]
    ds_read_b128 v[108:111], v3 offset:2976
    s_waitcnt lgkmcnt(2)
    v_mfma_f32_32x32x16_bf16 v[32:47], v[88:91], v[4:7], 0
    v_exp_f32 v48, v48
    v_exp_f32 v49, v49
    v_exp_f32 v50, v50
    v_exp_f32 v51, v51
    v_exp_f32 v52, v52
    v_exp_f32 v53, v53
    v_exp_f32 v54, v54
    v_exp_f32 v55, v55
    v_mfma_f32_32x32x8_bf16 v[32:47], v[96:97], v[8:9], v[32:47]
    v_cvt_pk_bf16_f32 v80, v48, v49
    v_cvt_pk_bf16_f32 v81, v50, v51
    v_cvt_pk_bf16_f32 v82, v52, v53
    v_cvt_pk_bf16_f32 v83, v54, v55
    ds_read_b128 v[92:95], v1 offset:7104
    ds_read_b32 v100, v2 offset:7104
    s_waitcnt lgkmcnt(3)
    v_mfma_f32_32x32x16_bf16 v[64:79], v[104:107], v[80:83], v[64:79]
    v_exp_f32 v56, v56
    v_exp_f32 v57, v57
    v_exp_f32 v58, v58
    v_exp_f32 v59, v59
    v_exp_f32 v60, v60
    v_exp_f32 v61, v61
    v_exp_f32 v62, v62
    v_exp_f32 v63, v63
    v_cvt_pk_bf16_f32 v84, v56, v57
    v_cvt_pk_bf16_f32 v85, v58, v59
    v_cvt_pk_bf16_f32 v86, v60, v61
    v_cvt_pk_bf16_f32 v87, v62, v63
    ds_read_b128 v[104:107], v3 offset:4736
    s_waitcnt lgkmcnt(3)
    v_mfma_f32_32x32x16_bf16 v[64:79], v[108:111], v[84:87], v[64:79]
    ds_read_b128 v[108:111], v3 offset:5344
    s_waitcnt lgkmcnt(2)
    v_mfma_f32_32x32x16_bf16 v[48:63], v[92:95], v[4:7], 0
    v_exp_f32 v32, v32
    v_exp_f32 v33, v33
    v_exp_f32 v34, v34
    v_exp_f32 v35, v35
    v_exp_f32 v36, v36
    v_exp_f32 v37, v37
    v_exp_f32 v38, v38
    v_exp_f32 v39, v39
    v_mfma_f32_32x32x8_bf16 v[48:63], v[100:101], v[8:9], v[48:63]
    v_cvt_pk_bf16_f32 v80, v32, v33
    v_cvt_pk_bf16_f32 v81, v34, v35
    v_cvt_pk_bf16_f32 v82, v36, v37
    v_cvt_pk_bf16_f32 v83, v38, v39
    ds_read_b128 v[88:91], v1 offset:9472
    ds_read_b32 v96, v2 offset:9472
    s_waitcnt lgkmcnt(3)
    v_mfma_f32_32x32x16_bf16 v[64:79], v[104:107], v[80:83], v[64:79]
    v_exp_f32 v40, v40
    v_exp_f32 v41, v41
    v_exp_f32 v42, v42
    v_exp_f32 v43, v43
    v_exp_f32 v44, v44
    v_exp_f32 v45, v45
    v_exp_f32 v46, v46
    v_exp_f32 v47, v47
    v_cvt_pk_bf16_f32 v84, v40, v41
    v_cvt_pk_bf16_f32 v85, v42, v43
    v_cvt_pk_bf16_f32 v86, v44, v45
    v_cvt_pk_bf16_f32 v87, v46, v47
    ds_read_b128 v[104:107], v3 offset:7104
    s_waitcnt lgkmcnt(3)
    v_mfma_f32_32x32x16_bf16 v[64:79], v[108:111], v[84:87], v[64:79]
    ds_read_b128 v[108:111], v3 offset:7712
    s_setprio 0
    s_waitcnt lgkmcnt(2)
    v_mfma_f32_32x32x16_bf16 v[32:47], v[88:91], v[4:7], 0
    v_exp_f32 v48, v48
    v_exp_f32 v49, v49
    v_exp_f32 v50, v50
    v_exp_f32 v51, v51
    v_exp_f32 v52, v52
    v_exp_f32 v53, v53
    v_exp_f32 v54, v54
    v_exp_f32 v55, v55
    v_mfma_f32_32x32x8_bf16 v[32:47], v[96:97], v[8:9], v[32:47]
    v_cvt_pk_bf16_f32 v80, v48, v49
    v_cvt_pk_bf16_f32 v81, v50, v51
    v_cvt_pk_bf16_f32 v82, v52, v53
    v_cvt_pk_bf16_f32 v83, v54, v55
    ds_read_b128 v[92:95], v1 offset:11840
    ds_read_b32 v100, v2 offset:11840
    s_waitcnt lgkmcnt(3)
    v_mfma_f32_32x32x16_bf16 v[64:79], v[104:107], v[80:83], v[64:79]
    v_exp_f32 v56, v56
    v_exp_f32 v57, v57
    v_exp_f32 v58, v58
    v_exp_f32 v59, v59
    v_exp_f32 v60, v60
    v_exp_f32 v61, v61
    v_exp_f32 v62, v62
    v_exp_f32 v63, v63
    v_cvt_pk_bf16_f32 v84, v56, v57
    v_cvt_pk_bf16_f32 v85, v58, v59
    v_cvt_pk_bf16_f32 v86, v60, v61
    v_cvt_pk_bf16_f32 v87, v62, v63
    ds_read_b128 v[104:107], v3 offset:9472
    s_waitcnt lgkmcnt(3)
    v_mfma_f32_32x32x16_bf16 v[64:79], v[108:111], v[84:87], v[64:79]
    ds_read_b128 v[108:111], v3 offset:10080
    s_setprio 1
    s_waitcnt lgkmcnt(2)
    v_mfma_f32_32x32x16_bf16 v[48:63], v[92:95], v[4:7], 0
    v_exp_f32 v32, v32
    v_exp_f32 v33, v33
    v_exp_f32 v34, v34
    v_exp_f32 v35, v35
    v_exp_f32 v36, v36
    v_exp_f32 v37, v37
    v_exp_f32 v38, v38
    v_exp_f32 v39, v39
    v_mfma_f32_32x32x8_bf16 v[48:63], v[100:101], v[8:9], v[48:63]
    v_cvt_pk_bf16_f32 v80, v32, v33
    v_cvt_pk_bf16_f32 v81, v34, v35
    v_cvt_pk_bf16_f32 v82, v36, v37
    v_cvt_pk_bf16_f32 v83, v38, v39
    ds_read_b128 v[88:91], v1 offset:14208
    ds_read_b32 v96, v2 offset:14208
    s_waitcnt lgkmcnt(3)
    v_mfma_f32_32x32x16_bf16 v[64:79], v[104:107], v[80:83], v[64:79]
    v_exp_f32 v40, v40
    v_exp_f32 v41, v41
    v_exp_f32 v42, v42
    v_exp_f32 v43, v43
    v_exp_f32 v44, v44
    v_exp_f32 v45, v45
    v_exp_f32 v46, v46
    v_exp_f32 v47, v47
    v_cvt_pk_bf16_f32 v84, v40, v41
    v_cvt_pk_bf16_f32 v85, v42, v43
    v_cvt_pk_bf16_f32 v86, v44, v45
    v_cvt_pk_bf16_f32 v87, v46, v47
    ds_read_b128 v[104:107], v3 offset:11840
    s_waitcnt lgkmcnt(3)
    v_mfma_f32_32x32x16_bf16 v[64:79], v[108:111], v[84:87], v[64:79]
    ds_read_b128 v[108:111], v3 offset:12448
    s_waitcnt lgkmcnt(2)
    v_mfma_f32_32x32x16_bf16 v[32:47], v[88:91], v[4:7], 0
    v_exp_f32 v48, v48
    v_exp_f32 v49, v49
    v_exp_f32 v50, v50
    v_exp_f32 v51, v51
    v_exp_f32 v52, v52
    v_exp_f32 v53, v53
    v_exp_f32 v54, v54
    v_exp_f32 v55, v55
    v_mfma_f32_32x32x8_bf16 v[32:47], v[96:97], v[8:9], v[32:47]
    v_cvt_pk_bf16_f32 v80, v48, v49
    v_cvt_pk_bf16_f32 v81, v50, v51
    v_cvt_pk_bf16_f32 v82, v52, v53
    v_cvt_pk_bf16_f32 v83, v54, v55
    ds_read_b128 v[92:95], v1 offset:16576
    ds_read_b32 v100, v2 offset:16576
    s_waitcnt lgkmcnt(3)
    v_mfma_f32_32x32x16_bf16 v[64:79], v[104:107], v[80:83], v[64:79]
    v_exp_f32 v56, v56
    v_exp_f32 v57, v57
    v_exp_f32 v58, v58
    v_exp_f32 v59, v59
    v_exp_f32 v60, v60
    v_exp_f32 v61, v61
    v_exp_f32 v62, v62
    v_exp_f32 v63, v63
    v_cvt_pk_bf16_f32 v84, v56, v57
    v_cvt_pk_bf16_f32 v85, v58, v59
    v_cvt_pk_bf16_f32 v86, v60, v61
    v_cvt_pk_bf16_f32 v87, v62, v63
    ds_read_b128 v[104:107], v3 offset:14208
    s_waitcnt lgkmcnt(3)
    v_mfma_f32_32x32x16_bf16 v[64:79], v[108:111], v[84:87], v[64:79]
    ds_read_b128 v[108:111], v3 offset:14816
    s_waitcnt lgkmcnt(2)
    v_mfma_f32_32x32x16_bf16 v[48:63], v[92:95], v[4:7], 0
    v_exp_f32 v32, v32
    v_exp_f32 v33, v33
    v_exp_f32 v34, v34
    v_exp_f32 v35, v35
    v_exp_f32 v36, v36
    v_exp_f32 v37, v37
    v_exp_f32 v38, v38
    v_exp_f32 v39, v39
    v_mfma_f32_32x32x8_bf16 v[48:63], v[100:101], v[8:9], v[48:63]
    v_cvt_pk_bf16_f32 v80, v32, v33
    v_cvt_pk_bf16_f32 v81, v34, v35
    v_cvt_pk_bf16_f32 v82, v36, v37
    v_cvt_pk_bf16_f32 v83, v38, v39
    ds_read_b128 v[88:91], v1 offset:18944
    ds_read_b32 v96, v2 offset:18944
    s_waitcnt lgkmcnt(3)
    v_mfma_f32_32x32x16_bf16 v[64:79], v[104:107], v[80:83], v[64:79]
    v_exp_f32 v40, v40
    v_exp_f32 v41, v41
    v_exp_f32 v42, v42
    v_exp_f32 v43, v43
    v_exp_f32 v44, v44
    v_exp_f32 v45, v45
    v_exp_f32 v46, v46
    v_exp_f32 v47, v47
    v_cvt_pk_bf16_f32 v84, v40, v41
    v_cvt_pk_bf16_f32 v85, v42, v43
    v_cvt_pk_bf16_f32 v86, v44, v45
    v_cvt_pk_bf16_f32 v87, v46, v47
    ds_read_b128 v[104:107], v3 offset:16576
    s_waitcnt lgkmcnt(3)
    v_mfma_f32_32x32x16_bf16 v[64:79], v[108:111], v[84:87], v[64:79]
    ds_read_b128 v[108:111], v3 offset:17184
    s_setprio 0
    s_waitcnt lgkmcnt(2)
    v_mfma_f32_32x32x16_bf16 v[32:47], v[88:91], v[4:7], 0
    v_exp_f32 v48, v48
    v_exp_f32 v49, v49
    v_exp_f32 v50, v50
    v_exp_f32 v51, v51
    v_exp_f32 v52, v52
    v_exp_f32 v53, v53
    v_exp_f32 v54, v54
    v_exp_f32 v55, v55
    v_mfma_f32_32x32x8_bf16 v[32:47], v[96:97], v[8:9], v[32:47]
    v_cvt_pk_bf16_f32 v80, v48, v49
    v_cvt_pk_bf16_f32 v81, v50, v51
    v_cvt_pk_bf16_f32 v82, v52, v53
    v_cvt_pk_bf16_f32 v83, v54, v55
    ds_read_b128 v[92:95], v1 offset:21312
    ds_read_b32 v100, v2 offset:21312
    s_waitcnt lgkmcnt(3)
    v_mfma_f32_32x32x16_bf16 v[64:79], v[104:107], v[80:83], v[64:79]
    v_exp_f32 v56, v56
    v_exp_f32 v57, v57
    v_exp_f32 v58, v58
    v_exp_f32 v59, v59
    v_exp_f32 v60, v60
    v_exp_f32 v61, v61
    v_exp_f32 v62, v62
    v_exp_f32 v63, v63
    v_cvt_pk_bf16_f32 v84, v56, v57
    v_cvt_pk_bf16_f32 v85, v58, v59
    v_cvt_pk_bf16_f32 v86, v60, v61
    v_cvt_pk_bf16_f32 v87, v62, v63
    ds_read_b128 v[104:107], v3 offset:18944
    s_waitcnt lgkmcnt(3)
    v_mfma_f32_32x32x16_bf16 v[64:79], v[108:111], v[84:87], v[64:79]
    ds_read_b128 v[108:111], v3 offset:19552
    v_add_u32 v1, 18944, v1
    v_add_u32 v2, 18944, v2
    v_add_u32 v3, 18944, v3
    s_add_u32 s21, s21, 1
    s_mov_b64 exec, 1
    ds_add_u32 v120, v121
    s_mov_b64 exec, -1
    v_add_u32 v120, 4, v120
    s_cmp_lt_u32 s21, 8
    s_cbranch_scc1 K2B_LOOP
K2_DONE:
    s_waitcnt lgkmcnt(0)
    s_nop 10
    v_mov_b32 v12, v74
    v_mov_b32 v13, v74
    s_nop 1
    v_permlane32_swap_b32 v12, v13
    v_max3_f32 v14, |v64|, |v65|, |v66|
    v_max3_f32 v14, v14, |v67|, |v68|
    v_max3_f32 v14, v14, |v69|, |v70|
    v_max3_f32 v14, v14, |v71|, |v72|
    v_max_f32_e64 v14, v14, |v73|
    s_mov_b32 s34, 0x17800000
    s_mov_b32 s35, 0x76800000
    s_mov_b32 s36, 0x7e800000
    v_cmp_le_f32 vcc, s34, v12
    v_cmp_ge_f32 s[28:29], s35, v12
    s_and_b64 vcc, vcc, s[28:29]
    v_cmp_ge_f32 s[28:29], s36, v14
    s_and_b64 vcc, vcc, s[28:29]
    s_cmp_eq_u64 vcc, -1
    s_cbranch_scc0 K2_FB
K2_OUT:
    v_rcp_f32 v12, v12
    v_sub_f32 v13, 1.0, v10
    v_mul_f32 v12, v12, v13
    v_mul_f32 v64, v64, v12
    v_mul_f32 v65, v65, v12
    v_mul_f32 v66, v66, v12
    v_mul_f32 v67, v67, v12
    v_mul_f32 v68, v68, v12
    v_mul_f32 v69, v69, v12
    v_mul_f32 v70, v70, v12
    v_mul_f32 v71, v71, v12
    v_mul_f32 v72, v72, v12
    v_mul_f32 v73, v73, v12
    v_cvt_pk_bf16_f32 v80, v64, v65
    v_cvt_pk_bf16_f32 v81, v66, v67
    v_cvt_pk_bf16_f32 v82, v68, v69
    v_cvt_pk_bf16_f32 v83, v70, v71
    v_cvt_pk_bf16_f32 v84, v72, v73
    s_lshr_b32 s6, s5, 1
    s_mul_i32 s6, s6, 73728
    s_and_b32 s7, s5, 1
    s_lshl_b32 s7, s7, 9
    s_add_u32 s6, s6, s7
    s_add_u32 s6, s6, 13871104
    s_lshr_b32 s7, s4, 2
    s_and_b32 s34, s4, 3
    s_lshl_b32 s35, s7, 13
    s_lshl_b32 s36, s34, 11
    s_add_u32 s35, s35, s36
    s_add_u32 s35, s35, s6
    v_and_b32 v2, 31, v0
    v_lshlrev_b32 v2, 4, v2
    v_lshrrev_b32 v1, 5, v0
    v_lshl_add_u32 v1, v1, 10, v2
    buffer_store_dwordx4 v[80:83], v1, s[8:11], s35 offen sc1
    s_lshl_b32 s7, s7, 10
    s_lshl_b32 s34, s34, 2
    s_add_u32 s7, s7, s34
    s_add_u32 s7, s7, s6
    s_add_u32 s7, s7, 65536
    s_mov_b32 exec_hi, 0
    buffer_store_dword v84, v2, s[8:11], s7 offen sc1
    s_mov_b32 exec_hi, -1
    s_cmp_ge_u32 s3, 4
    s_cbranch_scc1 K23_B
    s_cmp_ge_u32 s3, 2
    s_cbranch_scc1 K3_C1
K3_C0:
    v_mov_b32 v16, 0
    v_mov_b32 v17, 0
    v_mov_b32 v18, 0
    v_mov_b32 v19, 0
    v_mov_b32 v20, 0
    v_mov_b32 v21, 0
    v_mov_b32 v22, 0
    v_mov_b32 v23, 0
    v_mov_b32 v24, 0
    v_mov_b32 v25, 0
    v_mov_b32 v26, 0
    v_mov_b32 v27, 0
    v_mov_b32 v28, 0
    v_mov_b32 v29, 0
    v_mov_b32 v30, 0
    v_mov_b32 v31, 0
    v_mov_b32 v32, 0
    v_mov_b32 v33, 0
    v_mov_b32 v34, 0
    v_mov_b32 v35, 0
    v_mov_b32 v36, 0
    v_mov_b32 v37, 0
    v_mov_b32 v38, 0
    v_mov_b32 v39, 0
    v_mov_b32 v8, v128
    v_mov_b32 v9, v129
    v_mov_b32 v10, v130
    v_mov_b32 v11, v131
    s_mov_b32 s21, 17408
    s_lshr_b32 s22, s2, 5
    s_add_u32 s22, s22, s4
    s_mul_i32 s23, s22, 7282
    s_lshr_b32 s23, s23, 16
    s_mul_i32 s23, s23, 9
    s_sub_u32 s22, s22, s23
    s_mul_i32 s22, s22, 9216
    s_barrier
    ds_read_b64_tr_b16 v[48:49], v8 offset:0
    ds_read_b64_tr_b16 v[50:51], v8 offset:1024
    ds_read_b64_tr_b16 v[52:53], v9 offset:0
    ds_read_b64_tr_b16 v[54:55], v9 offset:1024
    ds_read_b128 v[64:67], v10 offset:0
    ds_read_b128 v[68:71], v10 offset:2048
    ds_read_b128 v[72:75], v10 offset:4096
    ds_read_b64_tr_b16 v[56:57], v8 offset:4096
    ds_read_b64_tr_b16 v[58:59], v8 offset:5120
    ds_read_b64_tr_b16 v[60:61], v9 offset:4096
    ds_read_b64_tr_b16 v[62:63], v9 offset:5120
    ds_read_b128 v[76:79], v11 offset:0
    ds_read_b128 v[80:83], v11 offset:2048
    ds_read_b128 v[84:87], v11 offset:4096
    s_mov_b32 s20, 0
    s_mov_b32 s24, 0
K3_C0_Y:
    s_cmp_lg_u32 s24, 0
    s_cbranch_scc1 K3_C0_NS0
    s_cmp_eq_u32 s20, 5
    s_cbranch_scc1 K3_C0_SG0
    s_getreg_b32 s25, hwreg(HW_REG_IB_STS, 0, 4)
    s_cmp_lg_u32 s25, 0
    s_cbranch_scc1 K3_C0_NS0
K3_C0_SG0:
    s_waitcnt vmcnt(0)
    v_mov_b32 v140, 0
    v_mov_b32 v141, 1
    s_mov_b64 exec, 1
    buffer_atomic_add v141, v140, s[8:11], s38 offen sc1
    s_mov_b64 exec, -1
    s_mov_b32 s24, 1
K3_C0_NS0:
    s_waitcnt lgkmcnt(7)
    v_mfma_f32_16x16x32_bf16 v[16:19], v[64:67], v[48:51], v[16:19]
    v_mfma_f32_16x16x32_bf16 v[20:23], v[64:67], v[52:55], v[20:23]
    s_barrier
    v_add_u32 v8, s21, v128
    v_add_u32 v9, s21, v129
    v_add_u32 v10, s21, v130
    v_add_u32 v11, s21, v131
    s_add_u32 s21, s21, 17408
    s_cmp_eq_u32 s21, 69632
    s_cselect_b32 s21, 0, s21
    ds_read_b64_tr_b16 v[88:89], v8 offset:0
    ds_read_b64_tr_b16 v[90:91], v8 offset:1024
    v_mfma_f32_16x16x32_bf16 v[24:27], v[68:71], v[48:51], v[24:27]
    ds_read_b64_tr_b16 v[92:93], v9 offset:0
    ds_read_b64_tr_b16 v[94:95], v9 offset:1024
    v_mfma_f32_16x16x32_bf16 v[28:31], v[68:71], v[52:55], v[28:31]
    ds_read_b128 v[104:107], v10 offset:0
    ds_read_b128 v[108:111], v10 offset:2048
    v_mfma_f32_16x16x32_bf16 v[32:35], v[72:75], v[48:51], v[32:35]
    ds_read_b128 v[112:115], v10 offset:4096
    ds_read_b64_tr_b16 v[96:97], v8 offset:4096
    v_mfma_f32_16x16x32_bf16 v[36:39], v[72:75], v[52:55], v[36:39]
    s_waitcnt lgkmcnt(8)
    ds_read_b64_tr_b16 v[98:99], v8 offset:5120
    ds_read_b64_tr_b16 v[100:101], v9 offset:4096
    v_mfma_f32_16x16x32_bf16 v[16:19], v[76:79], v[56:59], v[16:19]
    ds_read_b64_tr_b16 v[102:103], v9 offset:5120
    ds_read_b128 v[116:119], v11 offset:0
    v_mfma_f32_16x16x32_bf16 v[20:23], v[76:79], v[60:63], v[20:23]
    ds_read_b128 v[120:123], v11 offset:2048
    ds_read_b128 v[124:127], v11 offset:4096
    v_mfma_f32_16x16x32_bf16 v[24:27], v[80:83], v[56:59], v[24:27]
    v_mfma_f32_16x16x32_bf16 v[28:31], v[80:83], v[60:63], v[28:31]
    v_mfma_f32_16x16x32_bf16 v[32:35], v[84:87], v[56:59], v[32:35]
    v_mfma_f32_16x16x32_bf16 v[36:39], v[84:87], v[60:63], v[36:39]
    s_cmp_lg_u32 s24, 0
    s_cbranch_scc1 K3_C0_NS1
    s_getreg_b32 s25, hwreg(HW_REG_IB_STS, 0, 4)
    s_cmp_lg_u32 s25, 0
    s_cbranch_scc1 K3_C0_NS1
K3_C0_SG1:
    s_waitcnt vmcnt(0)
    v_mov_b32 v140, 0
    v_mov_b32 v141, 1
    s_mov_b64 exec, 1
    buffer_atomic_add v141, v140, s[8:11], s38 offen sc1
    s_mov_b64 exec, -1
    s_mov_b32 s24, 1
K3_C0_NS1:
    s_waitcnt lgkmcnt(7)
    v_mfma_f32_16x16x32_bf16 v[16:19], v[104:107], v[88:91], v[16:19]
    v_mfma_f32_16x16x32_bf16 v[20:23], v[104:107], v[92:95], v[20:23]
    s_barrier
    v_add_u32 v8, s21, v128
    v_add_u32 v9, s21, v129
    v_add_u32 v10, s21, v130
    v_add_u32 v11, s21, v131
    s_add_u32 s21, s21, 17408
    s_cmp_eq_u32 s21, 69632
    s_cselect_b32 s21, 0, s21
    ds_read_b64_tr_b16 v[48:49], v8 offset:0
    ds_read_b64_tr_b16 v[50:51], v8 offset:1024
    v_mfma_f32_16x16x32_bf16 v[24:27], v[108:111], v[88:91], v[24:27]
    ds_read_b64_tr_b16 v[52:53], v9 offset:0
    ds_read_b64_tr_b16 v[54:55], v9 offset:1024
    v_mfma_f32_16x16x32_bf16 v[28:31], v[108:111], v[92:95], v[28:31]
    ds_read_b128 v[64:67], v10 offset:0
    ds_read_b128 v[68:71], v10 offset:2048
    v_mfma_f32_16x16x32_bf16 v[32:35], v[112:115], v[88:91], v[32:35]
    ds_read_b128 v[72:75], v10 offset:4096
    ds_read_b64_tr_b16 v[56:57], v8 offset:4096
    v_mfma_f32_16x16x32_bf16 v[36:39], v[112:115], v[92:95], v[36:39]
    s_waitcnt lgkmcnt(8)
    ds_read_b64_tr_b16 v[58:59], v8 offset:5120
    ds_read_b64_tr_b16 v[60:61], v9 offset:4096
    v_mfma_f32_16x16x32_bf16 v[16:19], v[116:119], v[96:99], v[16:19]
    ds_read_b64_tr_b16 v[62:63], v9 offset:5120
    ds_read_b128 v[76:79], v11 offset:0
    v_mfma_f32_16x16x32_bf16 v[20:23], v[116:119], v[100:103], v[20:23]
    ds_read_b128 v[80:83], v11 offset:2048
    ds_read_b128 v[84:87], v11 offset:4096
    v_mfma_f32_16x16x32_bf16 v[24:27], v[120:123], v[96:99], v[24:27]
    v_mfma_f32_16x16x32_bf16 v[28:31], v[120:123], v[100:103], v[28:31]
    v_mfma_f32_16x16x32_bf16 v[32:35], v[124:127], v[96:99], v[32:35]
    v_mfma_f32_16x16x32_bf16 v[36:39], v[124:127], v[100:103], v[36:39]
    s_add_u32 s20, s20, 1
    s_cmp_lt_u32 s20, 8
    s_cbranch_scc1 K3_C0_Y
    s_waitcnt lgkmcnt(7)
    v_mfma_f32_16x16x32_bf16 v[16:19], v[64:67], v[48:51], v[16:19]
    v_mfma_f32_16x16x32_bf16 v[20:23], v[64:67], v[52:55], v[20:23]
    s_barrier
    v_add_u32 v8, s21, v128
    v_add_u32 v9, s21, v129
    v_add_u32 v10, s21, v130
    v_add_u32 v11, s21, v131
    s_add_u32 s21, s21, 17408
    s_cmp_eq_u32 s21, 69632
    s_cselect_b32 s21, 0, s21
    ds_read_b64_tr_b16 v[88:89], v8 offset:0
    ds_read_b64_tr_b16 v[90:91], v8 offset:1024
    v_mfma_f32_16x16x32_bf16 v[24:27], v[68:71], v[48:51], v[24:27]
    ds_read_b64_tr_b16 v[92:93], v9 offset:0
    ds_read_b64_tr_b16 v[94:95], v9 offset:1024
    v_mfma_f32_16x16x32_bf16 v[28:31], v[68:71], v[52:55], v[28:31]
    ds_read_b128 v[104:107], v10 offset:0
    ds_read_b128 v[108:111], v10 offset:2048
    v_mfma_f32_16x16x32_bf16 v[32:35], v[72:75], v[48:51], v[32:35]
    ds_read_b128 v[112:115], v10 offset:4096
    ds_read_b64_tr_b16 v[96:97], v8 offset:4096
    v_mfma_f32_16x16x32_bf16 v[36:39], v[72:75], v[52:55], v[36:39]
    s_waitcnt lgkmcnt(8)
    ds_read_b64_tr_b16 v[98:99], v8 offset:5120
    ds_read_b64_tr_b16 v[100:101], v9 offset:4096
    v_mfma_f32_16x16x32_bf16 v[16:19], v[76:79], v[56:59], v[16:19]
    ds_read_b64_tr_b16 v[102:103], v9 offset:5120
    ds_read_b128 v[116:119], v11 offset:0
    v_mfma_f32_16x16x32_bf16 v[20:23], v[76:79], v[60:63], v[20:23]
    ds_read_b128 v[120:123], v11 offset:2048
    ds_read_b128 v[124:127], v11 offset:4096
    v_mfma_f32_16x16x32_bf16 v[24:27], v[80:83], v[56:59], v[24:27]
    v_mfma_f32_16x16x32_bf16 v[28:31], v[80:83], v[60:63], v[28:31]
    v_mfma_f32_16x16x32_bf16 v[32:35], v[84:87], v[56:59], v[32:35]
    v_mfma_f32_16x16x32_bf16 v[36:39], v[84:87], v[60:63], v[36:39]
    s_waitcnt lgkmcnt(7)
    v_mfma_f32_16x16x32_bf16 v[16:19], v[104:107], v[88:91], v[16:19]
    v_mfma_f32_16x16x32_bf16 v[20:23], v[104:107], v[92:95], v[20:23]
    s_barrier
    v_add_u32 v12, s21, v132
    v_add_u32 v13, s22, v133
    s_add_u32 s22, s22, 9216
    s_cmp_eq_u32 s22, 82944
    s_cselect_b32 s22, 0, s22
    s_add_u32 s21, s21, 17408
    s_cmp_eq_u32 s21, 69632
    s_cselect_b32 s21, 0, s21
    ds_read_b128 v[48:51], v12 offset:0
    ds_read_b128 v[52:55], v12 offset:256
    v_mfma_f32_16x16x32_bf16 v[24:27], v[108:111], v[88:91], v[24:27]
    ds_read_b64_tr_b16 v[64:65], v13 offset:0
    ds_read_b64_tr_b16 v[66:67], v13 offset:144
    v_mfma_f32_16x16x32_bf16 v[28:31], v[108:111], v[92:95], v[28:31]
    ds_read_b64_tr_b16 v[68:69], v13 offset:32
    ds_read_b64_tr_b16 v[70:71], v13 offset:176
    v_mfma_f32_16x16x32_bf16 v[32:35], v[112:115], v[88:91], v[32:35]
    ds_read_b64_tr_b16 v[72:73], v13 offset:64
    ds_read_b64_tr_b16 v[74:75], v13 offset:208
    v_mfma_f32_16x16x32_bf16 v[36:39], v[112:115], v[92:95], v[36:39]
    s_waitcnt lgkmcnt(8)
    ds_read_b128 v[56:59], v12 offset:4096
    ds_read_b128 v[60:63], v12 offset:4352
    v_mfma_f32_16x16x32_bf16 v[16:19], v[116:119], v[96:99], v[16:19]
    ds_read_b64_tr_b16 v[76:77], v13 offset:4608
    ds_read_b64_tr_b16 v[78:79], v13 offset:4752
    v_mfma_f32_16x16x32_bf16 v[20:23], v[116:119], v[100:103], v[20:23]
    ds_read_b64_tr_b16 v[80:81], v13 offset:4640
    ds_read_b64_tr_b16 v[82:83], v13 offset:4784
    v_mfma_f32_16x16x32_bf16 v[24:27], v[120:123], v[96:99], v[24:27]
    ds_read_b64_tr_b16 v[84:85], v13 offset:4672
    ds_read_b64_tr_b16 v[86:87], v13 offset:4816
    v_mfma_f32_16x16x32_bf16 v[28:31], v[120:123], v[100:103], v[28:31]
    v_mfma_f32_16x16x32_bf16 v[32:35], v[124:127], v[96:99], v[32:35]
    v_mfma_f32_16x16x32_bf16 v[36:39], v[124:127], v[100:103], v[36:39]
    s_nop 4
    v_mul_f32 v16, v135, v16
    v_mul_f32 v17, v135, v17
    v_mul_f32 v18, v135, v18
    v_mul_f32 v19, v135, v19
    v_mul_f32 v20, v136, v20
    v_mul_f32 v21, v136, v21
    v_mul_f32 v22, v136, v22
    v_mul_f32 v23, v136, v23
    v_mul_f32 v24, v135, v24
    v_mul_f32 v25, v135, v25
    v_mul_f32 v26, v135, v26
    v_mul_f32 v27, v135, v27
    v_mul_f32 v28, v136, v28
    v_mul_f32 v29, v136, v29
    v_mul_f32 v30, v136, v30
    v_mul_f32 v31, v136, v31
    v_mul_f32 v32, v135, v32
    v_mul_f32 v33, v135, v33
    v_mul_f32 v34, v135, v34
    v_mul_f32 v35, v135, v35
    v_mul_f32 v36, v136, v36
    v_mul_f32 v37, v136, v37
    v_mul_f32 v38, v136, v38
    v_mul_f32 v39, v136, v39
    s_mov_b32 s20, 0
K3_C0_O:
    s_waitcnt lgkmcnt(8)
    v_mfma_f32_16x16x32_bf16 v[16:19], v[64:67], v[48:51], v[16:19]
    v_mfma_f32_16x16x32_bf16 v[20:23], v[64:67], v[52:55], v[20:23]
    s_barrier
    v_add_u32 v12, s21, v132
    v_add_u32 v13, s22, v133
    s_add_u32 s22, s22, 9216
    s_cmp_eq_u32 s22, 82944
    s_cselect_b32 s22, 0, s22
    s_add_u32 s21, s21, 17408
    s_cmp_eq_u32 s21, 69632
    s_cselect_b32 s21, 0, s21
    ds_read_b128 v[88:91], v12 offset:0
    ds_read_b128 v[92:95], v12 offset:256
    v_mfma_f32_16x16x32_bf16 v[24:27], v[68:71], v[48:51], v[24:27]
    ds_read_b64_tr_b16 v[104:105], v13 offset:0
    ds_read_b64_tr_b16 v[106:107], v13 offset:144
    v_mfma_f32_16x16x32_bf16 v[28:31], v[68:71], v[52:55], v[28:31]
    ds_read_b64_tr_b16 v[108:109], v13 offset:32
    ds_read_b64_tr_b16 v[110:111], v13 offset:176
    v_mfma_f32_16x16x32_bf16 v[32:35], v[72:75], v[48:51], v[32:35]
    ds_read_b64_tr_b16 v[112:113], v13 offset:64
    ds_read_b64_tr_b16 v[114:115], v13 offset:208
    v_mfma_f32_16x16x32_bf16 v[36:39], v[72:75], v[52:55], v[36:39]
    s_waitcnt lgkmcnt(8)
    ds_read_b128 v[96:99], v12 offset:4096
    ds_read_b128 v[100:103], v12 offset:4352
    v_mfma_f32_16x16x32_bf16 v[16:19], v[76:79], v[56:59], v[16:19]
    ds_read_b64_tr_b16 v[116:117], v13 offset:4608
    ds_read_b64_tr_b16 v[118:119], v13 offset:4752
    v_mfma_f32_16x16x32_bf16 v[20:23], v[76:79], v[60:63], v[20:23]
    ds_read_b64_tr_b16 v[120:121], v13 offset:4640
    ds_read_b64_tr_b16 v[122:123], v13 offset:4784
    v_mfma_f32_16x16x32_bf16 v[24:27], v[80:83], v[56:59], v[24:27]
    ds_read_b64_tr_b16 v[124:125], v13 offset:4672
    ds_read_b64_tr_b16 v[126:127], v13 offset:4816
    v_mfma_f32_16x16x32_bf16 v[28:31], v[80:83], v[60:63], v[28:31]
    v_mfma_f32_16x16x32_bf16 v[32:35], v[84:87], v[56:59], v[32:35]
    v_mfma_f32_16x16x32_bf16 v[36:39], v[84:87], v[60:63], v[36:39]
    s_waitcnt lgkmcnt(8)
    v_mfma_f32_16x16x32_bf16 v[16:19], v[104:107], v[88:91], v[16:19]
    v_mfma_f32_16x16x32_bf16 v[20:23], v[104:107], v[92:95], v[20:23]
    s_barrier
    v_add_u32 v12, s21, v132
    v_add_u32 v13, s22, v133
    s_add_u32 s22, s22, 9216
    s_cmp_eq_u32 s22, 82944
    s_cselect_b32 s22, 0, s22
    s_add_u32 s21, s21, 17408
    s_cmp_eq_u32 s21, 69632
    s_cselect_b32 s21, 0, s21
    ds_read_b128 v[48:51], v12 offset:0
    ds_read_b128 v[52:55], v12 offset:256
    v_mfma_f32_16x16x32_bf16 v[24:27], v[108:111], v[88:91], v[24:27]
    ds_read_b64_tr_b16 v[64:65], v13 offset:0
    ds_read_b64_tr_b16 v[66:67], v13 offset:144
    v_mfma_f32_16x16x32_bf16 v[28:31], v[108:111], v[92:95], v[28:31]
    ds_read_b64_tr_b16 v[68:69], v13 offset:32
    ds_read_b64_tr_b16 v[70:71], v13 offset:176
    v_mfma_f32_16x16x32_bf16 v[32:35], v[112:115], v[88:91], v[32:35]
    ds_read_b64_tr_b16 v[72:73], v13 offset:64
    ds_read_b64_tr_b16 v[74:75], v13 offset:208
    v_mfma_f32_16x16x32_bf16 v[36:39], v[112:115], v[92:95], v[36:39]
    s_waitcnt lgkmcnt(8)
    ds_read_b128 v[56:59], v12 offset:4096
    ds_read_b128 v[60:63], v12 offset:4352
    v_mfma_f32_16x16x32_bf16 v[16:19], v[116:119], v[96:99], v[16:19]
    ds_read_b64_tr_b16 v[76:77], v13 offset:4608
    ds_read_b64_tr_b16 v[78:79], v13 offset:4752
    v_mfma_f32_16x16x32_bf16 v[20:23], v[116:119], v[100:103], v[20:23]
    ds_read_b64_tr_b16 v[80:81], v13 offset:4640
    ds_read_b64_tr_b16 v[82:83], v13 offset:4784
    v_mfma_f32_16x16x32_bf16 v[24:27], v[120:123], v[96:99], v[24:27]
    ds_read_b64_tr_b16 v[84:85], v13 offset:4672
    ds_read_b64_tr_b16 v[86:87], v13 offset:4816
    v_mfma_f32_16x16x32_bf16 v[28:31], v[120:123], v[100:103], v[28:31]
    v_mfma_f32_16x16x32_bf16 v[32:35], v[124:127], v[96:99], v[32:35]
    v_mfma_f32_16x16x32_bf16 v[36:39], v[124:127], v[100:103], v[36:39]
    s_add_u32 s20, s20, 1
    s_cmp_lt_u32 s20, 4
    s_cbranch_scc1 K3_C0_O
    s_waitcnt lgkmcnt(8)
    v_mfma_f32_16x16x32_bf16 v[16:19], v[64:67], v[48:51], v[16:19]
    v_mfma_f32_16x16x32_bf16 v[20:23], v[64:67], v[52:55], v[20:23]
    v_mfma_f32_16x16x32_bf16 v[24:27], v[68:71], v[48:51], v[24:27]
    v_mfma_f32_16x16x32_bf16 v[28:31], v[68:71], v[52:55], v[28:31]
    v_mfma_f32_16x16x32_bf16 v[32:35], v[72:75], v[48:51], v[32:35]
    v_mfma_f32_16x16x32_bf16 v[36:39], v[72:75], v[52:55], v[36:39]
    s_waitcnt lgkmcnt(0)
    v_mfma_f32_16x16x32_bf16 v[16:19], v[76:79], v[56:59], v[16:19]
    v_mfma_f32_16x16x32_bf16 v[20:23], v[76:79], v[60:63], v[20:23]
    v_mfma_f32_16x16x32_bf16 v[24:27], v[80:83], v[56:59], v[24:27]
    v_mfma_f32_16x16x32_bf16 v[28:31], v[80:83], v[60:63], v[28:31]
    v_mfma_f32_16x16x32_bf16 v[32:35], v[84:87], v[56:59], v[32:35]
    v_mfma_f32_16x16x32_bf16 v[36:39], v[84:87], v[60:63], v[36:39]
    s_nop 7
    ds_write_b128 v134, v[16:19] offset:0
    ds_write_b128 v134, v[20:23] offset:4864
    ds_write_b128 v134, v[24:27] offset:64
    ds_write_b128 v134, v[28:31] offset:4928
    ds_write_b128 v134, v[32:35] offset:128
    ds_write_b128 v134, v[36:39] offset:4992
    s_waitcnt lgkmcnt(0)
    s_barrier
    s_endpgm
K3_C1:
    v_mov_b32 v16, 0
    v_mov_b32 v17, 0
    v_mov_b32 v18, 0
    v_mov_b32 v19, 0
    v_mov_b32 v20, 0
    v_mov_b32 v21, 0
    v_mov_b32 v22, 0
    v_mov_b32 v23, 0
    v_mov_b32 v24, 0
    v_mov_b32 v25, 0
    v_mov_b32 v26, 0
    v_mov_b32 v27, 0
    v_mov_b32 v28, 0
    v_mov_b32 v29, 0
    v_mov_b32 v30, 0
    v_mov_b32 v31, 0
    v_mov_b32 v32, 0
    v_mov_b32 v33, 0
    v_mov_b32 v34, 0
    v_mov_b32 v35, 0
    v_mov_b32 v36, 0
    v_mov_b32 v37, 0
    v_mov_b32 v38, 0
    v_mov_b32 v39, 0
    v_mov_b32 v8, v128
    v_mov_b32 v9, v129
    v_mov_b32 v10, v130
    v_mov_b32 v11, v131
    s_mov_b32 s21, 17408
    s_lshr_b32 s22, s2, 5
    s_add_u32 s22, s22, s4
    s_mul_i32 s23, s22, 7282
    s_lshr_b32 s23, s23, 16
    s_mul_i32 s23, s23, 9
    s_sub_u32 s22, s22, s23
    s_mul_i32 s22, s22, 9216
    s_barrier
    ds_read_b64_tr_b16 v[48:49], v8 offset:0
    ds_read_b64_tr_b16 v[50:51], v8 offset:1024
    ds_read_b64_tr_b16 v[52:53], v9 offset:0
    ds_read_b64_tr_b16 v[54:55], v9 offset:1024
    ds_read_b128 v[64:67], v10 offset:0
    ds_read_b128 v[68:71], v10 offset:2048
    ds_read_b64_tr_b16 v[56:57], v8 offset:4096
    ds_read_b64_tr_b16 v[58:59], v8 offset:5120
    ds_read_b64_tr_b16 v[60:61], v9 offset:4096
    ds_read_b64_tr_b16 v[62:63], v9 offset:5120
    ds_read_b128 v[76:79], v11 offset:0
    ds_read_b128 v[80:83], v11 offset:2048
    s_mov_b32 s20, 0
    s_mov_b32 s24, 0
K3_C1_Y:
    s_cmp_lg_u32 s24, 0
    s_cbranch_scc1 K3_C1_NS0
    s_cmp_eq_u32 s20, 5
    s_cbranch_scc1 K3_C1_SG0
    s_getreg_b32 s25, hwreg(HW_REG_IB_STS, 0, 4)
    s_cmp_lg_u32 s25, 0
    s_cbranch_scc1 K3_C1_NS0
K3_C1_SG0:
    s_waitcnt vmcnt(0)
    v_mov_b32 v140, 0
    v_mov_b32 v141, 1
    s_mov_b64 exec, 1
    buffer_atomic_add v141, v140, s[8:11], s38 offen sc1
    s_mov_b64 exec, -1
    s_mov_b32 s24, 1
K3_C1_NS0:
    s_waitcnt lgkmcnt(6)
    v_mfma_f32_16x16x32_bf16 v[16:19], v[64:67], v[48:51], v[16:19]
    v_mfma_f32_16x16x32_bf16 v[20:23], v[64:67], v[52:55], v[20:23]
    s_barrier
    v_add_u32 v8, s21, v128
    v_add_u32 v9, s21, v129
    v_add_u32 v10, s21, v130
    v_add_u32 v11, s21, v131
    s_add_u32 s21, s21, 17408
    s_cmp_eq_u32 s21, 69632
    s_cselect_b32 s21, 0, s21
    ds_read_b64_tr_b16 v[88:89], v8 offset:0
    ds_read_b64_tr_b16 v[90:91], v8 offset:1024
    v_mfma_f32_16x16x32_bf16 v[24:27], v[68:71], v[48:51], v[24:27]
    ds_read_b64_tr_b16 v[92:93], v9 offset:0
    ds_read_b64_tr_b16 v[94:95], v9 offset:1024
    v_mfma_f32_16x16x32_bf16 v[28:31], v[68:71], v[52:55], v[28:31]
    s_waitcnt lgkmcnt(4)
    ds_read_b128 v[104:107], v10 offset:0
    ds_read_b128 v[108:111], v10 offset:2048
    v_mfma_f32_16x16x32_bf16 v[16:19], v[76:79], v[56:59], v[16:19]
    ds_read_b64_tr_b16 v[96:97], v8 offset:4096
    ds_read_b64_tr_b16 v[98:99], v8 offset:5120
    v_mfma_f32_16x16x32_bf16 v[20:23], v[76:79], v[60:63], v[20:23]
    ds_read_b64_tr_b16 v[100:101], v9 offset:4096
    ds_read_b64_tr_b16 v[102:103], v9 offset:5120
    v_mfma_f32_16x16x32_bf16 v[24:27], v[80:83], v[56:59], v[24:27]
    ds_read_b128 v[116:119], v11 offset:0
    ds_read_b128 v[120:123], v11 offset:2048
    v_mfma_f32_16x16x32_bf16 v[28:31], v[80:83], v[60:63], v[28:31]
    s_cmp_lg_u32 s24, 0
    s_cbranch_scc1 K3_C1_NS1
    s_getreg_b32 s25, hwreg(HW_REG_IB_STS, 0, 4)
    s_cmp_lg_u32 s25, 0
    s_cbranch_scc1 K3_C1_NS1
K3_C1_SG1:
    s_waitcnt vmcnt(0)
    v_mov_b32 v140, 0
    v_mov_b32 v141, 1
    s_mov_b64 exec, 1
    buffer_atomic_add v141, v140, s[8:11], s38 offen sc1
    s_mov_b64 exec, -1
    s_mov_b32 s24, 1
K3_C1_NS1:
    s_waitcnt lgkmcnt(6)
    v_mfma_f32_16x16x32_bf16 v[16:19], v[104:107], v[88:91], v[16:19]
    v_mfma_f32_16x16x32_bf16 v[20:23], v[104:107], v[92:95], v[20:23]
    s_barrier
    v_add_u32 v8, s21, v128
    v_add_u32 v9, s21, v129
    v_add_u32 v10, s21, v130
    v_add_u32 v11, s21, v131
    s_add_u32 s21, s21, 17408
    s_cmp_eq_u32 s21, 69632
    s_cselect_b32 s21, 0, s21
    ds_read_b64_tr_b16 v[48:49], v8 offset:0
    ds_read_b64_tr_b16 v[50:51], v8 offset:1024
    v_mfma_f32_16x16x32_bf16 v[24:27], v[108:111], v[88:91], v[24:27]
    ds_read_b64_tr_b16 v[52:53], v9 offset:0
    ds_read_b64_tr_b16 v[54:55], v9 offset:1024
    v_mfma_f32_16x16x32_bf16 v[28:31], v[108:111], v[92:95], v[28:31]
    s_waitcnt lgkmcnt(4)
    ds_read_b128 v[64:67], v10 offset:0
    ds_read_b128 v[68:71], v10 offset:2048
    v_mfma_f32_16x16x32_bf16 v[16:19], v[116:119], v[96:99], v[16:19]
    ds_read_b64_tr_b16 v[56:57], v8 offset:4096
    ds_read_b64_tr_b16 v[58:59], v8 offset:5120
    v_mfma_f32_16x16x32_bf16 v[20:23], v[116:119], v[100:103], v[20:23]
    ds_read_b64_tr_b16 v[60:61], v9 offset:4096
    ds_read_b64_tr_b16 v[62:63], v9 offset:5120
    v_mfma_f32_16x16x32_bf16 v[24:27], v[120:123], v[96:99], v[24:27]
    ds_read_b128 v[76:79], v11 offset:0
    ds_read_b128 v[80:83], v11 offset:2048
    v_mfma_f32_16x16x32_bf16 v[28:31], v[120:123], v[100:103], v[28:31]
    s_add_u32 s20, s20, 1
    s_cmp_lt_u32 s20, 8
    s_cbranch_scc1 K3_C1_Y
    s_waitcnt lgkmcnt(6)
    v_mfma_f32_16x16x32_bf16 v[16:19], v[64:67], v[48:51], v[16:19]
    v_mfma_f32_16x16x32_bf16 v[20:23], v[64:67], v[52:55], v[20:23]
    s_barrier
    v_add_u32 v8, s21, v128
    v_add_u32 v9, s21, v129
    v_add_u32 v10, s21, v130
    v_add_u32 v11, s21, v131
    s_add_u32 s21, s21, 17408
    s_cmp_eq_u32 s21, 69632
    s_cselect_b32 s21, 0, s21
    ds_read_b64_tr_b16 v[88:89], v8 offset:0
    ds_read_b64_tr_b16 v[90:91], v8 offset:1024
    v_mfma_f32_16x16x32_bf16 v[24:27], v[68:71], v[48:51], v[24:27]
    ds_read_b64_tr_b16 v[92:93], v9 offset:0
    ds_read_b64_tr_b16 v[94:95], v9 offset:1024
    v_mfma_f32_16x16x32_bf16 v[28:31], v[68:71], v[52:55], v[28:31]
    s_waitcnt lgkmcnt(4)
    ds_read_b128 v[104:107], v10 offset:0
    ds_read_b128 v[108:111], v10 offset:2048
    v_mfma_f32_16x16x32_bf16 v[16:19], v[76:79], v[56:59], v[16:19]
    ds_read_b64_tr_b16 v[96:97], v8 offset:4096
    ds_read_b64_tr_b16 v[98:99], v8 offset:5120
    v_mfma_f32_16x16x32_bf16 v[20:23], v[76:79], v[60:63], v[20:23]
    ds_read_b64_tr_b16 v[100:101], v9 offset:4096
    ds_read_b64_tr_b16 v[102:103], v9 offset:5120
    v_mfma_f32_16x16x32_bf16 v[24:27], v[80:83], v[56:59], v[24:27]
    ds_read_b128 v[116:119], v11 offset:0
    ds_read_b128 v[120:123], v11 offset:2048
    v_mfma_f32_16x16x32_bf16 v[28:31], v[80:83], v[60:63], v[28:31]
    s_waitcnt lgkmcnt(6)
    v_mfma_f32_16x16x32_bf16 v[16:19], v[104:107], v[88:91], v[16:19]
    v_mfma_f32_16x16x32_bf16 v[20:23], v[104:107], v[92:95], v[20:23]
    s_barrier
    v_add_u32 v12, s21, v132
    v_add_u32 v13, s22, v133
    s_add_u32 s22, s22, 9216
    s_cmp_eq_u32 s22, 82944
    s_cselect_b32 s22, 0, s22
    s_add_u32 s21, s21, 17408
    s_cmp_eq_u32 s21, 69632
    s_cselect_b32 s21, 0, s21
    ds_read_b128 v[48:51], v12 offset:0
    ds_read_b128 v[52:55], v12 offset:256
    v_mfma_f32_16x16x32_bf16 v[24:27], v[108:111], v[88:91], v[24:27]
    ds_read_b64_tr_b16 v[64:65], v13 offset:0
    ds_read_b64_tr_b16 v[66:67], v13 offset:144
    v_mfma_f32_16x16x32_bf16 v[28:31], v[108:111], v[92:95], v[28:31]
    s_waitcnt lgkmcnt(4)
    ds_read_b64_tr_b16 v[68:69], v13 offset:32
    ds_read_b64_tr_b16 v[70:71], v13 offset:176
    v_mfma_f32_16x16x32_bf16 v[16:19], v[116:119], v[96:99], v[16:19]
    ds_read_b128 v[56:59], v12 offset:4096
    ds_read_b128 v[60:63], v12 offset:4352
    v_mfma_f32_16x16x32_bf16 v[20:23], v[116:119], v[100:103], v[20:23]
    ds_read_b64_tr_b16 v[76:77], v13 offset:4608
    ds_read_b64_tr_b16 v[78:79], v13 offset:4752
    v_mfma_f32_16x16x32_bf16 v[24:27], v[120:123], v[96:99], v[24:27]
    ds_read_b64_tr_b16 v[80:81], v13 offset:4640
    ds_read_b64_tr_b16 v[82:83], v13 offset:4784
    v_mfma_f32_16x16x32_bf16 v[28:31], v[120:123], v[100:103], v[28:31]
    s_nop 4
    v_mul_f32 v16, v135, v16
    v_mul_f32 v17, v135, v17
    v_mul_f32 v18, v135, v18
    v_mul_f32 v19, v135, v19
    v_mul_f32 v20, v136, v20
    v_mul_f32 v21, v136, v21
    v_mul_f32 v22, v136, v22
    v_mul_f32 v23, v136, v23
    v_mul_f32 v24, v135, v24
    v_mul_f32 v25, v135, v25
    v_mul_f32 v26, v135, v26
    v_mul_f32 v27, v135, v27
    v_mul_f32 v28, v136, v28
    v_mul_f32 v29, v136, v29
    v_mul_f32 v30, v136, v30
    v_mul_f32 v31, v136, v31
    s_mov_b32 s20, 0
K3_C1_O:
    s_waitcnt lgkmcnt(6)
    v_mfma_f32_16x16x32_bf16 v[16:19], v[64:67], v[48:51], v[16:19]
    v_mfma_f32_16x16x32_bf16 v[20:23], v[64:67], v[52:55], v[20:23]
    s_barrier
    v_add_u32 v12, s21, v132
    v_add_u32 v13, s22, v133
    s_add_u32 s22, s22, 9216
    s_cmp_eq_u32 s22, 82944
    s_cselect_b32 s22, 0, s22
    s_add_u32 s21, s21, 17408
    s_cmp_eq_u32 s21, 69632
    s_cselect_b32 s21, 0, s21
    ds_read_b128 v[88:91], v12 offset:0
    ds_read_b128 v[92:95], v12 offset:256
    v_mfma_f32_16x16x32_bf16 v[24:27], v[68:71], v[48:51], v[24:27]
    ds_read_b64_tr_b16 v[104:105], v13 offset:0
    ds_read_b64_tr_b16 v[106:107], v13 offset:144
    v_mfma_f32_16x16x32_bf16 v[28:31], v[68:71], v[52:55], v[28:31]
    s_waitcnt lgkmcnt(4)
    ds_read_b64_tr_b16 v[108:109], v13 offset:32
    ds_read_b64_tr_b16 v[110:111], v13 offset:176
    v_mfma_f32_16x16x32_bf16 v[16:19], v[76:79], v[56:59], v[16:19]
    ds_read_b128 v[96:99], v12 offset:4096
    ds_read_b128 v[100:103], v12 offset:4352
    v_mfma_f32_16x16x32_bf16 v[20:23], v[76:79], v[60:63], v[20:23]
    ds_read_b64_tr_b16 v[116:117], v13 offset:4608
    ds_read_b64_tr_b16 v[118:119], v13 offset:4752
    v_mfma_f32_16x16x32_bf16 v[24:27], v[80:83], v[56:59], v[24:27]
    ds_read_b64_tr_b16 v[120:121], v13 offset:4640
    ds_read_b64_tr_b16 v[122:123], v13 offset:4784
    v_mfma_f32_16x16x32_bf16 v[28:31], v[80:83], v[60:63], v[28:31]
    s_waitcnt lgkmcnt(6)
    v_mfma_f32_16x16x32_bf16 v[16:19], v[104:107], v[88:91], v[16:19]
    v_mfma_f32_16x16x32_bf16 v[20:23], v[104:107], v[92:95], v[20:23]
    s_barrier
    v_add_u32 v12, s21, v132
    v_add_u32 v13, s22, v133
    s_add_u32 s22, s22, 9216
    s_cmp_eq_u32 s22, 82944
    s_cselect_b32 s22, 0, s22
    s_add_u32 s21, s21, 17408
    s_cmp_eq_u32 s21, 69632
    s_cselect_b32 s21, 0, s21
    ds_read_b128 v[48:51], v12 offset:0
    ds_read_b128 v[52:55], v12 offset:256
    v_mfma_f32_16x16x32_bf16 v[24:27], v[108:111], v[88:91], v[24:27]
    ds_read_b64_tr_b16 v[64:65], v13 offset:0
    ds_read_b64_tr_b16 v[66:67], v13 offset:144
    v_mfma_f32_16x16x32_bf16 v[28:31], v[108:111], v[92:95], v[28:31]
    s_waitcnt lgkmcnt(4)
    ds_read_b64_tr_b16 v[68:69], v13 offset:32
    ds_read_b64_tr_b16 v[70:71], v13 offset:176
    v_mfma_f32_16x16x32_bf16 v[16:19], v[116:119], v[96:99], v[16:19]
    ds_read_b128 v[56:59], v12 offset:4096
    ds_read_b128 v[60:63], v12 offset:4352
    v_mfma_f32_16x16x32_bf16 v[20:23], v[116:119], v[100:103], v[20:23]
    ds_read_b64_tr_b16 v[76:77], v13 offset:4608
    ds_read_b64_tr_b16 v[78:79], v13 offset:4752
    v_mfma_f32_16x16x32_bf16 v[24:27], v[120:123], v[96:99], v[24:27]
    ds_read_b64_tr_b16 v[80:81], v13 offset:4640
    ds_read_b64_tr_b16 v[82:83], v13 offset:4784
    v_mfma_f32_16x16x32_bf16 v[28:31], v[120:123], v[100:103], v[28:31]
    s_add_u32 s20, s20, 1
    s_cmp_lt_u32 s20, 4
    s_cbranch_scc1 K3_C1_O
    s_waitcnt lgkmcnt(6)
    v_mfma_f32_16x16x32_bf16 v[16:19], v[64:67], v[48:51], v[16:19]
    v_mfma_f32_16x16x32_bf16 v[20:23], v[64:67], v[52:55], v[20:23]
    v_mfma_f32_16x16x32_bf16 v[24:27], v[68:71], v[48:51], v[24:27]
    v_mfma_f32_16x16x32_bf16 v[28:31], v[68:71], v[52:55], v[28:31]
    s_waitcnt lgkmcnt(0)
    v_mfma_f32_16x16x32_bf16 v[16:19], v[76:79], v[56:59], v[16:19]
    v_mfma_f32_16x16x32_bf16 v[20:23], v[76:79], v[60:63], v[20:23]
    v_mfma_f32_16x16x32_bf16 v[24:27], v[80:83], v[56:59], v[24:27]
    v_mfma_f32_16x16x32_bf16 v[28:31], v[80:83], v[60:63], v[28:31]
    s_nop 7
    ds_write_b128 v134, v[16:19] offset:0
    ds_write_b128 v134, v[20:23] offset:4864
    s_mov_b32 exec_hi, 0
    ds_write_b128 v134, v[24:27] offset:64
    s_mov_b32 exec_hi, 0
    ds_write_b128 v134, v[28:31] offset:4928
    s_waitcnt lgkmcnt(0)
    s_barrier
    s_endpgm
K23_B:
    s_barrier
    s_mov_b32 s37, 1
K23_BL:
    s_cmp_eq_u32 s37, 9
    s_cbranch_scc1 K23_BS
    s_getreg_b32 s25, hwreg(HW_REG_IB_STS, 0, 4)
    s_cmp_eq_u32 s25, 0
    s_cbranch_scc1 K23_BS
    s_barrier
    s_add_u32 s37, s37, 1
    s_branch K23_BL
K23_BS:
    s_waitcnt vmcnt(0)
    v_mov_b32 v140, 0
    v_mov_b32 v141, 1
    s_mov_b64 exec, 1
    buffer_atomic_add v141, v140, s[8:11], s38 offen sc1
    s_mov_b64 exec, -1
    s_cmp_eq_u32 s3, 4
    s_cbranch_scc1 K23_B4
    s_endpgm
K23_B4:
    s_lshl_b32 s34, s4, 10
    s_add_u32 s34, s34, 16240640
    v_lshlrev_b32 v12, 7, v0
    v_add_u32 v12, s34, v12
    v_mov_b32 v13, 8
K23_BM:
    s_cmp_ge_u32 s37, 9
    s_cbranch_scc1 K23_BN
    s_barrier
    s_add_u32 s37, s37, 1
    s_branch K23_BM
K23_BN:
    s_mov_b64 exec, 0xff
    buffer_load_dword v14, v12, s[8:11], 0 offen sc1
    s_barrier
    s_barrier
    s_barrier
    s_waitcnt vmcnt(0)
    v_cmp_le_u32 vcc, v13, v14
    s_cmp_eq_u32 vcc_lo, 0xff
    s_cbranch_scc1 K23_QO
    s_mov_b32 s35, 65536
K23_PO:
    buffer_load_dword v14, v12, s[8:11], 0 offen sc1
    s_waitcnt vmcnt(0)
    v_cmp_le_u32 vcc, v13, v14
    s_cmp_eq_u32 vcc_lo, 255
    s_cbranch_scc1 K23_QO
    s_sleep 2
    s_sub_u32 s35, s35, 1
    s_cmp_lg_u32 s35, 0
    s_cbranch_scc1 K23_PO
K23_QO:
    s_barrier
    s_endpgm
K2_HELP:
    s_sub_u32 s3, s3, 8
    s_mul_i32 s7, s4, 151552
    s_lshl_b32 s20, s3, 11
    s_add_u32 s7, s7, s20
    s_add_u32 s7, s7, 2359296
    v_lshlrev_b32 v11, 4, v0
    s_waitcnt lgkmcnt(0)
    s_mov_b32 m0, s20
    s_add_u32 s39, s7, 1024
    buffer_load_dwordx4 v11, s[8:11], s7 offen lds
    s_add_u32 m0, s20, 1024
    s_add_u32 s20, s20, 8192
    buffer_load_dwordx4 v11, s[8:11], s39 offen lds
    s_add_u32 s7, s7, 8192
    s_mov_b32 m0, s20
    s_add_u32 s39, s7, 1024
    buffer_load_dwordx4 v11, s[8:11], s7 offen lds
    s_add_u32 m0, s20, 1024
    s_add_u32 s20, s20, 8192
    buffer_load_dwordx4 v11, s[8:11], s39 offen lds
    s_add_u32 s7, s7, 8192
    s_mov_b32 m0, s20
    s_add_u32 s39, s7, 1024
    buffer_load_dwordx4 v11, s[8:11], s7 offen lds
    s_add_u32 m0, s20, 1024
    s_add_u32 s20, s20, 8192
    buffer_load_dwordx4 v11, s[8:11], s39 offen lds
    s_add_u32 s7, s7, 8192
    s_mov_b32 m0, s20
    s_add_u32 s39, s7, 1024
    buffer_load_dwordx4 v11, s[8:11], s7 offen lds
    s_add_u32 m0, s20, 1024
    s_add_u32 s20, s20, 8192
    buffer_load_dwordx4 v11, s[8:11], s39 offen lds
    s_add_u32 s7, s7, 8192
    s_mov_b32 m0, s20
    s_add_u32 s39, s7, 1024
    buffer_load_dwordx4 v11, s[8:11], s7 offen lds
    s_add_u32 m0, s20, 1024
    s_add_u32 s20, s20, 8192
    buffer_load_dwordx4 v11, s[8:11], s39 offen lds
    s_add_u32 s7, s7, 8192
    s_mov_b32 m0, s20
    s_add_u32 s39, s7, 1024
    buffer_load_dwordx4 v11, s[8:11], s7 offen lds
    s_add_u32 m0, s20, 1024
    s_add_u32 s20, s20, 8192
    buffer_load_dwordx4 v11, s[8:11], s39 offen lds
    s_add_u32 s7, s7, 8192
    s_lshr_b32 s44, s2, 5
    s_lshl_b32 s45, s3, 1
    v_lshrrev_b32 v16, 3, v0
    v_and_b32 v17, 7, v0
    v_and_b32 v18, 6, v16
    v_xor_b32 v18, v18, v17
    v_lshrrev_b32 v19, 2, v16
    v_and_b32 v20, 3, v16
    v_lshl_add_u32 v19, v19, 3, v20
    v_lshlrev_b32 v19, 7, v19
    v_lshl_add_u32 v19, v18, 4, v19
    s_lshl_b32 s46, s3, 11
    v_add_u32 v2, s46, v19
    v_add_u32 v3, 512, v2
    v_xor_b32 v17, v17, v16
    s_mul_i32 s46, s44, 72
    v_add_u32 v16, s46, v16
    v_mul_u32_u24 v16, 1152, v16
    v_lshl_add_u32 v16, v17, 4, v16
    s_mul_i32 s47, s45, 9216
    v_add_u32 v4, s47, v16
    v_add_u32 v5, 9216, v4
    v_add_u32 v6, 73728, v16
    v_lshlrev_b32 v7, 4, v0
    v_add_u32 v167, 32768, v7
    s_mul_i32 s46, s44, 144
    s_lshl_b32 s47, s45, 6
    v_add_u32 v16, s47, v0
    v_mul_u32_u24 v17, 7282, v16
    v_lshrrev_b32 v17, 16, v17
    v_mul_u32_u24 v18, 9, v17
    v_sub_u32 v16, v16, v18
    v_lshl_add_u32 v16, v16, 4, s46
    v_and_b32 v18, 1, v17
    v_bfe_u32 v19, v17, 1, 2
    v_lshl_add_u32 v19, v18, 2, v19
    v_and_b32 v17, 56, v17
    v_add_u32 v17, v17, v19
    v_lshrrev_b32 v18, 1, v17
    v_mul_u32_u24 v19, 18, v18
    v_and_b32 v18, 1, v18
    v_xor_b32 v18, 1, v18
    v_lshl_add_u32 v19, v18, 4, v19
    v_and_b32 v18, 1, v17
    v_add_u32 v19, v19, v18
    v_mul_u32_u24 v19, 1152, v19
    v_add_u32 v156, v19, v16
    v_lshrrev_b32 v18, 4, v17
    v_mul_u32_u24 v19, 18, v18
    v_and_b32 v18, 1, v18
    v_lshl_add_u32 v19, v18, 1, v19
    v_bfe_u32 v18, v17, 2, 1
    v_lshl_add_u32 v19, v18, 3, v19
    v_bfe_u32 v18, v17, 3, 1
    v_lshl_add_u32 v19, v18, 2, v19
    v_and_b32 v18, 3, v17
    v_add_u32 v19, v19, v18
    v_mul_u32_u24 v19, 1152, v19
    v_add_u32 v8, v19, v16
    s_lshl_b32 s47, s45, 6
    s_add_u32 s47, s47, 64
    v_add_u32 v16, s47, v0
    v_mul_u32_u24 v17, 7282, v16
    v_lshrrev_b32 v17, 16, v17
    v_mul_u32_u24 v18, 9, v17
    v_sub_u32 v16, v16, v18
    v_lshl_add_u32 v16, v16, 4, s46
    v_and_b32 v18, 1, v17
    v_bfe_u32 v19, v17, 1, 2
    v_lshl_add_u32 v19, v18, 2, v19
    v_and_b32 v17, 56, v17
    v_add_u32 v17, v17, v19
    v_lshrrev_b32 v18, 1, v17
    v_mul_u32_u24 v19, 18, v18
    v_and_b32 v18, 1, v18
    v_xor_b32 v18, 1, v18
    v_lshl_add_u32 v19, v18, 4, v19
    v_and_b32 v18, 1, v17
    v_add_u32 v19, v19, v18
    v_mul_u32_u24 v19, 1152, v19
    v_add_u32 v157, v19, v16
    v_lshrrev_b32 v18, 4, v17
    v_mul_u32_u24 v19, 18, v18
    v_and_b32 v18, 1, v18
    v_lshl_add_u32 v19, v18, 1, v19
    v_bfe_u32 v18, v17, 2, 1
    v_lshl_add_u32 v19, v18, 3, v19
    v_bfe_u32 v18, v17, 3, 1
    v_lshl_add_u32 v19, v18, 2, v19
    v_and_b32 v18, 3, v17
    v_add_u32 v19, v19, v18
    v_mul_u32_u24 v19, 1152, v19
    v_add_u32 v9, v19, v16
    v_add_u32 v16, 512, v0
    v_mul_u32_u24 v17, 7282, v16
    v_lshrrev_b32 v17, 16, v17
    v_mul_u32_u24 v18, 9, v17
    v_sub_u32 v16, v16, v18
    v_lshl_add_u32 v16, v16, 4, s46
    v_and_b32 v18, 1, v17
    v_bfe_u32 v19, v17, 1, 2
    v_lshl_add_u32 v19, v18, 2, v19
    v_and_b32 v17, 56, v17
    v_add_u32 v17, v17, v19
    v_lshrrev_b32 v18, 1, v17
    v_mul_u32_u24 v19, 18, v18
    v_and_b32 v18, 1, v18
    v_xor_b32 v18, 1, v18
    v_lshl_add_u32 v19, v18, 4, v19
    v_and_b32 v18, 1, v17
    v_add_u32 v19, v19, v18
    v_mul_u32_u24 v19, 1152, v19
    v_add_u32 v158, v19, v16
    v_lshrrev_b32 v18, 4, v17
    v_mul_u32_u24 v19, 18, v18
    v_and_b32 v18, 1, v18
    v_lshl_add_u32 v19, v18, 1, v19
    v_bfe_u32 v18, v17, 2, 1
    v_lshl_add_u32 v19, v18, 3, v19
    v_bfe_u32 v18, v17, 3, 1
    v_lshl_add_u32 v19, v18, 2, v19
    v_and_b32 v18, 3, v17
    v_add_u32 v19, v19, v18
    v_mul_u32_u24 v19, 1152, v19
    v_add_u32 v10, v19, v16
    v_mul_u32_u24 v160, 3641, v0
    v_lshrrev_b32 v160, 16, v160
    v_mul_u32_u24 v161, 18, v160
    v_sub_u32 v161, v0, v161
    v_mov_b32 v162, 163584
    s_lshl_b32 s46, s4, 7
    s_add_u32 s46, s46, 16232448
    s_lshl_b32 s47, s44, 7
    s_add_u32 s47, s47, 16236544
    v_mov_b32 v164, s47
    v_mov_b32 v165, 81
    s_mov_b64 exec, 1
    v_mov_b32 v164, s46
    v_mov_b32 v165, 36
    s_mov_b64 exec, -1
    s_add_u32 s12, s12, 11935744
    s_addc_u32 s13, s13, 0
    v_lshlrev_b32 v12, 2, v0
    v_add_u32 v12, 163584, v12
    v_mov_b32 v13, 0
    ds_write_b32 v12, v13
    s_waitcnt vmcnt(6) lgkmcnt(0)
    s_barrier
    s_mov_b32 m0, s20
    s_add_u32 s39, s7, 1024
    buffer_load_dwordx4 v11, s[8:11], s7 offen lds
    s_add_u32 m0, s20, 1024
    s_add_u32 s20, s20, 8192
    buffer_load_dwordx4 v11, s[8:11], s39 offen lds
    s_add_u32 s7, s7, 8192
    s_mov_b32 m0, s20
    s_add_u32 s39, s7, 1024
    buffer_load_dwordx4 v11, s[8:11], s7 offen lds
    s_add_u32 m0, s20, 1024
    s_add_u32 s20, s20, 8192
    buffer_load_dwordx4 v11, s[8:11], s39 offen lds
    s_add_u32 s7, s7, 8192
    s_mov_b32 m0, s20
    s_add_u32 s39, s7, 1024
    buffer_load_dwordx4 v11, s[8:11], s7 offen lds
    s_add_u32 m0, s20, 1024
    s_add_u32 s20, s20, 8192
    buffer_load_dwordx4 v11, s[8:11], s39 offen lds
    s_add_u32 s7, s7, 8192
    s_mov_b32 m0, s20
    s_add_u32 s39, s7, 1024
    buffer_load_dwordx4 v11, s[8:11], s7 offen lds
    s_add_u32 m0, s20, 1024
    s_add_u32 s20, s20, 8192
    buffer_load_dwordx4 v11, s[8:11], s39 offen lds
    s_add_u32 s7, s7, 8192
    s_mov_b32 m0, s20
    s_add_u32 s39, s7, 1024
    buffer_load_dwordx4 v11, s[8:11], s7 offen lds
    s_add_u32 m0, s20, 1024
    s_add_u32 s20, s20, 8192
    buffer_load_dwordx4 v11, s[8:11], s39 offen lds
    s_add_u32 s7, s7, 8192
    s_mov_b32 m0, s20
    s_add_u32 s39, s7, 1024
    buffer_load_dwordx4 v11, s[8:11], s7 offen lds
    s_add_u32 m0, s20, 1024
    s_add_u32 s20, s20, 8192
    buffer_load_dwordx4 v11, s[8:11], s39 offen lds
    s_add_u32 s7, s7, 8192
    s_mov_b32 m0, s20
    s_add_u32 s39, s7, 1024
    buffer_load_dwordx4 v11, s[8:11], s7 offen lds
    s_add_u32 m0, s20, 1024
    s_add_u32 s20, s20, 8192
    buffer_load_dwordx4 v11, s[8:11], s39 offen lds
    s_add_u32 s7, s7, 8192
    s_waitcnt vmcnt(14)
    s_barrier
    s_mov_b32 m0, s20
    s_add_u32 s39, s7, 1024
    buffer_load_dwordx4 v11, s[8:11], s7 offen lds
    s_add_u32 m0, s20, 1024
    s_add_u32 s20, s20, 8192
    buffer_load_dwordx4 v11, s[8:11], s39 offen lds
    s_add_u32 s7, s7, 8192
    s_mov_b32 m0, s20
    s_add_u32 s39, s7, 1024
    buffer_load_dwordx4 v11, s[8:11], s7 offen lds
    s_add_u32 m0, s20, 1024
    s_add_u32 s20, s20, 8192
    buffer_load_dwordx4 v11, s[8:11], s39 offen lds
    s_add_u32 s7, s7, 8192
    s_mov_b32 m0, s20
    s_add_u32 s39, s7, 1024
    buffer_load_dwordx4 v11, s[8:11], s7 offen lds
    s_add_u32 m0, s20, 1024
    s_add_u32 s20, s20, 8192
    buffer_load_dwordx4 v11, s[8:11], s39 offen lds
    s_add_u32 s7, s7, 8192
    s_mov_b32 m0, s20
    s_add_u32 s39, s7, 1024
    buffer_load_dwordx4 v11, s[8:11], s7 offen lds
    s_add_u32 m0, s20, 1024
    s_add_u32 s20, s20, 8192
    buffer_load_dwordx4 v11, s[8:11], s39 offen lds
    s_add_u32 s7, s7, 8192
    s_mov_b32 m0, s20
    s_add_u32 s39, s7, 1024
    buffer_load_dwordx4 v11, s[8:11], s7 offen lds
    s_add_u32 m0, s20, 1024
    s_add_u32 s20, s20, 8192
    buffer_load_dwordx4 v11, s[8:11], s39 offen lds
    s_add_u32 s7, s7, 8192
    s_mov_b32 m0, s20
    s_add_u32 s39, s7, 1024
    buffer_load_dwordx4 v11, s[8:11], s7 offen lds
    s_add_u32 m0, s20, 1024
    s_add_u32 s20, s20, 8192
    buffer_load_dwordx4 v11, s[8:11], s39 offen lds
    s_add_u32 s7, s7, 8192
    s_waitcnt vmcnt(0)
    s_barrier
    s_lshr_b32 s29, s2, 3
    s_and_b32 s28, s2, 1
    s_lshl_b32 s30, s29, 1
    s_add_u32 s28, s28, s30
    s_lshl_b32 s30, s3, 6
    s_add_u32 s28, s28, s30
    s_mov_b32 s43, s28
    s_bfe_u32 s30, s2, 0x20001
    s_mul_i32 s30, s30, 9
    s_cmp_ge_u32 s28, 32
    s_cbranch_scc1 K2_J1JOB
    s_lshl_b32 s28, s28, 1
    s_branch K2_JOBID
K2_J1JOB:
    s_add_u32 s28, s28, 32
K2_JOBID:
    s_mul_i32 s23, s28, 7282
    s_lshr_b32 s23, s23, 16
    s_mul_i32 s38, s23, 9
    s_sub_u32 s38, s28, s38
    s_add_u32 s38, s38, s30
    s_lshl_b32 s37, s38, 9
    v_lshlrev_b32 v100, 3, v0
    v_add_u32 v100, s37, v100
    v_lshrrev_b32 v101, 2, v0
    v_lshlrev_b32 v101, 3, v101
    s_mul_i32 s31, s23, 18432
    s_mul_i32 s32, s23, 147456
    s_lshl_b32 s37, s38, 11
    s_add_u32 s32, s32, s37
    s_add_u32 s32, s32, 7217152
    s_lshl_b32 s37, s38, 7
    s_add_u32 s33, s37, 12533760
    buffer_load_dwordx2 v[82:83], v101, s[8:11], s33 offen
    s_mov_b32 s14, 589824
    buffer_load_dwordx2 v[80:81], v100, s[12:15], s31 offen
    v_lshlrev_b32 v14, 5, v0
    s_add_u32 s34, s32, 0
    buffer_load_dwordx4 v[84:87], v14, s[8:11], s34 offen
    buffer_load_dwordx4 v[88:91], v14, s[8:11], s34 offen offset:16
    s_add_u32 s34, s32, 73728
    buffer_load_dwordx4 v[92:95], v14, s[8:11], s34 offen
    buffer_load_dwordx4 v[96:99], v14, s[8:11], s34 offen offset:16
    s_cmp_le_u32 s23, 0
    s_cbranch_scc1 K2J0_SL
    s_sub_u32 s31, s31, 18432
    s_cmp_gt_u32 s23, 0
    s_cselect_b32 s14, 589824, 0
    buffer_load_dwordx2 v[16:17], v100, s[12:15], s31 offen
    s_sub_u32 s31, s31, 18432
    s_cmp_gt_u32 s23, 1
    s_cselect_b32 s14, 589824, 0
    buffer_load_dwordx2 v[18:19], v100, s[12:15], s31 offen
    s_sub_u32 s31, s31, 18432
    s_cmp_gt_u32 s23, 2
    s_cselect_b32 s14, 589824, 0
    buffer_load_dwordx2 v[20:21], v100, s[12:15], s31 offen
    s_sub_u32 s31, s31, 18432
    s_cmp_gt_u32 s23, 3
    s_cselect_b32 s14, 589824, 0
    buffer_load_dwordx2 v[22:23], v100, s[12:15], s31 offen
    s_cmp_le_u32 s23, 4
    s_cbranch_scc1 K2J0_SL
    s_sub_u32 s31, s31, 18432
    s_cmp_gt_u32 s23, 4
    s_cselect_b32 s14, 589824, 0
    buffer_load_dwordx2 v[24:25], v100, s[12:15], s31 offen
    s_sub_u32 s31, s31, 18432
    s_cmp_gt_u32 s23, 5
    s_cselect_b32 s14, 589824, 0
    buffer_load_dwordx2 v[26:27], v100, s[12:15], s31 offen
    s_sub_u32 s31, s31, 18432
    s_cmp_gt_u32 s23, 6
    s_cselect_b32 s14, 589824, 0
    buffer_load_dwordx2 v[28:29], v100, s[12:15], s31 offen
    s_sub_u32 s31, s31, 18432
    s_cmp_gt_u32 s23, 7
    s_cselect_b32 s14, 589824, 0
    buffer_load_dwordx2 v[30:31], v100, s[12:15], s31 offen
    s_cmp_le_u32 s23, 8
    s_cbranch_scc1 K2J0_SL
    s_sub_u32 s31, s31, 18432
    s_cmp_gt_u32 s23, 8
    s_cselect_b32 s14, 589824, 0
    buffer_load_dwordx2 v[32:33], v100, s[12:15], s31 offen
    s_sub_u32 s31, s31, 18432
    s_cmp_gt_u32 s23, 9
    s_cselect_b32 s14, 589824, 0
    buffer_load_dwordx2 v[34:35], v100, s[12:15], s31 offen
    s_sub_u32 s31, s31, 18432
    s_cmp_gt_u32 s23, 10
    s_cselect_b32 s14, 589824, 0
    buffer_load_dwordx2 v[36:37], v100, s[12:15], s31 offen
    s_sub_u32 s31, s31, 18432
    s_cmp_gt_u32 s23, 11
    s_cselect_b32 s14, 589824, 0
    buffer_load_dwordx2 v[38:39], v100, s[12:15], s31 offen
    s_cmp_le_u32 s23, 12
    s_cbranch_scc1 K2J0_SL
    s_sub_u32 s31, s31, 18432
    s_cmp_gt_u32 s23, 12
    s_cselect_b32 s14, 589824, 0
    buffer_load_dwordx2 v[40:41], v100, s[12:15], s31 offen
    s_sub_u32 s31, s31, 18432
    s_cmp_gt_u32 s23, 13
    s_cselect_b32 s14, 589824, 0
    buffer_load_dwordx2 v[42:43], v100, s[12:15], s31 offen
    s_sub_u32 s31, s31, 18432
    s_cmp_gt_u32 s23, 14
    s_cselect_b32 s14, 589824, 0
    buffer_load_dwordx2 v[44:45], v100, s[12:15], s31 offen
    s_sub_u32 s31, s31, 18432
    s_cmp_gt_u32 s23, 15
    s_cselect_b32 s14, 589824, 0
    buffer_load_dwordx2 v[46:47], v100, s[12:15], s31 offen
    s_cmp_le_u32 s23, 16
    s_cbranch_scc1 K2J0_SL
    s_sub_u32 s31, s31, 18432
    s_cmp_gt_u32 s23, 16
    s_cselect_b32 s14, 589824, 0
    buffer_load_dwordx2 v[48:49], v100, s[12:15], s31 offen
    s_sub_u32 s31, s31, 18432
    s_cmp_gt_u32 s23, 17
    s_cselect_b32 s14, 589824, 0
    buffer_load_dwordx2 v[50:51], v100, s[12:15], s31 offen
    s_sub_u32 s31, s31, 18432
    s_cmp_gt_u32 s23, 18
    s_cselect_b32 s14, 589824, 0
    buffer_load_dwordx2 v[52:53], v100, s[12:15], s31 offen
    s_sub_u32 s31, s31, 18432
    s_cmp_gt_u32 s23, 19
    s_cselect_b32 s14, 589824, 0
    buffer_load_dwordx2 v[54:55], v100, s[12:15], s31 offen
    s_cmp_le_u32 s23, 20
    s_cbranch_scc1 K2J0_SL
    s_sub_u32 s31, s31, 18432
    s_cmp_gt_u32 s23, 20
    s_cselect_b32 s14, 589824, 0
    buffer_load_dwordx2 v[56:57], v100, s[12:15], s31 offen
    s_sub_u32 s31, s31, 18432
    s_cmp_gt_u32 s23, 21
    s_cselect_b32 s14, 589824, 0
    buffer_load_dwordx2 v[58:59], v100, s[12:15], s31 offen
    s_sub_u32 s31, s31, 18432
    s_cmp_gt_u32 s23, 22
    s_cselect_b32 s14, 589824, 0
    buffer_load_dwordx2 v[60:61], v100, s[12:15], s31 offen
    s_sub_u32 s31, s31, 18432
    s_cmp_gt_u32 s23, 23
    s_cselect_b32 s14, 589824, 0
    buffer_load_dwordx2 v[62:63], v100, s[12:15], s31 offen
    s_cmp_le_u32 s23, 24
    s_cbranch_scc1 K2J0_SL
    s_sub_u32 s31, s31, 18432
    s_cmp_gt_u32 s23, 24
    s_cselect_b32 s14, 589824, 0
    buffer_load_dwordx2 v[64:65], v100, s[12:15], s31 offen
    s_sub_u32 s31, s31, 18432
    s_cmp_gt_u32 s23, 25
    s_cselect_b32 s14, 589824, 0
    buffer_load_dwordx2 v[66:67], v100, s[12:15], s31 offen
    s_sub_u32 s31, s31, 18432
    s_cmp_gt_u32 s23, 26
    s_cselect_b32 s14, 589824, 0
    buffer_load_dwordx2 v[68:69], v100, s[12:15], s31 offen
    s_sub_u32 s31, s31, 18432
    s_cmp_gt_u32 s23, 27
    s_cselect_b32 s14, 589824, 0
    buffer_load_dwordx2 v[70:71], v100, s[12:15], s31 offen
    s_cmp_le_u32 s23, 28
    s_cbranch_scc1 K2J0_SL
    s_sub_u32 s31, s31, 18432
    s_cmp_gt_u32 s23, 28
    s_cselect_b32 s14, 589824, 0
    buffer_load_dwordx2 v[72:73], v100, s[12:15], s31 offen
    s_sub_u32 s31, s31, 18432
    s_cmp_gt_u32 s23, 29
    s_cselect_b32 s14, 589824, 0
    buffer_load_dwordx2 v[74:75], v100, s[12:15], s31 offen
    s_sub_u32 s31, s31, 18432
    s_cmp_gt_u32 s23, 30
    s_cselect_b32 s14, 589824, 0
    buffer_load_dwordx2 v[76:77], v100, s[12:15], s31 offen
    s_sub_u32 s31, s31, 18432
    s_cmp_gt_u32 s23, 31
    s_cselect_b32 s14, 589824, 0
    buffer_load_dwordx2 v[78:79], v100, s[12:15], s31 offen
K2J0_SL:
    s_mov_b32 s22, 0
    s_sub_u32 s36, s43, 32
    s_cmp_ge_u32 s36, 162
    s_cbranch_scc1 K2_JNOCF
    s_mul_i32 s34, s30, 18
    s_add_u32 s36, s36, s34
    s_cmp_ge_u32 s36, 648
    s_cbranch_scc1 K2_JNOCF
    s_mov_b32 s22, 2
    s_mul_i32 s41, s36, 810
    s_lshr_b32 s41, s41, 16
    s_lshl_b32 s36, s36, 6
    v_add_u32 v15, s36, v0
    v_lshlrev_b32 v12, 4, v15
    v_mul_u32_u24 v13, 58255, v15
    v_lshrrev_b32 v13, 22, v13
    v_mul_u32_u24 v13, 72, v13
    v_sub_u32 v13, v15, v13
    v_lshlrev_b32 v13, 4, v13
    s_mov_b32 s36, 12538368
    buffer_load_dwordx4 v[116:119], v12, s[16:19], 0 offen
    buffer_load_dwordx4 v[120:123], v12, s[24:27], 0 offen
    buffer_load_dwordx4 v[124:127], v13, s[8:11], s36 offen offset:0
    buffer_load_dwordx4 v[128:131], v13, s[8:11], s36 offen offset:1152
    buffer_load_dwordx4 v[132:135], v13, s[8:11], s36 offen offset:2304
    buffer_load_dwordx4 v[136:139], v13, s[8:11], s36 offen offset:3456
K2_JNOCF:
    s_waitcnt vmcnt(0)
K2_JGO:
    s_setprio 2
    v_mul_f32 v102, v83, v83
    v_mul_f32 v103, v82, v83
    v_fma_f32 v102, v82, v82, -v102
    v_add_f32 v103, v103, v103
    v_mul_f32 v104, v103, v103
    v_mul_f32 v105, v102, v103
    v_fma_f32 v104, v102, v102, -v104
    v_add_f32 v105, v105, v105
    v_mul_f32 v106, v105, v105
    v_mul_f32 v107, v104, v105
    v_fma_f32 v106, v104, v104, -v106
    v_add_f32 v107, v107, v107
    v_mul_f32 v102, v107, v107
    v_mul_f32 v103, v106, v107
    v_fma_f32 v102, v106, v106, -v102
    v_add_f32 v103, v103, v103
    v_mul_f32 v106, v103, v103
    v_mul_f32 v107, v102, v103
    v_fma_f32 v106, v102, v102, -v106
    v_add_f32 v107, v107, v107
    v_mul_f32 v104, v107, v107
    v_mul_f32 v105, v106, v107
    v_fma_f32 v104, v106, v106, -v104
    v_add_f32 v105, v105, v105
    v_mov_b32 v106, 0
    v_mov_b32 v107, 0
    s_cmp_le_u32 s23, 28
    s_cbranch_scc1 K2J0_SH7
    v_fma_f32 v78, v104, v106, v78
    v_fma_f32 v79, v104, v107, v79
    v_fma_f32 v78, -v105, v107, v78
    v_fma_f32 v79, v105, v106, v79
    v_fma_f32 v76, v104, v78, v76
    v_fma_f32 v77, v104, v79, v77
    v_fma_f32 v76, -v105, v79, v76
    v_fma_f32 v77, v105, v78, v77
    v_fma_f32 v74, v104, v76, v74
    v_fma_f32 v75, v104, v77, v75
    v_fma_f32 v74, -v105, v77, v74
    v_fma_f32 v75, v105, v76, v75
    v_fma_f32 v106, v104, v74, v72
    v_fma_f32 v107, v104, v75, v73
    v_fma_f32 v106, -v105, v75, v106
    v_fma_f32 v107, v105, v74, v107
K2J0_SH7:
    s_cmp_le_u32 s23, 24
    s_cbranch_scc1 K2J0_SH6
    v_fma_f32 v70, v104, v106, v70
    v_fma_f32 v71, v104, v107, v71
    v_fma_f32 v70, -v105, v107, v70
    v_fma_f32 v71, v105, v106, v71
    v_fma_f32 v68, v104, v70, v68
    v_fma_f32 v69, v104, v71, v69
    v_fma_f32 v68, -v105, v71, v68
    v_fma_f32 v69, v105, v70, v69
    v_fma_f32 v66, v104, v68, v66
    v_fma_f32 v67, v104, v69, v67
    v_fma_f32 v66, -v105, v69, v66
    v_fma_f32 v67, v105, v68, v67
    v_fma_f32 v106, v104, v66, v64
    v_fma_f32 v107, v104, v67, v65
    v_fma_f32 v106, -v105, v67, v106
    v_fma_f32 v107, v105, v66, v107
K2J0_SH6:
    s_cmp_le_u32 s23, 20
    s_cbranch_scc1 K2J0_SH5
    v_fma_f32 v62, v104, v106, v62
    v_fma_f32 v63, v104, v107, v63
    v_fma_f32 v62, -v105, v107, v62
    v_fma_f32 v63, v105, v106, v63
    v_fma_f32 v60, v104, v62, v60
    v_fma_f32 v61, v104, v63, v61
    v_fma_f32 v60, -v105, v63, v60
    v_fma_f32 v61, v105, v62, v61
    v_fma_f32 v58, v104, v60, v58
    v_fma_f32 v59, v104, v61, v59
    v_fma_f32 v58, -v105, v61, v58
    v_fma_f32 v59, v105, v60, v59
    v_fma_f32 v106, v104, v58, v56
    v_fma_f32 v107, v104, v59, v57
    v_fma_f32 v106, -v105, v59, v106
    v_fma_f32 v107, v105, v58, v107
K2J0_SH5:
    s_cmp_le_u32 s23, 16
    s_cbranch_scc1 K2J0_SH4
    v_fma_f32 v54, v104, v106, v54
    v_fma_f32 v55, v104, v107, v55
    v_fma_f32 v54, -v105, v107, v54
    v_fma_f32 v55, v105, v106, v55
    v_fma_f32 v52, v104, v54, v52
    v_fma_f32 v53, v104, v55, v53
    v_fma_f32 v52, -v105, v55, v52
    v_fma_f32 v53, v105, v54, v53
    v_fma_f32 v50, v104, v52, v50
    v_fma_f32 v51, v104, v53, v51
    v_fma_f32 v50, -v105, v53, v50
    v_fma_f32 v51, v105, v52, v51
    v_fma_f32 v106, v104, v50, v48
    v_fma_f32 v107, v104, v51, v49
    v_fma_f32 v106, -v105, v51, v106
    v_fma_f32 v107, v105, v50, v107
K2J0_SH4:
    s_cmp_le_u32 s23, 12
    s_cbranch_scc1 K2J0_SH3
    v_fma_f32 v46, v104, v106, v46
    v_fma_f32 v47, v104, v107, v47
    v_fma_f32 v46, -v105, v107, v46
    v_fma_f32 v47, v105, v106, v47
    v_fma_f32 v44, v104, v46, v44
    v_fma_f32 v45, v104, v47, v45
    v_fma_f32 v44, -v105, v47, v44
    v_fma_f32 v45, v105, v46, v45
    v_fma_f32 v42, v104, v44, v42
    v_fma_f32 v43, v104, v45, v43
    v_fma_f32 v42, -v105, v45, v42
    v_fma_f32 v43, v105, v44, v43
    v_fma_f32 v106, v104, v42, v40
    v_fma_f32 v107, v104, v43, v41
    v_fma_f32 v106, -v105, v43, v106
    v_fma_f32 v107, v105, v42, v107
K2J0_SH3:
    s_cmp_le_u32 s23, 8
    s_cbranch_scc1 K2J0_SH2
    v_fma_f32 v38, v104, v106, v38
    v_fma_f32 v39, v104, v107, v39
    v_fma_f32 v38, -v105, v107, v38
    v_fma_f32 v39, v105, v106, v39
    v_fma_f32 v36, v104, v38, v36
    v_fma_f32 v37, v104, v39, v37
    v_fma_f32 v36, -v105, v39, v36
    v_fma_f32 v37, v105, v38, v37
    v_fma_f32 v34, v104, v36, v34
    v_fma_f32 v35, v104, v37, v35
    v_fma_f32 v34, -v105, v37, v34
    v_fma_f32 v35, v105, v36, v35
    v_fma_f32 v106, v104, v34, v32
    v_fma_f32 v107, v104, v35, v33
    v_fma_f32 v106, -v105, v35, v106
    v_fma_f32 v107, v105, v34, v107
K2J0_SH2:
    s_cmp_le_u32 s23, 4
    s_cbranch_scc1 K2J0_SH1
    v_fma_f32 v30, v104, v106, v30
    v_fma_f32 v31, v104, v107, v31
    v_fma_f32 v30, -v105, v107, v30
    v_fma_f32 v31, v105, v106, v31
    v_fma_f32 v28, v104, v30, v28
    v_fma_f32 v29, v104, v31, v29
    v_fma_f32 v28, -v105, v31, v28
    v_fma_f32 v29, v105, v30, v29
    v_fma_f32 v26, v104, v28, v26
    v_fma_f32 v27, v104, v29, v27
    v_fma_f32 v26, -v105, v29, v26
    v_fma_f32 v27, v105, v28, v27
    v_fma_f32 v106, v104, v26, v24
    v_fma_f32 v107, v104, v27, v25
    v_fma_f32 v106, -v105, v27, v106
    v_fma_f32 v107, v105, v26, v107
K2J0_SH1:
    s_cmp_le_u32 s23, 0
    s_cbranch_scc1 K2J0_SH0
    v_fma_f32 v22, v104, v106, v22
    v_fma_f32 v23, v104, v107, v23
    v_fma_f32 v22, -v105, v107, v22
    v_fma_f32 v23, v105, v106, v23
    v_fma_f32 v20, v104, v22, v20
    v_fma_f32 v21, v104, v23, v21
    v_fma_f32 v20, -v105, v23, v20
    v_fma_f32 v21, v105, v22, v21
    v_fma_f32 v18, v104, v20, v18
    v_fma_f32 v19, v104, v21, v19
    v_fma_f32 v18, -v105, v21, v18
    v_fma_f32 v19, v105, v20, v19
    v_fma_f32 v106, v104, v18, v16
    v_fma_f32 v107, v104, v19, v17
    v_fma_f32 v106, -v105, v19, v106
    v_fma_f32 v107, v105, v18, v107
K2J0_SH0:
    s_nop 1
    v_mov_b32_dpp v110, v106 quad_perm:[0,0,0,0] row_mask:0xf bank_mask:0xf
    v_mov_b32_dpp v111, v107 quad_perm:[0,0,0,0] row_mask:0xf bank_mask:0xf
    v_mov_b32_dpp v108, v106 quad_perm:[1,1,1,1] row_mask:0xf bank_mask:0xf
    v_mov_b32_dpp v109, v107 quad_perm:[1,1,1,1] row_mask:0xf bank_mask:0xf
    v_fma_f32 v112, v102, v110, v108
    v_fma_f32 v113, v102, v111, v109
    v_fma_f32 v112, -v103, v111, v112
    v_fma_f32 v113, v103, v110, v113
    v_mov_b32_dpp v108, v106 quad_perm:[2,2,2,2] row_mask:0xf bank_mask:0xf
    v_mov_b32_dpp v109, v107 quad_perm:[2,2,2,2] row_mask:0xf bank_mask:0xf
    v_fma_f32 v110, v102, v112, v108
    v_fma_f32 v111, v102, v113, v109
    v_fma_f32 v110, -v103, v113, v110
    v_fma_f32 v111, v103, v112, v111
    v_mov_b32_dpp v108, v106 quad_perm:[3,3,3,3] row_mask:0xf bank_mask:0xf
    v_mov_b32_dpp v109, v107 quad_perm:[3,3,3,3] row_mask:0xf bank_mask:0xf
    v_fma_f32 v112, v102, v110, v108
    v_fma_f32 v113, v102, v111, v109
    v_fma_f32 v112, -v103, v111, v112
    v_fma_f32 v113, v103, v110, v113
    v_mov_b32_dpp v108, v80 quad_perm:[0,0,0,0] row_mask:0xf bank_mask:0xf
    v_mov_b32_dpp v109, v81 quad_perm:[0,0,0,0] row_mask:0xf bank_mask:0xf
    v_fma_f32 v16, v102, v112, v108
    v_fma_f32 v17, v102, v113, v109
    v_fma_f32 v16, -v103, v113, v16
    v_fma_f32 v17, v103, v112, v17
    v_mov_b32_dpp v108, v80 quad_perm:[1,1,1,1] row_mask:0xf bank_mask:0xf
    v_mov_b32_dpp v109, v81 quad_perm:[1,1,1,1] row_mask:0xf bank_mask:0xf
    v_fma_f32 v18, v102, v16, v108
    v_fma_f32 v19, v102, v17, v109
    v_fma_f32 v18, -v103, v17, v18
    v_fma_f32 v19, v103, v16, v19
    v_mov_b32_dpp v108, v80 quad_perm:[2,2,2,2] row_mask:0xf bank_mask:0xf
    v_mov_b32_dpp v109, v81 quad_perm:[2,2,2,2] row_mask:0xf bank_mask:0xf
    v_fma_f32 v20, v102, v18, v108
    v_fma_f32 v21, v102, v19, v109
    v_fma_f32 v20, -v103, v19, v20
    v_fma_f32 v21, v103, v18, v21
    s_mov_b32 s34, 0xeeeeeeee
    s_mov_b32 s35, 0xeeeeeeee
    v_cndmask_b32 v112, v112, v16, s[34:35]
    v_cndmask_b32 v113, v113, v17, s[34:35]
    s_mov_b32 s34, 0xcccccccc
    s_mov_b32 s35, 0xcccccccc
    v_cndmask_b32 v112, v112, v18, s[34:35]
    v_cndmask_b32 v113, v113, v19, s[34:35]
    s_mov_b32 s34, 0x88888888
    s_mov_b32 s35, 0x88888888
    v_cndmask_b32 v112, v112, v20, s[34:35]
    v_cndmask_b32 v113, v113, v21, s[34:35]
    v_lshlrev_b32 v108, 16, v84
    v_lshlrev_b32 v109, 16, v92
    v_fma_f32 v24, v82, v112, v108
    v_fma_f32 v40, v82, v113, v109
    v_fma_f32 v24, -v83, v113, v24
    v_fma_f32 v40, v83, v112, v40
    v_and_b32 v108, 0xffff0000, v84
    v_and_b32 v109, 0xffff0000, v92
    v_fma_f32 v25, v82, v24, v108
    v_fma_f32 v41, v82, v40, v109
    v_fma_f32 v25, -v83, v40, v25
    v_fma_f32 v41, v83, v24, v41
    v_lshlrev_b32 v108, 16, v85
    v_lshlrev_b32 v109, 16, v93
    v_fma_f32 v26, v82, v25, v108
    v_fma_f32 v42, v82, v41, v109
    v_fma_f32 v26, -v83, v41, v26
    v_fma_f32 v42, v83, v25, v42
    v_and_b32 v108, 0xffff0000, v85
    v_and_b32 v109, 0xffff0000, v93
    v_fma_f32 v27, v82, v26, v108
    v_fma_f32 v43, v82, v42, v109
    v_fma_f32 v27, -v83, v42, v27
    v_fma_f32 v43, v83, v26, v43
    v_lshlrev_b32 v108, 16, v86
    v_lshlrev_b32 v109, 16, v94
    v_fma_f32 v28, v82, v27, v108
    v_fma_f32 v44, v82, v43, v109
    v_fma_f32 v28, -v83, v43, v28
    v_fma_f32 v44, v83, v27, v44
    v_and_b32 v108, 0xffff0000, v86
    v_and_b32 v109, 0xffff0000, v94
    v_fma_f32 v29, v82, v28, v108
    v_fma_f32 v45, v82, v44, v109
    v_fma_f32 v29, -v83, v44, v29
    v_fma_f32 v45, v83, v28, v45
    v_lshlrev_b32 v108, 16, v87
    v_lshlrev_b32 v109, 16, v95
    v_fma_f32 v30, v82, v29, v108
    v_fma_f32 v46, v82, v45, v109
    v_fma_f32 v30, -v83, v45, v30
    v_fma_f32 v46, v83, v29, v46
    v_and_b32 v108, 0xffff0000, v87
    v_and_b32 v109, 0xffff0000, v95
    v_fma_f32 v31, v82, v30, v108
    v_fma_f32 v47, v82, v46, v109
    v_fma_f32 v31, -v83, v46, v31
    v_fma_f32 v47, v83, v30, v47
    v_lshlrev_b32 v108, 16, v88
    v_lshlrev_b32 v109, 16, v96
    v_fma_f32 v32, v82, v31, v108
    v_fma_f32 v48, v82, v47, v109
    v_fma_f32 v32, -v83, v47, v32
    v_fma_f32 v48, v83, v31, v48
    v_and_b32 v108, 0xffff0000, v88
    v_and_b32 v109, 0xffff0000, v96
    v_fma_f32 v33, v82, v32, v108
    v_fma_f32 v49, v82, v48, v109
    v_fma_f32 v33, -v83, v48, v33
    v_fma_f32 v49, v83, v32, v49
    v_lshlrev_b32 v108, 16, v89
    v_lshlrev_b32 v109, 16, v97
    v_fma_f32 v34, v82, v33, v108
    v_fma_f32 v50, v82, v49, v109
    v_fma_f32 v34, -v83, v49, v34
    v_fma_f32 v50, v83, v33, v50
    v_and_b32 v108, 0xffff0000, v89
    v_and_b32 v109, 0xffff0000, v97
    v_fma_f32 v35, v82, v34, v108
    v_fma_f32 v51, v82, v50, v109
    v_fma_f32 v35, -v83, v50, v35
    v_fma_f32 v51, v83, v34, v51
    v_lshlrev_b32 v108, 16, v90
    v_lshlrev_b32 v109, 16, v98
    v_fma_f32 v36, v82, v35, v108
    v_fma_f32 v52, v82, v51, v109
    v_fma_f32 v36, -v83, v51, v36
    v_fma_f32 v52, v83, v35, v52
    v_and_b32 v108, 0xffff0000, v90
    v_and_b32 v109, 0xffff0000, v98
    v_fma_f32 v37, v82, v36, v108
    v_fma_f32 v53, v82, v52, v109
    v_fma_f32 v37, -v83, v52, v37
    v_fma_f32 v53, v83, v36, v53
    v_lshlrev_b32 v108, 16, v91
    v_lshlrev_b32 v109, 16, v99
    v_fma_f32 v38, v82, v37, v108
    v_fma_f32 v54, v82, v53, v109
    v_fma_f32 v38, -v83, v53, v38
    v_fma_f32 v54, v83, v37, v54
    v_and_b32 v108, 0xffff0000, v91
    v_and_b32 v109, 0xffff0000, v99
    v_fma_f32 v39, v82, v38, v108
    v_fma_f32 v55, v82, v54, v109
    v_fma_f32 v39, -v83, v54, v39
    v_fma_f32 v55, v83, v38, v55
    v_cvt_pk_bf16_f32 v84, v24, v25
    v_cvt_pk_bf16_f32 v85, v26, v27
    v_cvt_pk_bf16_f32 v86, v28, v29
    v_cvt_pk_bf16_f32 v87, v30, v31
    v_cvt_pk_bf16_f32 v88, v32, v33
    v_cvt_pk_bf16_f32 v89, v34, v35
    v_cvt_pk_bf16_f32 v90, v36, v37
    v_cvt_pk_bf16_f32 v91, v38, v39
    v_cvt_pk_bf16_f32 v92, v40, v41
    v_cvt_pk_bf16_f32 v93, v42, v43
    v_cvt_pk_bf16_f32 v94, v44, v45
    v_cvt_pk_bf16_f32 v95, v46, v47
    v_cvt_pk_bf16_f32 v96, v48, v49
    v_cvt_pk_bf16_f32 v97, v50, v51
    v_cvt_pk_bf16_f32 v98, v52, v53
    v_cvt_pk_bf16_f32 v99, v54, v55
    s_add_u32 s34, s32, 0
    buffer_store_dwordx4 v[84:87], v14, s[8:11], s34 offen sc1
    buffer_store_dwordx4 v[88:91], v14, s[8:11], s34 offen offset:16 sc1
    s_add_u32 s34, s32, 73728
    buffer_store_dwordx4 v[92:95], v14, s[8:11], s34 offen sc1
    buffer_store_dwordx4 v[96:99], v14, s[8:11], s34 offen offset:16 sc1
    s_cmp_eq_u32 s22, 2
    s_cbranch_scc0 K2_JX
    s_waitcnt vmcnt(4)
    v_lshlrev_b32 v102, 16, v116
    v_lshlrev_b32 v103, 16, v120
    v_mul_f32 v140, v102, v124
    v_mul_f32 v148, v102, v125
    v_fma_f32 v140, -v103, v125, v140
    v_fma_f32 v148, -v103, v124, -v148
    v_and_b32 v106, 0xffff0000, v116
    v_and_b32 v107, 0xffff0000, v120
    v_mul_f32 v141, v106, v126
    v_mul_f32 v149, v106, v127
    v_fma_f32 v141, -v107, v127, v141
    v_fma_f32 v149, -v107, v126, -v149
    v_lshlrev_b32 v102, 16, v117
    v_lshlrev_b32 v103, 16, v121
    v_mul_f32 v142, v102, v128
    v_mul_f32 v150, v102, v129
    v_fma_f32 v142, -v103, v129, v142
    v_fma_f32 v150, -v103, v128, -v150
    v_and_b32 v106, 0xffff0000, v117
    v_and_b32 v107, 0xffff0000, v121
    v_mul_f32 v143, v106, v130
    v_mul_f32 v151, v106, v131
    v_fma_f32 v143, -v107, v131, v143
    v_fma_f32 v151, -v107, v130, -v151
    v_lshlrev_b32 v102, 16, v118
    v_lshlrev_b32 v103, 16, v122
    v_mul_f32 v144, v102, v132
    v_mul_f32 v152, v102, v133
    v_fma_f32 v144, -v103, v133, v144
    v_fma_f32 v152, -v103, v132, -v152
    v_and_b32 v106, 0xffff0000, v118
    v_and_b32 v107, 0xffff0000, v122
    v_mul_f32 v145, v106, v134
    v_mul_f32 v153, v106, v135
    v_fma_f32 v145, -v107, v135, v145
    v_fma_f32 v153, -v107, v134, -v153
    v_lshlrev_b32 v102, 16, v119
    v_lshlrev_b32 v103, 16, v123
    v_mul_f32 v146, v102, v136
    v_mul_f32 v154, v102, v137
    v_fma_f32 v146, -v103, v137, v146
    v_fma_f32 v154, -v103, v136, -v154
    v_and_b32 v106, 0xffff0000, v119
    v_and_b32 v107, 0xffff0000, v123
    v_mul_f32 v147, v106, v138
    v_mul_f32 v155, v106, v139
    v_fma_f32 v147, -v107, v139, v147
    v_fma_f32 v155, -v107, v138, -v155
    v_cvt_pk_bf16_f32 v116, v140, v141
    v_cvt_pk_bf16_f32 v117, v142, v143
    v_cvt_pk_bf16_f32 v118, v144, v145
    v_cvt_pk_bf16_f32 v119, v146, v147
    v_cvt_pk_bf16_f32 v120, v148, v149
    v_cvt_pk_bf16_f32 v121, v150, v151
    v_cvt_pk_bf16_f32 v122, v152, v153
    v_cvt_pk_bf16_f32 v123, v154, v155
    s_mov_b32 s34, 12544000
    s_mov_b32 s35, 13207552
    buffer_store_dwordx4 v[116:119], v12, s[8:11], s34 offen sc1
    buffer_store_dwordx4 v[120:123], v12, s[8:11], s35 offen sc1
    s_waitcnt vmcnt(0)
    s_lshl_b32 s34, s41, 7
    s_add_u32 s34, s34, 16236544
    v_mov_b32 v140, 0
    v_mov_b32 v141, 1
    s_mov_b64 exec, 1
    buffer_atomic_add v141, v140, s[8:11], s34 offen sc1
    s_mov_b64 exec, -1
    s_branch K2_JEND
K2_JX:
    s_cmp_lg_u32 s3, 0
    s_cbranch_scc1 K2_JWAIT
    s_cmp_ge_u32 s29, 16
    s_cbranch_scc1 K2_JWAIT
    s_setprio 0
    s_mov_b32 s40, s23
    s_add_u32 s28, s28, 1
    s_mul_i32 s23, s28, 7282
    s_lshr_b32 s23, s23, 16
    s_mul_i32 s38, s23, 9
    s_sub_u32 s38, s28, s38
    s_add_u32 s38, s38, s30
    s_lshl_b32 s37, s38, 9
    v_lshlrev_b32 v100, 3, v0
    v_add_u32 v100, s37, v100
    v_lshrrev_b32 v101, 2, v0
    v_lshlrev_b32 v101, 3, v101
    s_mul_i32 s31, s23, 18432
    s_mul_i32 s32, s23, 147456
    s_lshl_b32 s37, s38, 11
    s_add_u32 s32, s32, s37
    s_add_u32 s32, s32, 7217152
    s_lshl_b32 s37, s38, 7
    s_add_u32 s33, s37, 12533760
    buffer_load_dwordx2 v[82:83], v101, s[8:11], s33 offen
    s_mov_b32 s14, 589824
    buffer_load_dwordx2 v[80:81], v100, s[12:15], s31 offen
    v_lshlrev_b32 v14, 5, v0
    s_add_u32 s34, s32, 0
    buffer_load_dwordx4 v[84:87], v14, s[8:11], s34 offen
    buffer_load_dwordx4 v[88:91], v14, s[8:11], s34 offen offset:16
    s_add_u32 s34, s32, 73728
    buffer_load_dwordx4 v[92:95], v14, s[8:11], s34 offen
    buffer_load_dwordx4 v[96:99], v14, s[8:11], s34 offen offset:16
    s_cmp_le_u32 s23, 0
    s_cbranch_scc1 K2J1_SL
    s_sub_u32 s31, s31, 18432
    s_cmp_gt_u32 s23, 0
    s_cselect_b32 s14, 589824, 0
    buffer_load_dwordx2 v[16:17], v100, s[12:15], s31 offen
    s_sub_u32 s31, s31, 18432
    s_cmp_gt_u32 s23, 1
    s_cselect_b32 s14, 589824, 0
    buffer_load_dwordx2 v[18:19], v100, s[12:15], s31 offen
    s_sub_u32 s31, s31, 18432
    s_cmp_gt_u32 s23, 2
    s_cselect_b32 s14, 589824, 0
    buffer_load_dwordx2 v[20:21], v100, s[12:15], s31 offen
    s_sub_u32 s31, s31, 18432
    s_cmp_gt_u32 s23, 3
    s_cselect_b32 s14, 589824, 0
    buffer_load_dwordx2 v[22:23], v100, s[12:15], s31 offen
    s_cmp_le_u32 s23, 4
    s_cbranch_scc1 K2J1_SL
    s_sub_u32 s31, s31, 18432
    s_cmp_gt_u32 s23, 4
    s_cselect_b32 s14, 589824, 0
    buffer_load_dwordx2 v[24:25], v100, s[12:15], s31 offen
    s_sub_u32 s31, s31, 18432
    s_cmp_gt_u32 s23, 5
    s_cselect_b32 s14, 589824, 0
    buffer_load_dwordx2 v[26:27], v100, s[12:15], s31 offen
    s_sub_u32 s31, s31, 18432
    s_cmp_gt_u32 s23, 6
    s_cselect_b32 s14, 589824, 0
    buffer_load_dwordx2 v[28:29], v100, s[12:15], s31 offen
    s_sub_u32 s31, s31, 18432
    s_cmp_gt_u32 s23, 7
    s_cselect_b32 s14, 589824, 0
    buffer_load_dwordx2 v[30:31], v100, s[12:15], s31 offen
    s_cmp_le_u32 s23, 8
    s_cbranch_scc1 K2J1_SL
    s_sub_u32 s31, s31, 18432
    s_cmp_gt_u32 s23, 8
    s_cselect_b32 s14, 589824, 0
    buffer_load_dwordx2 v[32:33], v100, s[12:15], s31 offen
    s_sub_u32 s31, s31, 18432
    s_cmp_gt_u32 s23, 9
    s_cselect_b32 s14, 589824, 0
    buffer_load_dwordx2 v[34:35], v100, s[12:15], s31 offen
    s_sub_u32 s31, s31, 18432
    s_cmp_gt_u32 s23, 10
    s_cselect_b32 s14, 589824, 0
    buffer_load_dwordx2 v[36:37], v100, s[12:15], s31 offen
    s_sub_u32 s31, s31, 18432
    s_cmp_gt_u32 s23, 11
    s_cselect_b32 s14, 589824, 0
    buffer_load_dwordx2 v[38:39], v100, s[12:15], s31 offen
    s_cmp_le_u32 s23, 12
    s_cbranch_scc1 K2J1_SL
    s_sub_u32 s31, s31, 18432
    s_cmp_gt_u32 s23, 12
    s_cselect_b32 s14, 589824, 0
    buffer_load_dwordx2 v[40:41], v100, s[12:15], s31 offen
    s_sub_u32 s31, s31, 18432
    s_cmp_gt_u32 s23, 13
    s_cselect_b32 s14, 589824, 0
    buffer_load_dwordx2 v[42:43], v100, s[12:15], s31 offen
    s_sub_u32 s31, s31, 18432
    s_cmp_gt_u32 s23, 14
    s_cselect_b32 s14, 589824, 0
    buffer_load_dwordx2 v[44:45], v100, s[12:15], s31 offen
    s_sub_u32 s31, s31, 18432
    s_cmp_gt_u32 s23, 15
    s_cselect_b32 s14, 589824, 0
    buffer_load_dwordx2 v[46:47], v100, s[12:15], s31 offen
    s_cmp_le_u32 s23, 16
    s_cbranch_scc1 K2J1_SL
    s_sub_u32 s31, s31, 18432
    s_cmp_gt_u32 s23, 16
    s_cselect_b32 s14, 589824, 0
    buffer_load_dwordx2 v[48:49], v100, s[12:15], s31 offen
    s_sub_u32 s31, s31, 18432
    s_cmp_gt_u32 s23, 17
    s_cselect_b32 s14, 589824, 0
    buffer_load_dwordx2 v[50:51], v100, s[12:15], s31 offen
    s_sub_u32 s31, s31, 18432
    s_cmp_gt_u32 s23, 18
    s_cselect_b32 s14, 589824, 0
    buffer_load_dwordx2 v[52:53], v100, s[12:15], s31 offen
    s_sub_u32 s31, s31, 18432
    s_cmp_gt_u32 s23, 19
    s_cselect_b32 s14, 589824, 0
    buffer_load_dwordx2 v[54:55], v100, s[12:15], s31 offen
    s_cmp_le_u32 s23, 20
    s_cbranch_scc1 K2J1_SL
    s_sub_u32 s31, s31, 18432
    s_cmp_gt_u32 s23, 20
    s_cselect_b32 s14, 589824, 0
    buffer_load_dwordx2 v[56:57], v100, s[12:15], s31 offen
    s_sub_u32 s31, s31, 18432
    s_cmp_gt_u32 s23, 21
    s_cselect_b32 s14, 589824, 0
    buffer_load_dwordx2 v[58:59], v100, s[12:15], s31 offen
    s_sub_u32 s31, s31, 18432
    s_cmp_gt_u32 s23, 22
    s_cselect_b32 s14, 589824, 0
    buffer_load_dwordx2 v[60:61], v100, s[12:15], s31 offen
    s_sub_u32 s31, s31, 18432
    s_cmp_gt_u32 s23, 23
    s_cselect_b32 s14, 589824, 0
    buffer_load_dwordx2 v[62:63], v100, s[12:15], s31 offen
    s_cmp_le_u32 s23, 24
    s_cbranch_scc1 K2J1_SL
    s_sub_u32 s31, s31, 18432
    s_cmp_gt_u32 s23, 24
    s_cselect_b32 s14, 589824, 0
    buffer_load_dwordx2 v[64:65], v100, s[12:15], s31 offen
    s_sub_u32 s31, s31, 18432
    s_cmp_gt_u32 s23, 25
    s_cselect_b32 s14, 589824, 0
    buffer_load_dwordx2 v[66:67], v100, s[12:15], s31 offen
    s_sub_u32 s31, s31, 18432
    s_cmp_gt_u32 s23, 26
    s_cselect_b32 s14, 589824, 0
    buffer_load_dwordx2 v[68:69], v100, s[12:15], s31 offen
    s_sub_u32 s31, s31, 18432
    s_cmp_gt_u32 s23, 27
    s_cselect_b32 s14, 589824, 0
    buffer_load_dwordx2 v[70:71], v100, s[12:15], s31 offen
    s_cmp_le_u32 s23, 28
    s_cbranch_scc1 K2J1_SL
    s_sub_u32 s31, s31, 18432
    s_cmp_gt_u32 s23, 28
    s_cselect_b32 s14, 589824, 0
    buffer_load_dwordx2 v[72:73], v100, s[12:15], s31 offen
    s_sub_u32 s31, s31, 18432
    s_cmp_gt_u32 s23, 29
    s_cselect_b32 s14, 589824, 0
    buffer_load_dwordx2 v[74:75], v100, s[12:15], s31 offen
    s_sub_u32 s31, s31, 18432
    s_cmp_gt_u32 s23, 30
    s_cselect_b32 s14, 589824, 0
    buffer_load_dwordx2 v[76:77], v100, s[12:15], s31 offen
    s_sub_u32 s31, s31, 18432
    s_cmp_gt_u32 s23, 31
    s_cselect_b32 s14, 589824, 0
    buffer_load_dwordx2 v[78:79], v100, s[12:15], s31 offen
K2J1_SL:
    s_waitcnt vmcnt(0)
    s_lshl_b32 s34, s40, 7
    s_add_u32 s34, s34, 16232448
    v_mov_b32 v140, 0
    v_mov_b32 v141, 1
    s_mov_b64 exec, 1
    buffer_atomic_add v141, v140, s[8:11], s34 offen sc1
    s_mov_b64 exec, -1
    s_setprio 2
    v_mul_f32 v102, v83, v83
    v_mul_f32 v103, v82, v83
    v_fma_f32 v102, v82, v82, -v102
    v_add_f32 v103, v103, v103
    v_mul_f32 v104, v103, v103
    v_mul_f32 v105, v102, v103
    v_fma_f32 v104, v102, v102, -v104
    v_add_f32 v105, v105, v105
    v_mul_f32 v106, v105, v105
    v_mul_f32 v107, v104, v105
    v_fma_f32 v106, v104, v104, -v106
    v_add_f32 v107, v107, v107
    v_mul_f32 v102, v107, v107
    v_mul_f32 v103, v106, v107
    v_fma_f32 v102, v106, v106, -v102
    v_add_f32 v103, v103, v103
    v_mul_f32 v106, v103, v103
    v_mul_f32 v107, v102, v103
    v_fma_f32 v106, v102, v102, -v106
    v_add_f32 v107, v107, v107
    v_mul_f32 v104, v107, v107
    v_mul_f32 v105, v106, v107
    v_fma_f32 v104, v106, v106, -v104
    v_add_f32 v105, v105, v105
    v_mov_b32 v106, 0
    v_mov_b32 v107, 0
    s_cmp_le_u32 s23, 28
    s_cbranch_scc1 K2J1_SH7
    v_fma_f32 v78, v104, v106, v78
    v_fma_f32 v79, v104, v107, v79
    v_fma_f32 v78, -v105, v107, v78
    v_fma_f32 v79, v105, v106, v79
    v_fma_f32 v76, v104, v78, v76
    v_fma_f32 v77, v104, v79, v77
    v_fma_f32 v76, -v105, v79, v76
    v_fma_f32 v77, v105, v78, v77
    v_fma_f32 v74, v104, v76, v74
    v_fma_f32 v75, v104, v77, v75
    v_fma_f32 v74, -v105, v77, v74
    v_fma_f32 v75, v105, v76, v75
    v_fma_f32 v106, v104, v74, v72
    v_fma_f32 v107, v104, v75, v73
    v_fma_f32 v106, -v105, v75, v106
    v_fma_f32 v107, v105, v74, v107
K2J1_SH7:
    s_cmp_le_u32 s23, 24
    s_cbranch_scc1 K2J1_SH6
    v_fma_f32 v70, v104, v106, v70
    v_fma_f32 v71, v104, v107, v71
    v_fma_f32 v70, -v105, v107, v70
    v_fma_f32 v71, v105, v106, v71
    v_fma_f32 v68, v104, v70, v68
    v_fma_f32 v69, v104, v71, v69
    v_fma_f32 v68, -v105, v71, v68
    v_fma_f32 v69, v105, v70, v69
    v_fma_f32 v66, v104, v68, v66
    v_fma_f32 v67, v104, v69, v67
    v_fma_f32 v66, -v105, v69, v66
    v_fma_f32 v67, v105, v68, v67
    v_fma_f32 v106, v104, v66, v64
    v_fma_f32 v107, v104, v67, v65
    v_fma_f32 v106, -v105, v67, v106
    v_fma_f32 v107, v105, v66, v107
K2J1_SH6:
    s_cmp_le_u32 s23, 20
    s_cbranch_scc1 K2J1_SH5
    v_fma_f32 v62, v104, v106, v62
    v_fma_f32 v63, v104, v107, v63
    v_fma_f32 v62, -v105, v107, v62
    v_fma_f32 v63, v105, v106, v63
    v_fma_f32 v60, v104, v62, v60
    v_fma_f32 v61, v104, v63, v61
    v_fma_f32 v60, -v105, v63, v60
    v_fma_f32 v61, v105, v62, v61
    v_fma_f32 v58, v104, v60, v58
    v_fma_f32 v59, v104, v61, v59
    v_fma_f32 v58, -v105, v61, v58
    v_fma_f32 v59, v105, v60, v59
    v_fma_f32 v106, v104, v58, v56
    v_fma_f32 v107, v104, v59, v57
    v_fma_f32 v106, -v105, v59, v106
    v_fma_f32 v107, v105, v58, v107
K2J1_SH5:
    s_cmp_le_u32 s23, 16
    s_cbranch_scc1 K2J1_SH4
    v_fma_f32 v54, v104, v106, v54
    v_fma_f32 v55, v104, v107, v55
    v_fma_f32 v54, -v105, v107, v54
    v_fma_f32 v55, v105, v106, v55
    v_fma_f32 v52, v104, v54, v52
    v_fma_f32 v53, v104, v55, v53
    v_fma_f32 v52, -v105, v55, v52
    v_fma_f32 v53, v105, v54, v53
    v_fma_f32 v50, v104, v52, v50
    v_fma_f32 v51, v104, v53, v51
    v_fma_f32 v50, -v105, v53, v50
    v_fma_f32 v51, v105, v52, v51
    v_fma_f32 v106, v104, v50, v48
    v_fma_f32 v107, v104, v51, v49
    v_fma_f32 v106, -v105, v51, v106
    v_fma_f32 v107, v105, v50, v107
K2J1_SH4:
    s_cmp_le_u32 s23, 12
    s_cbranch_scc1 K2J1_SH3
    v_fma_f32 v46, v104, v106, v46
    v_fma_f32 v47, v104, v107, v47
    v_fma_f32 v46, -v105, v107, v46
    v_fma_f32 v47, v105, v106, v47
    v_fma_f32 v44, v104, v46, v44
    v_fma_f32 v45, v104, v47, v45
    v_fma_f32 v44, -v105, v47, v44
    v_fma_f32 v45, v105, v46, v45
    v_fma_f32 v42, v104, v44, v42
    v_fma_f32 v43, v104, v45, v43
    v_fma_f32 v42, -v105, v45, v42
    v_fma_f32 v43, v105, v44, v43
    v_fma_f32 v106, v104, v42, v40
    v_fma_f32 v107, v104, v43, v41
    v_fma_f32 v106, -v105, v43, v106
    v_fma_f32 v107, v105, v42, v107
K2J1_SH3:
    s_cmp_le_u32 s23, 8
    s_cbranch_scc1 K2J1_SH2
    v_fma_f32 v38, v104, v106, v38
    v_fma_f32 v39, v104, v107, v39
    v_fma_f32 v38, -v105, v107, v38
    v_fma_f32 v39, v105, v106, v39
    v_fma_f32 v36, v104, v38, v36
    v_fma_f32 v37, v104, v39, v37
    v_fma_f32 v36, -v105, v39, v36
    v_fma_f32 v37, v105, v38, v37
    v_fma_f32 v34, v104, v36, v34
    v_fma_f32 v35, v104, v37, v35
    v_fma_f32 v34, -v105, v37, v34
    v_fma_f32 v35, v105, v36, v35
    v_fma_f32 v106, v104, v34, v32
    v_fma_f32 v107, v104, v35, v33
    v_fma_f32 v106, -v105, v35, v106
    v_fma_f32 v107, v105, v34, v107
K2J1_SH2:
    s_cmp_le_u32 s23, 4
    s_cbranch_scc1 K2J1_SH1
    v_fma_f32 v30, v104, v106, v30
    v_fma_f32 v31, v104, v107, v31
    v_fma_f32 v30, -v105, v107, v30
    v_fma_f32 v31, v105, v106, v31
    v_fma_f32 v28, v104, v30, v28
    v_fma_f32 v29, v104, v31, v29
    v_fma_f32 v28, -v105, v31, v28
    v_fma_f32 v29, v105, v30, v29
    v_fma_f32 v26, v104, v28, v26
    v_fma_f32 v27, v104, v29, v27
    v_fma_f32 v26, -v105, v29, v26
    v_fma_f32 v27, v105, v28, v27
    v_fma_f32 v106, v104, v26, v24
    v_fma_f32 v107, v104, v27, v25
    v_fma_f32 v106, -v105, v27, v106
    v_fma_f32 v107, v105, v26, v107
K2J1_SH1:
    s_cmp_le_u32 s23, 0
    s_cbranch_scc1 K2J1_SH0
    v_fma_f32 v22, v104, v106, v22
    v_fma_f32 v23, v104, v107, v23
    v_fma_f32 v22, -v105, v107, v22
    v_fma_f32 v23, v105, v106, v23
    v_fma_f32 v20, v104, v22, v20
    v_fma_f32 v21, v104, v23, v21
    v_fma_f32 v20, -v105, v23, v20
    v_fma_f32 v21, v105, v22, v21
    v_fma_f32 v18, v104, v20, v18
    v_fma_f32 v19, v104, v21, v19
    v_fma_f32 v18, -v105, v21, v18
    v_fma_f32 v19, v105, v20, v19
    v_fma_f32 v106, v104, v18, v16
    v_fma_f32 v107, v104, v19, v17
    v_fma_f32 v106, -v105, v19, v106
    v_fma_f32 v107, v105, v18, v107
K2J1_SH0:
    s_nop 1
    v_mov_b32_dpp v110, v106 quad_perm:[0,0,0,0] row_mask:0xf bank_mask:0xf
    v_mov_b32_dpp v111, v107 quad_perm:[0,0,0,0] row_mask:0xf bank_mask:0xf
    v_mov_b32_dpp v108, v106 quad_perm:[1,1,1,1] row_mask:0xf bank_mask:0xf
    v_mov_b32_dpp v109, v107 quad_perm:[1,1,1,1] row_mask:0xf bank_mask:0xf
    v_fma_f32 v112, v102, v110, v108
    v_fma_f32 v113, v102, v111, v109
    v_fma_f32 v112, -v103, v111, v112
    v_fma_f32 v113, v103, v110, v113
    v_mov_b32_dpp v108, v106 quad_perm:[2,2,2,2] row_mask:0xf bank_mask:0xf
    v_mov_b32_dpp v109, v107 quad_perm:[2,2,2,2] row_mask:0xf bank_mask:0xf
    v_fma_f32 v110, v102, v112, v108
    v_fma_f32 v111, v102, v113, v109
    v_fma_f32 v110, -v103, v113, v110
    v_fma_f32 v111, v103, v112, v111
    v_mov_b32_dpp v108, v106 quad_perm:[3,3,3,3] row_mask:0xf bank_mask:0xf
    v_mov_b32_dpp v109, v107 quad_perm:[3,3,3,3] row_mask:0xf bank_mask:0xf
    v_fma_f32 v112, v102, v110, v108
    v_fma_f32 v113, v102, v111, v109
    v_fma_f32 v112, -v103, v111, v112
    v_fma_f32 v113, v103, v110, v113
    v_mov_b32_dpp v108, v80 quad_perm:[0,0,0,0] row_mask:0xf bank_mask:0xf
    v_mov_b32_dpp v109, v81 quad_perm:[0,0,0,0] row_mask:0xf bank_mask:0xf
    v_fma_f32 v16, v102, v112, v108
    v_fma_f32 v17, v102, v113, v109
    v_fma_f32 v16, -v103, v113, v16
    v_fma_f32 v17, v103, v112, v17
    v_mov_b32_dpp v108, v80 quad_perm:[1,1,1,1] row_mask:0xf bank_mask:0xf
    v_mov_b32_dpp v109, v81 quad_perm:[1,1,1,1] row_mask:0xf bank_mask:0xf
    v_fma_f32 v18, v102, v16, v108
    v_fma_f32 v19, v102, v17, v109
    v_fma_f32 v18, -v103, v17, v18
    v_fma_f32 v19, v103, v16, v19
    v_mov_b32_dpp v108, v80 quad_perm:[2,2,2,2] row_mask:0xf bank_mask:0xf
    v_mov_b32_dpp v109, v81 quad_perm:[2,2,2,2] row_mask:0xf bank_mask:0xf
    v_fma_f32 v20, v102, v18, v108
    v_fma_f32 v21, v102, v19, v109
    v_fma_f32 v20, -v103, v19, v20
    v_fma_f32 v21, v103, v18, v21
    s_mov_b32 s34, 0xeeeeeeee
    s_mov_b32 s35, 0xeeeeeeee
    v_cndmask_b32 v112, v112, v16, s[34:35]
    v_cndmask_b32 v113, v113, v17, s[34:35]
    s_mov_b32 s34, 0xcccccccc
    s_mov_b32 s35, 0xcccccccc
    v_cndmask_b32 v112, v112, v18, s[34:35]
    v_cndmask_b32 v113, v113, v19, s[34:35]
    s_mov_b32 s34, 0x88888888
    s_mov_b32 s35, 0x88888888
    v_cndmask_b32 v112, v112, v20, s[34:35]
    v_cndmask_b32 v113, v113, v21, s[34:35]
    v_lshlrev_b32 v108, 16, v84
    v_lshlrev_b32 v109, 16, v92
    v_fma_f32 v24, v82, v112, v108
    v_fma_f32 v40, v82, v113, v109
    v_fma_f32 v24, -v83, v113, v24
    v_fma_f32 v40, v83, v112, v40
    v_and_b32 v108, 0xffff0000, v84
    v_and_b32 v109, 0xffff0000, v92
    v_fma_f32 v25, v82, v24, v108
    v_fma_f32 v41, v82, v40, v109
    v_fma_f32 v25, -v83, v40, v25
    v_fma_f32 v41, v83, v24, v41
    v_lshlrev_b32 v108, 16, v85
    v_lshlrev_b32 v109, 16, v93
    v_fma_f32 v26, v82, v25, v108
    v_fma_f32 v42, v82, v41, v109
    v_fma_f32 v26, -v83, v41, v26
    v_fma_f32 v42, v83, v25, v42
    v_and_b32 v108, 0xffff0000, v85
    v_and_b32 v109, 0xffff0000, v93
    v_fma_f32 v27, v82, v26, v108
    v_fma_f32 v43, v82, v42, v109
    v_fma_f32 v27, -v83, v42, v27
    v_fma_f32 v43, v83, v26, v43
    v_lshlrev_b32 v108, 16, v86
    v_lshlrev_b32 v109, 16, v94
    v_fma_f32 v28, v82, v27, v108
    v_fma_f32 v44, v82, v43, v109
    v_fma_f32 v28, -v83, v43, v28
    v_fma_f32 v44, v83, v27, v44
    v_and_b32 v108, 0xffff0000, v86
    v_and_b32 v109, 0xffff0000, v94
    v_fma_f32 v29, v82, v28, v108
    v_fma_f32 v45, v82, v44, v109
    v_fma_f32 v29, -v83, v44, v29
    v_fma_f32 v45, v83, v28, v45
    v_lshlrev_b32 v108, 16, v87
    v_lshlrev_b32 v109, 16, v95
    v_fma_f32 v30, v82, v29, v108
    v_fma_f32 v46, v82, v45, v109
    v_fma_f32 v30, -v83, v45, v30
    v_fma_f32 v46, v83, v29, v46
    v_and_b32 v108, 0xffff0000, v87
    v_and_b32 v109, 0xffff0000, v95
    v_fma_f32 v31, v82, v30, v108
    v_fma_f32 v47, v82, v46, v109
    v_fma_f32 v31, -v83, v46, v31
    v_fma_f32 v47, v83, v30, v47
    v_lshlrev_b32 v108, 16, v88
    v_lshlrev_b32 v109, 16, v96
    v_fma_f32 v32, v82, v31, v108
    v_fma_f32 v48, v82, v47, v109
    v_fma_f32 v32, -v83, v47, v32
    v_fma_f32 v48, v83, v31, v48
    v_and_b32 v108, 0xffff0000, v88
    v_and_b32 v109, 0xffff0000, v96
    v_fma_f32 v33, v82, v32, v108
    v_fma_f32 v49, v82, v48, v109
    v_fma_f32 v33, -v83, v48, v33
    v_fma_f32 v49, v83, v32, v49
    v_lshlrev_b32 v108, 16, v89
    v_lshlrev_b32 v109, 16, v97
    v_fma_f32 v34, v82, v33, v108
    v_fma_f32 v50, v82, v49, v109
    v_fma_f32 v34, -v83, v49, v34
    v_fma_f32 v50, v83, v33, v50
    v_and_b32 v108, 0xffff0000, v89
    v_and_b32 v109, 0xffff0000, v97
    v_fma_f32 v35, v82, v34, v108
    v_fma_f32 v51, v82, v50, v109
    v_fma_f32 v35, -v83, v50, v35
    v_fma_f32 v51, v83, v34, v51
    v_lshlrev_b32 v108, 16, v90
    v_lshlrev_b32 v109, 16, v98
    v_fma_f32 v36, v82, v35, v108
    v_fma_f32 v52, v82, v51, v109
    v_fma_f32 v36, -v83, v51, v36
    v_fma_f32 v52, v83, v35, v52
    v_and_b32 v108, 0xffff0000, v90
    v_and_b32 v109, 0xffff0000, v98
    v_fma_f32 v37, v82, v36, v108
    v_fma_f32 v53, v82, v52, v109
    v_fma_f32 v37, -v83, v52, v37
    v_fma_f32 v53, v83, v36, v53
    v_lshlrev_b32 v108, 16, v91
    v_lshlrev_b32 v109, 16, v99
    v_fma_f32 v38, v82, v37, v108
    v_fma_f32 v54, v82, v53, v109
    v_fma_f32 v38, -v83, v53, v38
    v_fma_f32 v54, v83, v37, v54
    v_and_b32 v108, 0xffff0000, v91
    v_and_b32 v109, 0xffff0000, v99
    v_fma_f32 v39, v82, v38, v108
    v_fma_f32 v55, v82, v54, v109
    v_fma_f32 v39, -v83, v54, v39
    v_fma_f32 v55, v83, v38, v55
    v_cvt_pk_bf16_f32 v84, v24, v25
    v_cvt_pk_bf16_f32 v85, v26, v27
    v_cvt_pk_bf16_f32 v86, v28, v29
    v_cvt_pk_bf16_f32 v87, v30, v31
    v_cvt_pk_bf16_f32 v88, v32, v33
    v_cvt_pk_bf16_f32 v89, v34, v35
    v_cvt_pk_bf16_f32 v90, v36, v37
    v_cvt_pk_bf16_f32 v91, v38, v39
    v_cvt_pk_bf16_f32 v92, v40, v41
    v_cvt_pk_bf16_f32 v93, v42, v43
    v_cvt_pk_bf16_f32 v94, v44, v45
    v_cvt_pk_bf16_f32 v95, v46, v47
    v_cvt_pk_bf16_f32 v96, v48, v49
    v_cvt_pk_bf16_f32 v97, v50, v51
    v_cvt_pk_bf16_f32 v98, v52, v53
    v_cvt_pk_bf16_f32 v99, v54, v55
    s_add_u32 s34, s32, 0
    buffer_store_dwordx4 v[84:87], v14, s[8:11], s34 offen sc1
    buffer_store_dwordx4 v[88:91], v14, s[8:11], s34 offen offset:16 sc1
    s_add_u32 s34, s32, 73728
    buffer_store_dwordx4 v[92:95], v14, s[8:11], s34 offen sc1
    buffer_store_dwordx4 v[96:99], v14, s[8:11], s34 offen offset:16 sc1
K2_JWAIT:
    s_waitcnt vmcnt(0)
K2_JEND:
    s_lshl_b32 s34, s23, 7
    s_add_u32 s34, s34, 16232448
    v_mov_b32 v140, 0
    v_mov_b32 v141, 1
    s_mov_b64 exec, 1
    buffer_atomic_add v141, v140, s[8:11], s34 offen sc1
    s_mov_b64 exec, -1
    s_setprio 0
    s_load_dwordx2 s[12:13], s[0:1], 88
    s_load_dwordx2 s[16:17], s[0:1], 0
    s_load_dwordx2 s[20:21], s[0:1], 64
    s_load_dwordx2 s[24:25], s[0:1], 104
    s_mov_b32 s14, 663552
    s_mov_b32 s15, 0x00020000
    s_mov_b32 s18, 2359296
    s_mov_b32 s19, 0x00020000
    s_mov_b32 s22, 1152
    s_mov_b32 s23, 0x00020000
    s_mov_b32 s26, 4718592
    s_mov_b32 s27, 0x00020000
    s_mov_b32 s6, s4
    s_lshr_b32 s7, s2, 5
    s_add_u32 s46, s6, s7
    s_mul_i32 s47, s46, 7282
    s_lshr_b32 s47, s47, 16
    s_mul_i32 s47, s47, 9
    s_sub_u32 s42, s46, s47
    s_lshl_b32 s41, s42, 1
    s_mov_b32 s34, 0
    s_mov_b32 s35, 0
    s_mov_b32 s36, 4096
    s_mov_b32 s37, 8192
    s_mov_b32 s38, 12288
    s_mov_b32 s39, 16384
    s_cmp_eq_u32 s3, 1
    s_cbranch_scc1 K3_L1
    s_cmp_eq_u32 s3, 2
    s_cbranch_scc1 K3_L2
    s_cmp_eq_u32 s3, 3
    s_cbranch_scc1 K3_L3
K3_L0:
    s_mul_i32 s30, s6, 147456
    s_add_u32 s30, s30, 7217152
    s_mul_i32 s31, s6, 73728
    s_add_u32 s31, s31, 13871104
    v_add_u32 v15, 124928, v7
    s_waitcnt lgkmcnt(0)
    s_mov_b32 s47, 497664
    buffer_load_dwordx4 v[16:19], v8, s[12:15], s47 offen
    buffer_load_dwordx4 v[20:23], v9, s[12:15], s47 offen
    buffer_load_dwordx4 v[24:27], v10, s[12:15], s47 offen
    s_mov_b32 s47, 580608
    buffer_load_dwordx4 v[28:31], v8, s[12:15], s47 offen
    buffer_load_dwordx4 v[32:35], v9, s[12:15], s47 offen
    buffer_load_dwordx4 v[36:39], v10, s[12:15], s47 offen
    s_mov_b32 s47, 0
    buffer_load_dwordx4 v[40:43], v156, s[12:15], s47 offen
    buffer_load_dwordx4 v[44:47], v157, s[12:15], s47 offen
    buffer_load_dwordx4 v[48:51], v158, s[12:15], s47 offen
    s_mov_b32 s35, 65536
K23_PWr0:
    ds_read_b32 v163, v162 offset:44
    s_waitcnt lgkmcnt(0)
    v_cmp_eq_u32 vcc, 8, v163
    s_cbranch_vccnz K23_QWr0
    s_sleep 4
    s_sub_u32 s35, s35, 1
    s_cmp_lg_u32 s35, 0
    s_cbranch_scc1 K23_PWr0
K23_QWr0:
    s_mov_b64 exec, 3
    s_mov_b32 s35, 65536
K23_PY:
    buffer_load_dword v166, v164, s[8:11], 0 offen sc1
    s_waitcnt vmcnt(0)
    v_cmp_le_u32 vcc, v165, v166
    s_cmp_eq_u32 vcc_lo, 3
    s_cbranch_scc1 K23_QY
    s_sleep 8
    s_sub_u32 s35, s35, 1
    s_cmp_lg_u32 s35, 0
    s_cbranch_scc1 K23_PY
K23_QY:
    s_mov_b64 exec, -1
    v_mov_b32 v163, 1
    ds_write_b32 v162, v163 offset:0
    s_lshl_b32 s46, s41, 13
    s_add_u32 s46, s46, s30
    s_lshl_b32 s47, s41, 7
    s_cmp_ge_u32 s41, 9
    s_cselect_b32 s48, 662400, 0
    s_add_u32 s47, s47, s48
    s_add_u32 s47, s47, 12544000
    s_add_u32 s41, s41, 1
    s_cmp_eq_u32 s41, 18
    s_cselect_b32 s41, 0, s41
    s_mov_b32 m0, 0
    s_nop 0
    buffer_load_dwordx4 v2, s[8:11], s46 offen sc1 lds
    s_mov_b32 m0, 1024
    s_nop 0
    buffer_load_dwordx4 v3, s[8:11], s46 offen sc1 lds
    s_mov_b32 m0, 8192
    s_nop 0
    buffer_load_dwordx4 v4, s[8:11], s47 offen sc1 lds
    s_mov_b32 m0, 9216
    s_nop 0
    buffer_load_dwordx4 v5, s[8:11], s47 offen sc1 lds
    s_lshl_b32 s46, s41, 13
    s_add_u32 s46, s46, s30
    s_lshl_b32 s47, s41, 7
    s_cmp_ge_u32 s41, 9
    s_cselect_b32 s48, 662400, 0
    s_add_u32 s47, s47, s48
    s_add_u32 s47, s47, 12544000
    s_add_u32 s41, s41, 1
    s_cmp_eq_u32 s41, 18
    s_cselect_b32 s41, 0, s41
    s_mov_b32 m0, 17408
    s_nop 0
    buffer_load_dwordx4 v2, s[8:11], s46 offen sc1 lds
    s_mov_b32 m0, 18432
    s_nop 0
    buffer_load_dwordx4 v3, s[8:11], s46 offen sc1 lds
    s_mov_b32 m0, 25600
    s_nop 0
    buffer_load_dwordx4 v4, s[8:11], s47 offen sc1 lds
    s_mov_b32 m0, 26624
    s_nop 0
    buffer_load_dwordx4 v5, s[8:11], s47 offen sc1 lds
    s_lshl_b32 s46, s41, 13
    s_add_u32 s46, s46, s30
    s_lshl_b32 s47, s41, 7
    s_cmp_ge_u32 s41, 9
    s_cselect_b32 s48, 662400, 0
    s_add_u32 s47, s47, s48
    s_add_u32 s47, s47, 12544000
    s_add_u32 s41, s41, 1
    s_cmp_eq_u32 s41, 18
    s_cselect_b32 s41, 0, s41
    s_mov_b32 m0, 34816
    s_nop 0
    buffer_load_dwordx4 v2, s[8:11], s46 offen sc1 lds
    s_mov_b32 m0, 35840
    s_nop 0
    buffer_load_dwordx4 v3, s[8:11], s46 offen sc1 lds
    s_mov_b32 m0, 43008
    s_nop 0
    buffer_load_dwordx4 v4, s[8:11], s47 offen sc1 lds
    s_mov_b32 m0, 44032
    s_nop 0
    buffer_load_dwordx4 v5, s[8:11], s47 offen sc1 lds
    s_lshl_b32 s46, s41, 13
    s_add_u32 s46, s46, s30
    s_lshl_b32 s47, s41, 7
    s_cmp_ge_u32 s41, 9
    s_cselect_b32 s48, 662400, 0
    s_add_u32 s47, s47, s48
    s_add_u32 s47, s47, 12544000
    s_add_u32 s41, s41, 1
    s_cmp_eq_u32 s41, 18
    s_cselect_b32 s41, 0, s41
    s_mov_b32 m0, 52224
    s_nop 0
    buffer_load_dwordx4 v2, s[8:11], s46 offen sc1 lds
    s_mov_b32 m0, 53248
    s_nop 0
    buffer_load_dwordx4 v3, s[8:11], s46 offen sc1 lds
    s_mov_b32 m0, 60416
    s_nop 0
    buffer_load_dwordx4 v4, s[8:11], s47 offen sc1 lds
    s_mov_b32 m0, 61440
    s_nop 0
    buffer_load_dwordx4 v5, s[8:11], s47 offen sc1 lds
    s_lshl_b32 s46, s41, 13
    s_add_u32 s46, s46, s30
    s_lshl_b32 s47, s41, 7
    s_cmp_ge_u32 s41, 9
    s_cselect_b32 s48, 662400, 0
    s_add_u32 s47, s47, s48
    s_add_u32 s47, s47, 12544000
    s_add_u32 s41, s41, 1
    s_cmp_eq_u32 s41, 18
    s_cselect_b32 s41, 0, s41
    buffer_load_dwordx4 v[52:55], v2, s[8:11], s46 offen sc1
    buffer_load_dwordx4 v[56:59], v3, s[8:11], s46 offen sc1
    buffer_load_dwordx4 v[60:63], v4, s[8:11], s47 offen sc1
    buffer_load_dwordx4 v[64:67], v5, s[8:11], s47 offen sc1
    s_lshl_b32 s46, s41, 13
    s_add_u32 s46, s46, s30
    s_lshl_b32 s47, s41, 7
    s_cmp_ge_u32 s41, 9
    s_cselect_b32 s48, 662400, 0
    s_add_u32 s47, s47, s48
    s_add_u32 s47, s47, 12544000
    s_add_u32 s41, s41, 1
    s_cmp_eq_u32 s41, 18
    s_cselect_b32 s41, 0, s41
    buffer_load_dwordx4 v[68:71], v2, s[8:11], s46 offen sc1
    buffer_load_dwordx4 v[72:75], v3, s[8:11], s46 offen sc1
    buffer_load_dwordx4 v[76:79], v4, s[8:11], s47 offen sc1
    buffer_load_dwordx4 v[80:83], v5, s[8:11], s47 offen sc1
    s_lshl_b32 s46, s41, 13
    s_add_u32 s46, s46, s30
    s_lshl_b32 s47, s41, 7
    s_cmp_ge_u32 s41, 9
    s_cselect_b32 s48, 662400, 0
    s_add_u32 s47, s47, s48
    s_add_u32 s47, s47, 12544000
    s_add_u32 s41, s41, 1
    s_cmp_eq_u32 s41, 18
    s_cselect_b32 s41, 0, s41
    buffer_load_dwordx4 v[84:87], v2, s[8:11], s46 offen sc1
    buffer_load_dwordx4 v[88:91], v3, s[8:11], s46 offen sc1
    buffer_load_dwordx4 v[92:95], v4, s[8:11], s47 offen sc1
    buffer_load_dwordx4 v[96:99], v5, s[8:11], s47 offen sc1
    s_lshl_b32 s46, s41, 13
    s_add_u32 s46, s46, s30
    s_lshl_b32 s47, s41, 7
    s_cmp_ge_u32 s41, 9
    s_cselect_b32 s48, 662400, 0
    s_add_u32 s47, s47, s48
    s_add_u32 s47, s47, 12544000
    s_add_u32 s41, s41, 1
    s_cmp_eq_u32 s41, 18
    s_cselect_b32 s41, 0, s41
    buffer_load_dwordx4 v[100:103], v2, s[8:11], s46 offen sc1
    buffer_load_dwordx4 v[104:107], v3, s[8:11], s46 offen sc1
    buffer_load_dwordx4 v[108:111], v4, s[8:11], s47 offen sc1
    buffer_load_dwordx4 v[112:115], v5, s[8:11], s47 offen sc1
    s_lshl_b32 s46, s41, 13
    s_add_u32 s46, s46, s30
    s_lshl_b32 s47, s41, 7
    s_cmp_ge_u32 s41, 9
    s_cselect_b32 s48, 662400, 0
    s_add_u32 s47, s47, s48
    s_add_u32 s47, s47, 12544000
    s_add_u32 s41, s41, 1
    s_cmp_eq_u32 s41, 18
    s_cselect_b32 s41, 0, s41
    buffer_load_dwordx4 v[116:119], v2, s[8:11], s46 offen sc1
    buffer_load_dwordx4 v[120:123], v3, s[8:11], s46 offen sc1
    buffer_load_dwordx4 v[124:127], v4, s[8:11], s47 offen sc1
    buffer_load_dwordx4 v[128:131], v5, s[8:11], s47 offen sc1
    s_lshl_b32 s46, s41, 13
    s_add_u32 s46, s46, s30
    s_lshl_b32 s47, s41, 7
    s_cmp_ge_u32 s41, 9
    s_cselect_b32 s48, 662400, 0
    s_add_u32 s47, s47, s48
    s_add_u32 s47, s47, 12544000
    s_add_u32 s41, s41, 1
    s_cmp_eq_u32 s41, 18
    s_cselect_b32 s41, 0, s41
    buffer_load_dwordx4 v[132:135], v2, s[8:11], s46 offen sc1
    buffer_load_dwordx4 v[136:139], v3, s[8:11], s46 offen sc1
    buffer_load_dwordx4 v[140:143], v4, s[8:11], s47 offen sc1
    buffer_load_dwordx4 v[144:147], v5, s[8:11], s47 offen sc1
    s_mov_b32 s35, 65536
K23_PWa0:
    ds_read_b32 v163, v162 offset:52
    s_waitcnt lgkmcnt(0)
    v_cmp_eq_u32 vcc, 8, v163
    s_cbranch_vccnz K23_QWa0
    s_sleep 4
    s_sub_u32 s35, s35, 1
    s_cmp_lg_u32 s35, 0
    s_cbranch_scc1 K23_PWa0
K23_QWa0:
    s_waitcnt vmcnt(24)
    s_mov_b32 s47, 0
    s_mov_b32 m0, 69632
    s_nop 0
    buffer_load_dwordx4 v8, s[12:15], s47 offen lds
    s_mov_b32 m0, 70656
    s_nop 0
    buffer_load_dwordx4 v9, s[12:15], s47 offen lds
    s_mov_b32 m0, 77824
    s_nop 0
    buffer_load_dwordx4 v10, s[12:15], s47 offen lds
    s_mov_b32 s47, 82944
    s_mov_b32 m0, 78848
    s_nop 0
    buffer_load_dwordx4 v8, s[12:15], s47 offen lds
    s_mov_b32 m0, 79872
    s_nop 0
    buffer_load_dwordx4 v9, s[12:15], s47 offen lds
    s_mov_b32 m0, 87040
    s_nop 0
    buffer_load_dwordx4 v10, s[12:15], s47 offen lds
    s_mov_b32 s47, 165888
    s_mov_b32 m0, 88064
    s_nop 0
    buffer_load_dwordx4 v8, s[12:15], s47 offen lds
    s_mov_b32 m0, 89088
    s_nop 0
    buffer_load_dwordx4 v9, s[12:15], s47 offen lds
    s_mov_b32 m0, 96256
    s_nop 0
    buffer_load_dwordx4 v10, s[12:15], s47 offen lds
    s_mov_b32 s47, 248832
    s_mov_b32 m0, 97280
    s_nop 0
    buffer_load_dwordx4 v8, s[12:15], s47 offen lds
    s_mov_b32 m0, 98304
    s_nop 0
    buffer_load_dwordx4 v9, s[12:15], s47 offen lds
    s_mov_b32 m0, 105472
    s_nop 0
    buffer_load_dwordx4 v10, s[12:15], s47 offen lds
    s_mov_b32 s35, 65536
K23_PWb0:
    ds_read_b32 v163, v162 offset:56
    s_waitcnt lgkmcnt(0)
    v_cmp_eq_u32 vcc, 8, v163
    s_cbranch_vccnz K23_QWb0
    s_sleep 4
    s_sub_u32 s35, s35, 1
    s_cmp_lg_u32 s35, 0
    s_cbranch_scc1 K23_PWb0
K23_QWb0:
    s_mov_b32 s47, 331776
    s_mov_b32 m0, 106496
    s_nop 0
    buffer_load_dwordx4 v8, s[12:15], s47 offen lds
    s_mov_b32 m0, 107520
    s_nop 0
    buffer_load_dwordx4 v9, s[12:15], s47 offen lds
    s_mov_b32 m0, 114688
    s_nop 0
    buffer_load_dwordx4 v10, s[12:15], s47 offen lds
    s_mov_b32 s47, 414720
    s_mov_b32 m0, 115712
    s_nop 0
    buffer_load_dwordx4 v8, s[12:15], s47 offen lds
    s_mov_b32 m0, 116736
    s_nop 0
    buffer_load_dwordx4 v9, s[12:15], s47 offen lds
    s_mov_b32 m0, 123904
    s_nop 0
    buffer_load_dwordx4 v10, s[12:15], s47 offen lds
    s_mov_b32 s34, 0
    s_mov_b32 s35, 0
    s_mov_b32 s36, 4096
    s_mov_b32 s37, 8192
    s_mov_b32 s38, 12288
    s_mov_b32 s39, 16384
    s_barrier
    ds_write_b128 v15, v[16:19] offset:0
    ds_write_b128 v15, v[20:23] offset:1024
    ds_write_b128 v15, v[24:27] offset:8192
    s_barrier
    ds_write_b128 v15, v[28:31] offset:9216
    ds_write_b128 v15, v[32:35] offset:10240
    ds_write_b128 v15, v[36:39] offset:17408
    s_waitcnt vmcnt(38)
    s_waitcnt lgkmcnt(3)
    ds_write_b128 v7, v[52:55] offset:0
    ds_write_b128 v7, v[56:59] offset:1024
    ds_write_b128 v7, v[60:63] offset:8192
    ds_write_b128 v7, v[64:67] offset:9216
    s_barrier
    ds_write_b128 v15, v[40:43] offset:18432
    ds_write_b128 v15, v[44:47] offset:19456
    ds_write_b128 v15, v[48:51] offset:26624
    s_waitcnt vmcnt(34)
    s_waitcnt lgkmcnt(3)
    s_lshl_b32 s46, s41, 13
    s_add_u32 s46, s46, s30
    s_lshl_b32 s47, s41, 7
    s_cmp_ge_u32 s41, 9
    s_cselect_b32 s48, 662400, 0
    s_add_u32 s47, s47, s48
    s_add_u32 s47, s47, 12544000
    s_add_u32 s41, s41, 1
    s_cmp_eq_u32 s41, 18
    s_cselect_b32 s41, 0, s41
    buffer_load_dwordx4 v[52:55], v2, s[8:11], s46 offen sc1
    ds_write_b128 v7, v[68:71] offset:17408
    buffer_load_dwordx4 v[56:59], v3, s[8:11], s46 offen sc1
    ds_write_b128 v7, v[72:75] offset:18432
    buffer_load_dwordx4 v[60:63], v4, s[8:11], s47 offen sc1
    ds_write_b128 v7, v[76:79] offset:25600
    buffer_load_dwordx4 v[64:67], v5, s[8:11], s47 offen sc1
    ds_write_b128 v7, v[80:83] offset:26624
    s_barrier
    s_waitcnt vmcnt(34)
    s_waitcnt lgkmcnt(0)
    s_lshl_b32 s46, s41, 13
    s_add_u32 s46, s46, s30
    s_lshl_b32 s47, s41, 7
    s_cmp_ge_u32 s41, 9
    s_cselect_b32 s48, 662400, 0
    s_add_u32 s47, s47, s48
    s_add_u32 s47, s47, 12544000
    s_add_u32 s41, s41, 1
    s_cmp_eq_u32 s41, 18
    s_cselect_b32 s41, 0, s41
    buffer_load_dwordx4 v[68:71], v2, s[8:11], s46 offen sc1
    ds_write_b128 v7, v[84:87] offset:34816
    buffer_load_dwordx4 v[72:75], v3, s[8:11], s46 offen sc1
    ds_write_b128 v7, v[88:91] offset:35840
    buffer_load_dwordx4 v[76:79], v4, s[8:11], s47 offen sc1
    ds_write_b128 v7, v[92:95] offset:43008
    buffer_load_dwordx4 v[80:83], v5, s[8:11], s47 offen sc1
    ds_write_b128 v7, v[96:99] offset:44032
    s_barrier
    s_waitcnt vmcnt(34)
    s_waitcnt lgkmcnt(0)
    s_lshl_b32 s46, s41, 13
    s_add_u32 s46, s46, s30
    s_lshl_b32 s47, s41, 7
    s_cmp_ge_u32 s41, 9
    s_cselect_b32 s48, 662400, 0
    s_add_u32 s47, s47, s48
    s_add_u32 s47, s47, 12544000
    s_add_u32 s41, s41, 1
    s_cmp_eq_u32 s41, 18
    s_cselect_b32 s41, 0, s41
    buffer_load_dwordx4 v[84:87], v2, s[8:11], s46 offen sc1
    ds_write_b128 v7, v[100:103] offset:52224
    buffer_load_dwordx4 v[88:91], v3, s[8:11], s46 offen sc1
    ds_write_b128 v7, v[104:107] offset:53248
    buffer_load_dwordx4 v[92:95], v4, s[8:11], s47 offen sc1
    ds_write_b128 v7, v[108:111] offset:60416
    buffer_load_dwordx4 v[96:99], v5, s[8:11], s47 offen sc1
    ds_write_b128 v7, v[112:115] offset:61440
    s_barrier
    s_waitcnt vmcnt(34)
    s_waitcnt lgkmcnt(0)
    s_lshl_b32 s46, s41, 13
    s_add_u32 s46, s46, s30
    s_lshl_b32 s47, s41, 7
    s_cmp_ge_u32 s41, 9
    s_cselect_b32 s48, 662400, 0
    s_add_u32 s47, s47, s48
    s_add_u32 s47, s47, 12544000
    s_add_u32 s41, s41, 1
    s_cmp_eq_u32 s41, 18
    s_cselect_b32 s41, 0, s41
    buffer_load_dwordx4 v[100:103], v2, s[8:11], s46 offen sc1
    ds_write_b128 v7, v[116:119] offset:0
    buffer_load_dwordx4 v[104:107], v3, s[8:11], s46 offen sc1
    ds_write_b128 v7, v[120:123] offset:1024
    buffer_load_dwordx4 v[108:111], v4, s[8:11], s47 offen sc1
    ds_write_b128 v7, v[124:127] offset:8192
    buffer_load_dwordx4 v[112:115], v5, s[8:11], s47 offen sc1
    ds_write_b128 v7, v[128:131] offset:9216
    s_barrier
    s_waitcnt vmcnt(34)
    s_waitcnt lgkmcnt(0)
    s_lshl_b32 s46, s41, 13
    s_add_u32 s46, s46, s30
    s_lshl_b32 s47, s41, 7
    s_cmp_ge_u32 s41, 9
    s_cselect_b32 s48, 662400, 0
    s_add_u32 s47, s47, s48
    s_add_u32 s47, s47, 12544000
    s_add_u32 s41, s41, 1
    s_cmp_eq_u32 s41, 18
    s_cselect_b32 s41, 0, s41
    buffer_load_dwordx4 v[116:119], v2, s[8:11], s46 offen sc1
    ds_write_b128 v7, v[132:135] offset:17408
    buffer_load_dwordx4 v[120:123], v3, s[8:11], s46 offen sc1
    ds_write_b128 v7, v[136:139] offset:18432
    buffer_load_dwordx4 v[124:127], v4, s[8:11], s47 offen sc1
    ds_write_b128 v7, v[140:143] offset:25600
    buffer_load_dwordx4 v[128:131], v5, s[8:11], s47 offen sc1
    ds_write_b128 v7, v[144:147] offset:26624
    s_barrier
    s_waitcnt lgkmcnt(0)
    s_lshl_b32 s46, s41, 13
    s_add_u32 s46, s46, s30
    s_lshl_b32 s47, s41, 7
    s_cmp_ge_u32 s41, 9
    s_cselect_b32 s48, 662400, 0
    s_add_u32 s47, s47, s48
    s_add_u32 s47, s47, 12544000
    s_add_u32 s41, s41, 1
    s_cmp_eq_u32 s41, 18
    s_cselect_b32 s41, 0, s41
    buffer_load_dwordx4 v[132:135], v2, s[8:11], s46 offen sc1
    buffer_load_dwordx4 v[136:139], v3, s[8:11], s46 offen sc1
    buffer_load_dwordx4 v[140:143], v4, s[8:11], s47 offen sc1
    buffer_load_dwordx4 v[144:147], v5, s[8:11], s47 offen sc1
    s_barrier
    s_waitcnt vmcnt(20)
    ds_write_b128 v7, v[52:55] offset:34816
    ds_write_b128 v7, v[56:59] offset:35840
    ds_write_b128 v7, v[60:63] offset:43008
    ds_write_b128 v7, v[64:67] offset:44032
    s_barrier
    s_waitcnt vmcnt(16)
    s_waitcnt lgkmcnt(0)
    s_lshl_b32 s46, s41, 13
    s_add_u32 s46, s46, s30
    s_lshl_b32 s47, s41, 7
    s_cmp_ge_u32 s41, 9
    s_cselect_b32 s48, 662400, 0
    s_add_u32 s47, s47, s48
    s_add_u32 s47, s47, 12544000
    s_add_u32 s41, s41, 1
    s_cmp_eq_u32 s41, 18
    s_cselect_b32 s41, 0, s41
    buffer_load_dwordx4 v[52:55], v2, s[8:11], s46 offen sc1
    ds_write_b128 v7, v[68:71] offset:52224
    buffer_load_dwordx4 v[56:59], v3, s[8:11], s46 offen sc1
    ds_write_b128 v7, v[72:75] offset:53248
    buffer_load_dwordx4 v[60:63], v4, s[8:11], s47 offen sc1
    ds_write_b128 v7, v[76:79] offset:60416
    buffer_load_dwordx4 v[64:67], v5, s[8:11], s47 offen sc1
    ds_write_b128 v7, v[80:83] offset:61440
    s_barrier
    s_waitcnt vmcnt(16)
    s_waitcnt lgkmcnt(0)
    s_lshl_b32 s46, s41, 13
    s_add_u32 s46, s46, s30
    s_lshl_b32 s47, s41, 7
    s_cmp_ge_u32 s41, 9
    s_cselect_b32 s48, 662400, 0
    s_add_u32 s47, s47, s48
    s_add_u32 s47, s47, 12544000
    s_add_u32 s41, s41, 1
    s_cmp_eq_u32 s41, 18
    s_cselect_b32 s41, 0, s41
    buffer_load_dwordx4 v[68:71], v2, s[8:11], s46 offen sc1
    ds_write_b128 v7, v[84:87] offset:0
    buffer_load_dwordx4 v[72:75], v3, s[8:11], s46 offen sc1
    ds_write_b128 v7, v[88:91] offset:1024
    buffer_load_dwordx4 v[76:79], v4, s[8:11], s47 offen sc1
    ds_write_b128 v7, v[92:95] offset:8192
    buffer_load_dwordx4 v[80:83], v5, s[8:11], s47 offen sc1
    ds_write_b128 v7, v[96:99] offset:9216
    s_barrier
    s_waitcnt vmcnt(16)
    s_waitcnt lgkmcnt(0)
    ds_write_b128 v7, v[100:103] offset:17408
    ds_write_b128 v7, v[104:107] offset:18432
    ds_write_b128 v7, v[108:111] offset:25600
    ds_write_b128 v7, v[112:115] offset:26624
    s_lshl_b32 s46, s6, 6
    s_add_u32 s46, s46, 0
    v_add_u32 v20, s46, v160
    v_mul_u32_u24 v16, 1152, v20
    s_mul_i32 s47, s7, 144
    v_lshl_add_u32 v21, v161, 3, s47
    v_add_u32 v16, v16, v21
    v_lshlrev_b32 v17, 2, v20
    v_mul_u32_u24 v18, 2304, v20
    v_lshl_add_u32 v18, v21, 1, v18
    v_mul_u32_u24 v19, 304, v160
    v_lshl_add_u32 v19, v161, 4, v19
    v_add_u32 v19, 0, v19
    v_mov_b32 v22, v21
    buffer_load_dwordx2 v[20:21], v22, s[20:23], 0 offen
    s_mov_b32 s47, 12525568
    buffer_load_dwordx2 v[22:23], v16, s[16:19], s34 offen offset:0
    buffer_load_dword v34, v17, s[8:11], s47 offen offset:0
    buffer_load_dwordx2 v[24:25], v16, s[16:19], s35 offen offset:3456
    buffer_load_dword v35, v17, s[8:11], s47 offen offset:12
    buffer_load_dwordx2 v[26:27], v16, s[16:19], s36 offen offset:2816
    buffer_load_dword v36, v17, s[8:11], s47 offen offset:24
    buffer_load_dwordx2 v[28:29], v16, s[16:19], s37 offen offset:2176
    buffer_load_dword v37, v17, s[8:11], s47 offen offset:36
    buffer_load_dwordx2 v[30:31], v16, s[16:19], s38 offen offset:1536
    buffer_load_dword v38, v17, s[8:11], s47 offen offset:48
    buffer_load_dwordx2 v[32:33], v16, s[16:19], s39 offen offset:896
    buffer_load_dword v39, v17, s[8:11], s47 offen offset:60
    s_barrier
    s_waitcnt vmcnt(25)
    s_waitcnt lgkmcnt(0)
    s_lshl_b32 s46, s42, 13
    s_add_u32 s46, s46, s31
    buffer_load_dwordx4 v[84:87], v7, s[8:11], s46 offen sc1
    ds_write_b128 v7, v[116:119] offset:34816
    buffer_load_dwordx4 v[88:91], v7, s[8:11], s46 offen offset:1024 sc1
    ds_write_b128 v7, v[120:123] offset:35840
    s_add_u32 s42, s42, 1
    s_cmp_eq_u32 s42, 9
    s_cselect_b32 s42, 0, s42
    s_lshl_b32 s46, s42, 13
    s_add_u32 s46, s46, s31
    buffer_load_dwordx4 v[92:95], v7, s[8:11], s46 offen sc1
    ds_write_b128 v7, v[124:127] offset:43008
    buffer_load_dwordx4 v[96:99], v7, s[8:11], s46 offen offset:1024 sc1
    ds_write_b128 v7, v[128:131] offset:44032
    s_add_u32 s42, s42, 1
    s_cmp_eq_u32 s42, 9
    s_cselect_b32 s42, 0, s42
    s_barrier
    s_waitcnt vmcnt(25)
    s_waitcnt lgkmcnt(0)
    s_lshl_b32 s46, s42, 13
    s_add_u32 s46, s46, s31
    buffer_load_dwordx4 v[100:103], v7, s[8:11], s46 offen sc1
    ds_write_b128 v7, v[132:135] offset:52224
    buffer_load_dwordx4 v[104:107], v7, s[8:11], s46 offen offset:1024 sc1
    ds_write_b128 v7, v[136:139] offset:53248
    s_add_u32 s42, s42, 1
    s_cmp_eq_u32 s42, 9
    s_cselect_b32 s42, 0, s42
    s_lshl_b32 s46, s42, 13
    s_add_u32 s46, s46, s31
    buffer_load_dwordx4 v[108:111], v7, s[8:11], s46 offen sc1
    ds_write_b128 v7, v[140:143] offset:60416
    buffer_load_dwordx4 v[112:115], v7, s[8:11], s46 offen offset:1024 sc1
    ds_write_b128 v7, v[144:147] offset:61440
    s_add_u32 s42, s42, 1
    s_cmp_eq_u32 s42, 9
    s_cselect_b32 s42, 0, s42
    s_barrier
    s_waitcnt vmcnt(25)
    s_waitcnt lgkmcnt(0)
    s_lshl_b32 s46, s42, 13
    s_add_u32 s46, s46, s31
    buffer_load_dwordx4 v[116:119], v7, s[8:11], s46 offen sc1
    ds_write_b128 v7, v[52:55] offset:0
    buffer_load_dwordx4 v[120:123], v7, s[8:11], s46 offen offset:1024 sc1
    ds_write_b128 v7, v[56:59] offset:1024
    s_add_u32 s42, s42, 1
    s_cmp_eq_u32 s42, 9
    s_cselect_b32 s42, 0, s42
    s_lshl_b32 s46, s42, 13
    s_add_u32 s46, s46, s31
    buffer_load_dwordx4 v[124:127], v7, s[8:11], s46 offen sc1
    ds_write_b128 v7, v[60:63] offset:8192
    buffer_load_dwordx4 v[128:131], v7, s[8:11], s46 offen offset:1024 sc1
    ds_write_b128 v7, v[64:67] offset:9216
    s_add_u32 s42, s42, 1
    s_cmp_eq_u32 s42, 9
    s_cselect_b32 s42, 0, s42
    s_barrier
    s_waitcnt vmcnt(25)
    s_waitcnt lgkmcnt(0)
    s_lshl_b32 s46, s42, 13
    s_add_u32 s46, s46, s31
    buffer_load_dwordx4 v[132:135], v7, s[8:11], s46 offen sc1
    ds_write_b128 v7, v[68:71] offset:17408
    buffer_load_dwordx4 v[136:139], v7, s[8:11], s46 offen offset:1024 sc1
    ds_write_b128 v7, v[72:75] offset:18432
    s_add_u32 s42, s42, 1
    s_cmp_eq_u32 s42, 9
    s_cselect_b32 s42, 0, s42
    s_lshl_b32 s46, s42, 13
    s_add_u32 s46, s46, s31
    buffer_load_dwordx4 v[140:143], v7, s[8:11], s46 offen sc1
    ds_write_b128 v7, v[76:79] offset:25600
    buffer_load_dwordx4 v[144:147], v7, s[8:11], s46 offen offset:1024 sc1
    ds_write_b128 v7, v[80:83] offset:26624
    s_add_u32 s42, s42, 1
    s_cmp_eq_u32 s42, 9
    s_cselect_b32 s42, 0, s42
    s_barrier
    s_waitcnt vmcnt(14)
    s_waitcnt lgkmcnt(0)
    s_lshl_b32 s46, s42, 13
    s_add_u32 s46, s46, s31
    buffer_load_dwordx4 v[52:55], v7, s[8:11], s46 offen sc1
    ds_write_b128 v7, v[84:87] offset:34816
    buffer_load_dwordx4 v[56:59], v7, s[8:11], s46 offen offset:1024 sc1
    ds_write_b128 v7, v[88:91] offset:35840
    s_add_u32 s42, s42, 1
    s_cmp_eq_u32 s42, 9
    s_cselect_b32 s42, 0, s42
    s_barrier
    s_waitcnt vmcnt(14)
    s_waitcnt lgkmcnt(0)
    ds_write_b128 v7, v[92:95] offset:52224
    ds_write_b128 v7, v[96:99] offset:53248
    s_barrier
    s_waitcnt vmcnt(12)
    s_waitcnt lgkmcnt(0)
    ds_write_b128 v7, v[100:103] offset:0
    ds_write_b128 v7, v[104:107] offset:1024
    s_barrier
    s_waitcnt vmcnt(10)
    s_waitcnt lgkmcnt(0)
    ds_write_b128 v7, v[108:111] offset:17408
    ds_write_b128 v7, v[112:115] offset:18432
    s_barrier
    s_waitcnt vmcnt(8)
    s_waitcnt lgkmcnt(0)
    ds_write_b128 v7, v[116:119] offset:34816
    ds_write_b128 v7, v[120:123] offset:35840
    s_barrier
    s_waitcnt vmcnt(6)
    s_waitcnt lgkmcnt(0)
    ds_write_b128 v7, v[124:127] offset:52224
    ds_write_b128 v7, v[128:131] offset:53248
    s_barrier
    s_waitcnt vmcnt(4)
    s_waitcnt lgkmcnt(0)
    ds_write_b128 v7, v[132:135] offset:0
    ds_write_b128 v7, v[136:139] offset:1024
    s_barrier
    s_waitcnt vmcnt(2)
    s_waitcnt lgkmcnt(0)
    ds_write_b128 v7, v[140:143] offset:17408
    ds_write_b128 v7, v[144:147] offset:18432
    s_barrier
    s_waitcnt vmcnt(0)
    s_waitcnt lgkmcnt(0)
    ds_write_b128 v7, v[52:55] offset:34816
    ds_write_b128 v7, v[56:59] offset:35840
    s_barrier
    s_waitcnt lgkmcnt(0)
    s_barrier
    s_waitcnt vmcnt(0)
    v_lshlrev_b32 v64, 16, v20
    v_and_b32 v65, 0xffff0000, v20
    v_lshlrev_b32 v66, 16, v21
    v_and_b32 v67, 0xffff0000, v21
    v_lshlrev_b32 v68, 16, v22
    v_and_b32 v69, 0xffff0000, v22
    v_lshlrev_b32 v70, 16, v23
    v_and_b32 v71, 0xffff0000, v23
    v_mul_f32 v68, v68, v64
    v_mul_f32 v69, v69, v65
    v_mul_f32 v70, v70, v66
    v_mul_f32 v71, v71, v67
    v_lshlrev_b32 v72, 16, v24
    v_and_b32 v73, 0xffff0000, v24
    v_lshlrev_b32 v74, 16, v25
    v_and_b32 v75, 0xffff0000, v25
    v_mul_f32 v72, v72, v64
    v_mul_f32 v73, v73, v65
    v_mul_f32 v74, v74, v66
    v_mul_f32 v75, v75, v67
    v_lshlrev_b32 v76, 16, v26
    v_and_b32 v77, 0xffff0000, v26
    v_lshlrev_b32 v78, 16, v27
    v_and_b32 v79, 0xffff0000, v27
    v_mul_f32 v76, v76, v64
    v_mul_f32 v77, v77, v65
    v_mul_f32 v78, v78, v66
    v_mul_f32 v79, v79, v67
    v_lshlrev_b32 v80, 16, v28
    v_and_b32 v81, 0xffff0000, v28
    v_lshlrev_b32 v82, 16, v29
    v_and_b32 v83, 0xffff0000, v29
    v_mul_f32 v80, v80, v64
    v_mul_f32 v81, v81, v65
    v_mul_f32 v82, v82, v66
    v_mul_f32 v83, v83, v67
    v_lshlrev_b32 v84, 16, v30
    v_and_b32 v85, 0xffff0000, v30
    v_lshlrev_b32 v86, 16, v31
    v_and_b32 v87, 0xffff0000, v31
    v_mul_f32 v84, v84, v64
    v_mul_f32 v85, v85, v65
    v_mul_f32 v86, v86, v66
    v_mul_f32 v87, v87, v67
    v_lshlrev_b32 v88, 16, v32
    v_and_b32 v89, 0xffff0000, v32
    v_lshlrev_b32 v90, 16, v33
    v_and_b32 v91, 0xffff0000, v33
    v_mul_f32 v88, v88, v64
    v_mul_f32 v89, v89, v65
    v_mul_f32 v90, v90, v66
    v_mul_f32 v91, v91, v67
    s_barrier
    s_mov_b32 exec_hi, 0x003fffff
    ds_read_b128 v[92:95], v19 offset:0
    ds_read_b128 v[96:99], v19 offset:912
    ds_read_b128 v[100:103], v19 offset:1824
    ds_read_b128 v[104:107], v19 offset:2736
    ds_read_b128 v[108:111], v19 offset:3648
    ds_read_b128 v[112:115], v19 offset:4560
    s_waitcnt lgkmcnt(5)
    v_fmac_f32 v92, v34, v68
    v_fmac_f32 v93, v34, v69
    v_fmac_f32 v94, v34, v70
    v_fmac_f32 v95, v34, v71
    s_mov_b32 s46, 0
    buffer_store_dwordx4 v[92:95], v18, s[24:27], s46 offen sc1
    s_waitcnt lgkmcnt(4)
    v_fmac_f32 v96, v35, v72
    v_fmac_f32 v97, v35, v73
    v_fmac_f32 v98, v35, v74
    v_fmac_f32 v99, v35, v75
    s_mov_b32 s46, 6912
    buffer_store_dwordx4 v[96:99], v18, s[24:27], s46 offen sc1
    s_waitcnt lgkmcnt(3)
    v_fmac_f32 v100, v36, v76
    v_fmac_f32 v101, v36, v77
    v_fmac_f32 v102, v36, v78
    v_fmac_f32 v103, v36, v79
    s_mov_b32 s46, 13824
    buffer_store_dwordx4 v[100:103], v18, s[24:27], s46 offen sc1
    s_waitcnt lgkmcnt(2)
    v_fmac_f32 v104, v37, v80
    v_fmac_f32 v105, v37, v81
    v_fmac_f32 v106, v37, v82
    v_fmac_f32 v107, v37, v83
    s_mov_b32 s46, 20736
    buffer_store_dwordx4 v[104:107], v18, s[24:27], s46 offen sc1
    s_waitcnt lgkmcnt(1)
    v_fmac_f32 v108, v38, v84
    v_fmac_f32 v109, v38, v85
    v_fmac_f32 v110, v38, v86
    v_fmac_f32 v111, v38, v87
    s_mov_b32 s46, 27648
    buffer_store_dwordx4 v[108:111], v18, s[24:27], s46 offen sc1
    s_mov_b32 exec_hi, 0
    s_mov_b32 exec_lo, 0x3ffff
    s_waitcnt lgkmcnt(0)
    v_fmac_f32 v112, v39, v88
    v_fmac_f32 v113, v39, v89
    v_fmac_f32 v114, v39, v90
    v_fmac_f32 v115, v39, v91
    s_mov_b32 s46, 34560
    buffer_store_dwordx4 v[112:115], v18, s[24:27], s46 offen sc1
    s_endpgm
K3_L1:
    s_mul_i32 s30, s6, 147456
    s_add_u32 s30, s30, 7217152
    s_mul_i32 s31, s6, 73728
    s_add_u32 s31, s31, 13873152
    v_add_u32 v15, 124928, v7
    s_waitcnt lgkmcnt(0)
    s_mov_b32 s47, 497664
    buffer_load_dwordx4 v[16:19], v8, s[12:15], s47 offen
    buffer_load_dwordx4 v[20:23], v9, s[12:15], s47 offen
    s_mov_b32 s47, 580608
    buffer_load_dwordx4 v[24:27], v8, s[12:15], s47 offen
    buffer_load_dwordx4 v[28:31], v9, s[12:15], s47 offen
    s_mov_b32 s47, 0
    buffer_load_dwordx4 v[32:35], v156, s[12:15], s47 offen
    buffer_load_dwordx4 v[36:39], v157, s[12:15], s47 offen
    s_mov_b32 s35, 65536
K23_PWr1:
    ds_read_b32 v163, v162 offset:44
    s_waitcnt lgkmcnt(0)
    v_cmp_eq_u32 vcc, 8, v163
    s_cbranch_vccnz K23_QWr1
    s_sleep 4
    s_sub_u32 s35, s35, 1
    s_cmp_lg_u32 s35, 0
    s_cbranch_scc1 K23_PWr1
K23_QWr1:
    s_mov_b32 s35, 65536
K23_PWg1:
    ds_read_b32 v163, v162 offset:0
    s_waitcnt lgkmcnt(0)
    v_cmp_eq_u32 vcc, 1, v163
    s_cbranch_vccnz K23_QWg1
    s_sleep 8
    s_sub_u32 s35, s35, 1
    s_cmp_lg_u32 s35, 0
    s_cbranch_scc1 K23_PWg1
K23_QWg1:
    s_lshl_b32 s46, s41, 13
    s_add_u32 s46, s46, s30
    s_lshl_b32 s47, s41, 7
    s_cmp_ge_u32 s41, 9
    s_cselect_b32 s48, 662400, 0
    s_add_u32 s47, s47, s48
    s_add_u32 s47, s47, 12544000
    s_add_u32 s41, s41, 1
    s_cmp_eq_u32 s41, 18
    s_cselect_b32 s41, 0, s41
    s_mov_b32 m0, 2048
    s_nop 0
    buffer_load_dwordx4 v2, s[8:11], s46 offen sc1 lds
    s_mov_b32 m0, 3072
    s_nop 0
    buffer_load_dwordx4 v3, s[8:11], s46 offen sc1 lds
    s_mov_b32 m0, 10240
    s_nop 0
    buffer_load_dwordx4 v4, s[8:11], s47 offen sc1 lds
    s_mov_b32 m0, 11264
    s_nop 0
    buffer_load_dwordx4 v5, s[8:11], s47 offen sc1 lds
    s_lshl_b32 s46, s41, 13
    s_add_u32 s46, s46, s30
    s_lshl_b32 s47, s41, 7
    s_cmp_ge_u32 s41, 9
    s_cselect_b32 s48, 662400, 0
    s_add_u32 s47, s47, s48
    s_add_u32 s47, s47, 12544000
    s_add_u32 s41, s41, 1
    s_cmp_eq_u32 s41, 18
    s_cselect_b32 s41, 0, s41
    s_mov_b32 m0, 19456
    s_nop 0
    buffer_load_dwordx4 v2, s[8:11], s46 offen sc1 lds
    s_mov_b32 m0, 20480
    s_nop 0
    buffer_load_dwordx4 v3, s[8:11], s46 offen sc1 lds
    s_mov_b32 m0, 27648
    s_nop 0
    buffer_load_dwordx4 v4, s[8:11], s47 offen sc1 lds
    s_mov_b32 m0, 28672
    s_nop 0
    buffer_load_dwordx4 v5, s[8:11], s47 offen sc1 lds
    s_lshl_b32 s46, s41, 13
    s_add_u32 s46, s46, s30
    s_lshl_b32 s47, s41, 7
    s_cmp_ge_u32 s41, 9
    s_cselect_b32 s48, 662400, 0
    s_add_u32 s47, s47, s48
    s_add_u32 s47, s47, 12544000
    s_add_u32 s41, s41, 1
    s_cmp_eq_u32 s41, 18
    s_cselect_b32 s41, 0, s41
    s_mov_b32 m0, 36864
    s_nop 0
    buffer_load_dwordx4 v2, s[8:11], s46 offen sc1 lds
    s_mov_b32 m0, 37888
    s_nop 0
    buffer_load_dwordx4 v3, s[8:11], s46 offen sc1 lds
    s_mov_b32 m0, 45056
    s_nop 0
    buffer_load_dwordx4 v4, s[8:11], s47 offen sc1 lds
    s_mov_b32 m0, 46080
    s_nop 0
    buffer_load_dwordx4 v5, s[8:11], s47 offen sc1 lds
    s_lshl_b32 s46, s41, 13
    s_add_u32 s46, s46, s30
    s_lshl_b32 s47, s41, 7
    s_cmp_ge_u32 s41, 9
    s_cselect_b32 s48, 662400, 0
    s_add_u32 s47, s47, s48
    s_add_u32 s47, s47, 12544000
    s_add_u32 s41, s41, 1
    s_cmp_eq_u32 s41, 18
    s_cselect_b32 s41, 0, s41
    s_mov_b32 m0, 54272
    s_nop 0
    buffer_load_dwordx4 v2, s[8:11], s46 offen sc1 lds
    s_mov_b32 m0, 55296
    s_nop 0
    buffer_load_dwordx4 v3, s[8:11], s46 offen sc1 lds
    s_mov_b32 m0, 62464
    s_nop 0
    buffer_load_dwordx4 v4, s[8:11], s47 offen sc1 lds
    s_mov_b32 m0, 63488
    s_nop 0
    buffer_load_dwordx4 v5, s[8:11], s47 offen sc1 lds
    s_lshl_b32 s46, s41, 13
    s_add_u32 s46, s46, s30
    s_lshl_b32 s47, s41, 7
    s_cmp_ge_u32 s41, 9
    s_cselect_b32 s48, 662400, 0
    s_add_u32 s47, s47, s48
    s_add_u32 s47, s47, 12544000
    s_add_u32 s41, s41, 1
    s_cmp_eq_u32 s41, 18
    s_cselect_b32 s41, 0, s41
    buffer_load_dwordx4 v[40:43], v2, s[8:11], s46 offen sc1
    buffer_load_dwordx4 v[44:47], v3, s[8:11], s46 offen sc1
    buffer_load_dwordx4 v[48:51], v4, s[8:11], s47 offen sc1
    buffer_load_dwordx4 v[52:55], v5, s[8:11], s47 offen sc1
    s_lshl_b32 s46, s41, 13
    s_add_u32 s46, s46, s30
    s_lshl_b32 s47, s41, 7
    s_cmp_ge_u32 s41, 9
    s_cselect_b32 s48, 662400, 0
    s_add_u32 s47, s47, s48
    s_add_u32 s47, s47, 12544000
    s_add_u32 s41, s41, 1
    s_cmp_eq_u32 s41, 18
    s_cselect_b32 s41, 0, s41
    buffer_load_dwordx4 v[56:59], v2, s[8:11], s46 offen sc1
    buffer_load_dwordx4 v[60:63], v3, s[8:11], s46 offen sc1
    buffer_load_dwordx4 v[64:67], v4, s[8:11], s47 offen sc1
    buffer_load_dwordx4 v[68:71], v5, s[8:11], s47 offen sc1
    s_lshl_b32 s46, s41, 13
    s_add_u32 s46, s46, s30
    s_lshl_b32 s47, s41, 7
    s_cmp_ge_u32 s41, 9
    s_cselect_b32 s48, 662400, 0
    s_add_u32 s47, s47, s48
    s_add_u32 s47, s47, 12544000
    s_add_u32 s41, s41, 1
    s_cmp_eq_u32 s41, 18
    s_cselect_b32 s41, 0, s41
    buffer_load_dwordx4 v[72:75], v2, s[8:11], s46 offen sc1
    buffer_load_dwordx4 v[76:79], v3, s[8:11], s46 offen sc1
    buffer_load_dwordx4 v[80:83], v4, s[8:11], s47 offen sc1
    buffer_load_dwordx4 v[84:87], v5, s[8:11], s47 offen sc1
    s_lshl_b32 s46, s41, 13
    s_add_u32 s46, s46, s30
    s_lshl_b32 s47, s41, 7
    s_cmp_ge_u32 s41, 9
    s_cselect_b32 s48, 662400, 0
    s_add_u32 s47, s47, s48
    s_add_u32 s47, s47, 12544000
    s_add_u32 s41, s41, 1
    s_cmp_eq_u32 s41, 18
    s_cselect_b32 s41, 0, s41
    buffer_load_dwordx4 v[88:91], v2, s[8:11], s46 offen sc1
    buffer_load_dwordx4 v[92:95], v3, s[8:11], s46 offen sc1
    buffer_load_dwordx4 v[96:99], v4, s[8:11], s47 offen sc1
    buffer_load_dwordx4 v[100:103], v5, s[8:11], s47 offen sc1
    s_lshl_b32 s46, s41, 13
    s_add_u32 s46, s46, s30
    s_lshl_b32 s47, s41, 7
    s_cmp_ge_u32 s41, 9
    s_cselect_b32 s48, 662400, 0
    s_add_u32 s47, s47, s48
    s_add_u32 s47, s47, 12544000
    s_add_u32 s41, s41, 1
    s_cmp_eq_u32 s41, 18
    s_cselect_b32 s41, 0, s41
    buffer_load_dwordx4 v[104:107], v2, s[8:11], s46 offen sc1
    buffer_load_dwordx4 v[108:111], v3, s[8:11], s46 offen sc1
    buffer_load_dwordx4 v[112:115], v4, s[8:11], s47 offen sc1
    buffer_load_dwordx4 v[116:119], v5, s[8:11], s47 offen sc1
    s_lshl_b32 s46, s41, 13
    s_add_u32 s46, s46, s30
    s_lshl_b32 s47, s41, 7
    s_cmp_ge_u32 s41, 9
    s_cselect_b32 s48, 662400, 0
    s_add_u32 s47, s47, s48
    s_add_u32 s47, s47, 12544000
    s_add_u32 s41, s41, 1
    s_cmp_eq_u32 s41, 18
    s_cselect_b32 s41, 0, s41
    buffer_load_dwordx4 v[120:123], v2, s[8:11], s46 offen sc1
    buffer_load_dwordx4 v[124:127], v3, s[8:11], s46 offen sc1
    buffer_load_dwordx4 v[128:131], v4, s[8:11], s47 offen sc1
    buffer_load_dwordx4 v[132:135], v5, s[8:11], s47 offen sc1
    s_mov_b32 s35, 65536
K23_PWa1:
    ds_read_b32 v163, v162 offset:52
    s_waitcnt lgkmcnt(0)
    v_cmp_eq_u32 vcc, 8, v163
    s_cbranch_vccnz K23_QWa1
    s_sleep 4
    s_sub_u32 s35, s35, 1
    s_cmp_lg_u32 s35, 0
    s_cbranch_scc1 K23_PWa1
K23_QWa1:
    s_waitcnt vmcnt(24)
    s_mov_b32 s47, 0
    s_mov_b32 m0, 71680
    s_nop 0
    buffer_load_dwordx4 v8, s[12:15], s47 offen lds
    s_mov_b32 m0, 72704
    s_nop 0
    buffer_load_dwordx4 v9, s[12:15], s47 offen lds
    s_mov_b32 s47, 82944
    s_mov_b32 m0, 80896
    s_nop 0
    buffer_load_dwordx4 v8, s[12:15], s47 offen lds
    s_mov_b32 m0, 81920
    s_nop 0
    buffer_load_dwordx4 v9, s[12:15], s47 offen lds
    s_mov_b32 s47, 165888
    s_mov_b32 m0, 90112
    s_nop 0
    buffer_load_dwordx4 v8, s[12:15], s47 offen lds
    s_mov_b32 m0, 91136
    s_nop 0
    buffer_load_dwordx4 v9, s[12:15], s47 offen lds
    s_mov_b32 s47, 248832
    s_mov_b32 m0, 99328
    s_nop 0
    buffer_load_dwordx4 v8, s[12:15], s47 offen lds
    s_mov_b32 m0, 100352
    s_nop 0
    buffer_load_dwordx4 v9, s[12:15], s47 offen lds
    s_mov_b32 s35, 65536
K23_PWb1:
    ds_read_b32 v163, v162 offset:56
    s_waitcnt lgkmcnt(0)
    v_cmp_eq_u32 vcc, 8, v163
    s_cbranch_vccnz K23_QWb1
    s_sleep 4
    s_sub_u32 s35, s35, 1
    s_cmp_lg_u32 s35, 0
    s_cbranch_scc1 K23_PWb1
K23_QWb1:
    s_mov_b32 s47, 331776
    s_mov_b32 m0, 108544
    s_nop 0
    buffer_load_dwordx4 v8, s[12:15], s47 offen lds
    s_mov_b32 m0, 109568
    s_nop 0
    buffer_load_dwordx4 v9, s[12:15], s47 offen lds
    s_mov_b32 s47, 414720
    s_mov_b32 m0, 117760
    s_nop 0
    buffer_load_dwordx4 v8, s[12:15], s47 offen lds
    s_mov_b32 m0, 118784
    s_nop 0
    buffer_load_dwordx4 v9, s[12:15], s47 offen lds
    s_mov_b32 s34, 0
    s_mov_b32 s35, 0
    s_mov_b32 s36, 4096
    s_mov_b32 s37, 8192
    s_mov_b32 s38, 12288
    s_mov_b32 s39, 16384
    s_barrier
    ds_write_b128 v15, v[16:19] offset:2048
    ds_write_b128 v15, v[20:23] offset:3072
    s_barrier
    ds_write_b128 v15, v[24:27] offset:11264
    ds_write_b128 v15, v[28:31] offset:12288
    s_waitcnt vmcnt(32)
    s_waitcnt lgkmcnt(2)
    ds_write_b128 v7, v[40:43] offset:2048
    ds_write_b128 v7, v[44:47] offset:3072
    ds_write_b128 v7, v[48:51] offset:10240
    ds_write_b128 v7, v[52:55] offset:11264
    s_barrier
    ds_write_b128 v15, v[32:35] offset:20480
    ds_write_b128 v15, v[36:39] offset:21504
    s_waitcnt vmcnt(28)
    s_waitcnt lgkmcnt(2)
    s_lshl_b32 s46, s41, 13
    s_add_u32 s46, s46, s30
    s_lshl_b32 s47, s41, 7
    s_cmp_ge_u32 s41, 9
    s_cselect_b32 s48, 662400, 0
    s_add_u32 s47, s47, s48
    s_add_u32 s47, s47, 12544000
    s_add_u32 s41, s41, 1
    s_cmp_eq_u32 s41, 18
    s_cselect_b32 s41, 0, s41
    buffer_load_dwordx4 v[40:43], v2, s[8:11], s46 offen sc1
    ds_write_b128 v7, v[56:59] offset:19456
    buffer_load_dwordx4 v[44:47], v3, s[8:11], s46 offen sc1
    ds_write_b128 v7, v[60:63] offset:20480
    buffer_load_dwordx4 v[48:51], v4, s[8:11], s47 offen sc1
    ds_write_b128 v7, v[64:67] offset:27648
    buffer_load_dwordx4 v[52:55], v5, s[8:11], s47 offen sc1
    ds_write_b128 v7, v[68:71] offset:28672
    s_barrier
    s_waitcnt vmcnt(28)
    s_waitcnt lgkmcnt(0)
    s_lshl_b32 s46, s41, 13
    s_add_u32 s46, s46, s30
    s_lshl_b32 s47, s41, 7
    s_cmp_ge_u32 s41, 9
    s_cselect_b32 s48, 662400, 0
    s_add_u32 s47, s47, s48
    s_add_u32 s47, s47, 12544000
    s_add_u32 s41, s41, 1
    s_cmp_eq_u32 s41, 18
    s_cselect_b32 s41, 0, s41
    buffer_load_dwordx4 v[56:59], v2, s[8:11], s46 offen sc1
    ds_write_b128 v7, v[72:75] offset:36864
    buffer_load_dwordx4 v[60:63], v3, s[8:11], s46 offen sc1
    ds_write_b128 v7, v[76:79] offset:37888
    buffer_load_dwordx4 v[64:67], v4, s[8:11], s47 offen sc1
    ds_write_b128 v7, v[80:83] offset:45056
    buffer_load_dwordx4 v[68:71], v5, s[8:11], s47 offen sc1
    ds_write_b128 v7, v[84:87] offset:46080
    s_barrier
    s_waitcnt vmcnt(28)
    s_waitcnt lgkmcnt(0)
    s_lshl_b32 s46, s41, 13
    s_add_u32 s46, s46, s30
    s_lshl_b32 s47, s41, 7
    s_cmp_ge_u32 s41, 9
    s_cselect_b32 s48, 662400, 0
    s_add_u32 s47, s47, s48
    s_add_u32 s47, s47, 12544000
    s_add_u32 s41, s41, 1
    s_cmp_eq_u32 s41, 18
    s_cselect_b32 s41, 0, s41
    buffer_load_dwordx4 v[72:75], v2, s[8:11], s46 offen sc1
    ds_write_b128 v7, v[88:91] offset:54272
    buffer_load_dwordx4 v[76:79], v3, s[8:11], s46 offen sc1
    ds_write_b128 v7, v[92:95] offset:55296
    buffer_load_dwordx4 v[80:83], v4, s[8:11], s47 offen sc1
    ds_write_b128 v7, v[96:99] offset:62464
    buffer_load_dwordx4 v[84:87], v5, s[8:11], s47 offen sc1
    ds_write_b128 v7, v[100:103] offset:63488
    s_barrier
    s_waitcnt vmcnt(28)
    s_waitcnt lgkmcnt(0)
    s_lshl_b32 s46, s41, 13
    s_add_u32 s46, s46, s30
    s_lshl_b32 s47, s41, 7
    s_cmp_ge_u32 s41, 9
    s_cselect_b32 s48, 662400, 0
    s_add_u32 s47, s47, s48
    s_add_u32 s47, s47, 12544000
    s_add_u32 s41, s41, 1
    s_cmp_eq_u32 s41, 18
    s_cselect_b32 s41, 0, s41
    buffer_load_dwordx4 v[88:91], v2, s[8:11], s46 offen sc1
    ds_write_b128 v7, v[104:107] offset:2048
    buffer_load_dwordx4 v[92:95], v3, s[8:11], s46 offen sc1
    ds_write_b128 v7, v[108:111] offset:3072
    buffer_load_dwordx4 v[96:99], v4, s[8:11], s47 offen sc1
    ds_write_b128 v7, v[112:115] offset:10240
    buffer_load_dwordx4 v[100:103], v5, s[8:11], s47 offen sc1
    ds_write_b128 v7, v[116:119] offset:11264
    s_barrier
    s_waitcnt vmcnt(28)
    s_waitcnt lgkmcnt(0)
    s_lshl_b32 s46, s41, 13
    s_add_u32 s46, s46, s30
    s_lshl_b32 s47, s41, 7
    s_cmp_ge_u32 s41, 9
    s_cselect_b32 s48, 662400, 0
    s_add_u32 s47, s47, s48
    s_add_u32 s47, s47, 12544000
    s_add_u32 s41, s41, 1
    s_cmp_eq_u32 s41, 18
    s_cselect_b32 s41, 0, s41
    buffer_load_dwordx4 v[104:107], v2, s[8:11], s46 offen sc1
    ds_write_b128 v7, v[120:123] offset:19456
    buffer_load_dwordx4 v[108:111], v3, s[8:11], s46 offen sc1
    ds_write_b128 v7, v[124:127] offset:20480
    buffer_load_dwordx4 v[112:115], v4, s[8:11], s47 offen sc1
    ds_write_b128 v7, v[128:131] offset:27648
    buffer_load_dwordx4 v[116:119], v5, s[8:11], s47 offen sc1
    ds_write_b128 v7, v[132:135] offset:28672
    s_barrier
    s_waitcnt lgkmcnt(0)
    s_lshl_b32 s46, s41, 13
    s_add_u32 s46, s46, s30
    s_lshl_b32 s47, s41, 7
    s_cmp_ge_u32 s41, 9
    s_cselect_b32 s48, 662400, 0
    s_add_u32 s47, s47, s48
    s_add_u32 s47, s47, 12544000
    s_add_u32 s41, s41, 1
    s_cmp_eq_u32 s41, 18
    s_cselect_b32 s41, 0, s41
    buffer_load_dwordx4 v[120:123], v2, s[8:11], s46 offen sc1
    buffer_load_dwordx4 v[124:127], v3, s[8:11], s46 offen sc1
    buffer_load_dwordx4 v[128:131], v4, s[8:11], s47 offen sc1
    buffer_load_dwordx4 v[132:135], v5, s[8:11], s47 offen sc1
    s_barrier
    s_waitcnt vmcnt(20)
    ds_write_b128 v7, v[40:43] offset:36864
    ds_write_b128 v7, v[44:47] offset:37888
    ds_write_b128 v7, v[48:51] offset:45056
    ds_write_b128 v7, v[52:55] offset:46080
    s_barrier
    s_waitcnt vmcnt(16)
    s_waitcnt lgkmcnt(0)
    s_lshl_b32 s46, s41, 13
    s_add_u32 s46, s46, s30
    s_lshl_b32 s47, s41, 7
    s_cmp_ge_u32 s41, 9
    s_cselect_b32 s48, 662400, 0
    s_add_u32 s47, s47, s48
    s_add_u32 s47, s47, 12544000
    s_add_u32 s41, s41, 1
    s_cmp_eq_u32 s41, 18
    s_cselect_b32 s41, 0, s41
    buffer_load_dwordx4 v[40:43], v2, s[8:11], s46 offen sc1
    ds_write_b128 v7, v[56:59] offset:54272
    buffer_load_dwordx4 v[44:47], v3, s[8:11], s46 offen sc1
    ds_write_b128 v7, v[60:63] offset:55296
    buffer_load_dwordx4 v[48:51], v4, s[8:11], s47 offen sc1
    ds_write_b128 v7, v[64:67] offset:62464
    buffer_load_dwordx4 v[52:55], v5, s[8:11], s47 offen sc1
    ds_write_b128 v7, v[68:71] offset:63488
    s_barrier
    s_waitcnt vmcnt(16)
    s_waitcnt lgkmcnt(0)
    s_lshl_b32 s46, s41, 13
    s_add_u32 s46, s46, s30
    s_lshl_b32 s47, s41, 7
    s_cmp_ge_u32 s41, 9
    s_cselect_b32 s48, 662400, 0
    s_add_u32 s47, s47, s48
    s_add_u32 s47, s47, 12544000
    s_add_u32 s41, s41, 1
    s_cmp_eq_u32 s41, 18
    s_cselect_b32 s41, 0, s41
    buffer_load_dwordx4 v[56:59], v2, s[8:11], s46 offen sc1
    ds_write_b128 v7, v[72:75] offset:2048
    buffer_load_dwordx4 v[60:63], v3, s[8:11], s46 offen sc1
    ds_write_b128 v7, v[76:79] offset:3072
    buffer_load_dwordx4 v[64:67], v4, s[8:11], s47 offen sc1
    ds_write_b128 v7, v[80:83] offset:10240
    buffer_load_dwordx4 v[68:71], v5, s[8:11], s47 offen sc1
    ds_write_b128 v7, v[84:87] offset:11264
    s_barrier
    s_waitcnt vmcnt(16)
    s_waitcnt lgkmcnt(0)
    ds_write_b128 v7, v[88:91] offset:19456
    ds_write_b128 v7, v[92:95] offset:20480
    ds_write_b128 v7, v[96:99] offset:27648
    ds_write_b128 v7, v[100:103] offset:28672
    s_lshl_b32 s46, s6, 6
    s_add_u32 s46, s46, 16
    v_add_u32 v20, s46, v160
    v_mul_u32_u24 v16, 1152, v20
    s_mul_i32 s47, s7, 144
    v_lshl_add_u32 v21, v161, 3, s47
    v_add_u32 v16, v16, v21
    v_lshlrev_b32 v17, 2, v20
    v_mul_u32_u24 v18, 2304, v20
    v_lshl_add_u32 v18, v21, 1, v18
    v_mul_u32_u24 v19, 304, v160
    v_lshl_add_u32 v19, v161, 4, v19
    v_add_u32 v19, 4864, v19
    v_mov_b32 v22, v21
    buffer_load_dwordx2 v[20:21], v22, s[20:23], 0 offen
    s_mov_b32 s47, 12525568
    buffer_load_dwordx2 v[22:23], v16, s[16:19], s34 offen offset:0
    buffer_load_dword v34, v17, s[8:11], s47 offen offset:0
    buffer_load_dwordx2 v[24:25], v16, s[16:19], s35 offen offset:3456
    buffer_load_dword v35, v17, s[8:11], s47 offen offset:12
    buffer_load_dwordx2 v[26:27], v16, s[16:19], s36 offen offset:2816
    buffer_load_dword v36, v17, s[8:11], s47 offen offset:24
    buffer_load_dwordx2 v[28:29], v16, s[16:19], s37 offen offset:2176
    buffer_load_dword v37, v17, s[8:11], s47 offen offset:36
    buffer_load_dwordx2 v[30:31], v16, s[16:19], s38 offen offset:1536
    buffer_load_dword v38, v17, s[8:11], s47 offen offset:48
    buffer_load_dwordx2 v[32:33], v16, s[16:19], s39 offen offset:896
    buffer_load_dword v39, v17, s[8:11], s47 offen offset:60
    s_barrier
    s_waitcnt vmcnt(25)
    s_waitcnt lgkmcnt(0)
    s_lshl_b32 s46, s42, 13
    s_add_u32 s46, s46, s31
    buffer_load_dwordx4 v[72:75], v7, s[8:11], s46 offen sc1
    ds_write_b128 v7, v[104:107] offset:36864
    buffer_load_dwordx4 v[76:79], v7, s[8:11], s46 offen offset:1024 sc1
    ds_write_b128 v7, v[108:111] offset:37888
    s_add_u32 s42, s42, 1
    s_cmp_eq_u32 s42, 9
    s_cselect_b32 s42, 0, s42
    s_lshl_b32 s46, s42, 13
    s_add_u32 s46, s46, s31
    buffer_load_dwordx4 v[80:83], v7, s[8:11], s46 offen sc1
    ds_write_b128 v7, v[112:115] offset:45056
    buffer_load_dwordx4 v[84:87], v7, s[8:11], s46 offen offset:1024 sc1
    ds_write_b128 v7, v[116:119] offset:46080
    s_add_u32 s42, s42, 1
    s_cmp_eq_u32 s42, 9
    s_cselect_b32 s42, 0, s42
    s_barrier
    s_waitcnt vmcnt(25)
    s_waitcnt lgkmcnt(0)
    s_lshl_b32 s46, s42, 13
    s_add_u32 s46, s46, s31
    buffer_load_dwordx4 v[88:91], v7, s[8:11], s46 offen sc1
    ds_write_b128 v7, v[120:123] offset:54272
    buffer_load_dwordx4 v[92:95], v7, s[8:11], s46 offen offset:1024 sc1
    ds_write_b128 v7, v[124:127] offset:55296
    s_add_u32 s42, s42, 1
    s_cmp_eq_u32 s42, 9
    s_cselect_b32 s42, 0, s42
    s_lshl_b32 s46, s42, 13
    s_add_u32 s46, s46, s31
    buffer_load_dwordx4 v[96:99], v7, s[8:11], s46 offen sc1
    ds_write_b128 v7, v[128:131] offset:62464
    buffer_load_dwordx4 v[100:103], v7, s[8:11], s46 offen offset:1024 sc1
    ds_write_b128 v7, v[132:135] offset:63488
    s_add_u32 s42, s42, 1
    s_cmp_eq_u32 s42, 9
    s_cselect_b32 s42, 0, s42
    s_barrier
    s_waitcnt vmcnt(25)
    s_waitcnt lgkmcnt(0)
    s_lshl_b32 s46, s42, 13
    s_add_u32 s46, s46, s31
    buffer_load_dwordx4 v[104:107], v7, s[8:11], s46 offen sc1
    ds_write_b128 v7, v[40:43] offset:2048
    buffer_load_dwordx4 v[108:111], v7, s[8:11], s46 offen offset:1024 sc1
    ds_write_b128 v7, v[44:47] offset:3072
    s_add_u32 s42, s42, 1
    s_cmp_eq_u32 s42, 9
    s_cselect_b32 s42, 0, s42
    s_lshl_b32 s46, s42, 13
    s_add_u32 s46, s46, s31
    buffer_load_dwordx4 v[112:115], v7, s[8:11], s46 offen sc1
    ds_write_b128 v7, v[48:51] offset:10240
    buffer_load_dwordx4 v[116:119], v7, s[8:11], s46 offen offset:1024 sc1
    ds_write_b128 v7, v[52:55] offset:11264
    s_add_u32 s42, s42, 1
    s_cmp_eq_u32 s42, 9
    s_cselect_b32 s42, 0, s42
    s_barrier
    s_waitcnt vmcnt(25)
    s_waitcnt lgkmcnt(0)
    s_lshl_b32 s46, s42, 13
    s_add_u32 s46, s46, s31
    buffer_load_dwordx4 v[120:123], v7, s[8:11], s46 offen sc1
    ds_write_b128 v7, v[56:59] offset:19456
    buffer_load_dwordx4 v[124:127], v7, s[8:11], s46 offen offset:1024 sc1
    ds_write_b128 v7, v[60:63] offset:20480
    s_add_u32 s42, s42, 1
    s_cmp_eq_u32 s42, 9
    s_cselect_b32 s42, 0, s42
    s_lshl_b32 s46, s42, 13
    s_add_u32 s46, s46, s31
    buffer_load_dwordx4 v[128:131], v7, s[8:11], s46 offen sc1
    ds_write_b128 v7, v[64:67] offset:27648
    buffer_load_dwordx4 v[132:135], v7, s[8:11], s46 offen offset:1024 sc1
    ds_write_b128 v7, v[68:71] offset:28672
    s_add_u32 s42, s42, 1
    s_cmp_eq_u32 s42, 9
    s_cselect_b32 s42, 0, s42
    s_barrier
    s_waitcnt vmcnt(14)
    s_waitcnt lgkmcnt(0)
    s_lshl_b32 s46, s42, 13
    s_add_u32 s46, s46, s31
    buffer_load_dwordx4 v[40:43], v7, s[8:11], s46 offen sc1
    ds_write_b128 v7, v[72:75] offset:36864
    buffer_load_dwordx4 v[44:47], v7, s[8:11], s46 offen offset:1024 sc1
    ds_write_b128 v7, v[76:79] offset:37888
    s_add_u32 s42, s42, 1
    s_cmp_eq_u32 s42, 9
    s_cselect_b32 s42, 0, s42
    s_barrier
    s_waitcnt vmcnt(14)
    s_waitcnt lgkmcnt(0)
    ds_write_b128 v7, v[80:83] offset:54272
    ds_write_b128 v7, v[84:87] offset:55296
    s_barrier
    s_waitcnt vmcnt(12)
    s_waitcnt lgkmcnt(0)
    ds_write_b128 v7, v[88:91] offset:2048
    ds_write_b128 v7, v[92:95] offset:3072
    s_barrier
    s_waitcnt vmcnt(10)
    s_waitcnt lgkmcnt(0)
    ds_write_b128 v7, v[96:99] offset:19456
    ds_write_b128 v7, v[100:103] offset:20480
    s_barrier
    s_waitcnt vmcnt(8)
    s_waitcnt lgkmcnt(0)
    ds_write_b128 v7, v[104:107] offset:36864
    ds_write_b128 v7, v[108:111] offset:37888
    s_barrier
    s_waitcnt vmcnt(6)
    s_waitcnt lgkmcnt(0)
    ds_write_b128 v7, v[112:115] offset:54272
    ds_write_b128 v7, v[116:119] offset:55296
    s_barrier
    s_waitcnt vmcnt(4)
    s_waitcnt lgkmcnt(0)
    ds_write_b128 v7, v[120:123] offset:2048
    ds_write_b128 v7, v[124:127] offset:3072
    s_barrier
    s_waitcnt vmcnt(2)
    s_waitcnt lgkmcnt(0)
    ds_write_b128 v7, v[128:131] offset:19456
    ds_write_b128 v7, v[132:135] offset:20480
    s_barrier
    s_waitcnt vmcnt(0)
    s_waitcnt lgkmcnt(0)
    ds_write_b128 v7, v[40:43] offset:36864
    ds_write_b128 v7, v[44:47] offset:37888
    s_barrier
    s_waitcnt lgkmcnt(0)
    s_barrier
    s_waitcnt vmcnt(0)
    v_lshlrev_b32 v64, 16, v20
    v_and_b32 v65, 0xffff0000, v20
    v_lshlrev_b32 v66, 16, v21
    v_and_b32 v67, 0xffff0000, v21
    v_lshlrev_b32 v68, 16, v22
    v_and_b32 v69, 0xffff0000, v22
    v_lshlrev_b32 v70, 16, v23
    v_and_b32 v71, 0xffff0000, v23
    v_mul_f32 v68, v68, v64
    v_mul_f32 v69, v69, v65
    v_mul_f32 v70, v70, v66
    v_mul_f32 v71, v71, v67
    v_lshlrev_b32 v72, 16, v24
    v_and_b32 v73, 0xffff0000, v24
    v_lshlrev_b32 v74, 16, v25
    v_and_b32 v75, 0xffff0000, v25
    v_mul_f32 v72, v72, v64
    v_mul_f32 v73, v73, v65
    v_mul_f32 v74, v74, v66
    v_mul_f32 v75, v75, v67
    v_lshlrev_b32 v76, 16, v26
    v_and_b32 v77, 0xffff0000, v26
    v_lshlrev_b32 v78, 16, v27
    v_and_b32 v79, 0xffff0000, v27
    v_mul_f32 v76, v76, v64
    v_mul_f32 v77, v77, v65
    v_mul_f32 v78, v78, v66
    v_mul_f32 v79, v79, v67
    v_lshlrev_b32 v80, 16, v28
    v_and_b32 v81, 0xffff0000, v28
    v_lshlrev_b32 v82, 16, v29
    v_and_b32 v83, 0xffff0000, v29
    v_mul_f32 v80, v80, v64
    v_mul_f32 v81, v81, v65
    v_mul_f32 v82, v82, v66
    v_mul_f32 v83, v83, v67
    v_lshlrev_b32 v84, 16, v30
    v_and_b32 v85, 0xffff0000, v30
    v_lshlrev_b32 v86, 16, v31
    v_and_b32 v87, 0xffff0000, v31
    v_mul_f32 v84, v84, v64
    v_mul_f32 v85, v85, v65
    v_mul_f32 v86, v86, v66
    v_mul_f32 v87, v87, v67
    v_lshlrev_b32 v88, 16, v32
    v_and_b32 v89, 0xffff0000, v32
    v_lshlrev_b32 v90, 16, v33
    v_and_b32 v91, 0xffff0000, v33
    v_mul_f32 v88, v88, v64
    v_mul_f32 v89, v89, v65
    v_mul_f32 v90, v90, v66
    v_mul_f32 v91, v91, v67
    s_barrier
    s_mov_b32 exec_hi, 0x003fffff
    ds_read_b128 v[92:95], v19 offset:0
    ds_read_b128 v[96:99], v19 offset:912
    ds_read_b128 v[100:103], v19 offset:1824
    ds_read_b128 v[104:107], v19 offset:2736
    ds_read_b128 v[108:111], v19 offset:3648
    ds_read_b128 v[112:115], v19 offset:4560
    s_waitcnt lgkmcnt(5)
    v_fmac_f32 v92, v34, v68
    v_fmac_f32 v93, v34, v69
    v_fmac_f32 v94, v34, v70
    v_fmac_f32 v95, v34, v71
    s_mov_b32 s46, 0
    buffer_store_dwordx4 v[92:95], v18, s[24:27], s46 offen sc1
    s_waitcnt lgkmcnt(4)
    v_fmac_f32 v96, v35, v72
    v_fmac_f32 v97, v35, v73
    v_fmac_f32 v98, v35, v74
    v_fmac_f32 v99, v35, v75
    s_mov_b32 s46, 6912
    buffer_store_dwordx4 v[96:99], v18, s[24:27], s46 offen sc1
    s_waitcnt lgkmcnt(3)
    v_fmac_f32 v100, v36, v76
    v_fmac_f32 v101, v36, v77
    v_fmac_f32 v102, v36, v78
    v_fmac_f32 v103, v36, v79
    s_mov_b32 s46, 13824
    buffer_store_dwordx4 v[100:103], v18, s[24:27], s46 offen sc1
    s_waitcnt lgkmcnt(2)
    v_fmac_f32 v104, v37, v80
    v_fmac_f32 v105, v37, v81
    v_fmac_f32 v106, v37, v82
    v_fmac_f32 v107, v37, v83
    s_mov_b32 s46, 20736
    buffer_store_dwordx4 v[104:107], v18, s[24:27], s46 offen sc1
    s_waitcnt lgkmcnt(1)
    v_fmac_f32 v108, v38, v84
    v_fmac_f32 v109, v38, v85
    v_fmac_f32 v110, v38, v86
    v_fmac_f32 v111, v38, v87
    s_mov_b32 s46, 27648
    buffer_store_dwordx4 v[108:111], v18, s[24:27], s46 offen sc1
    s_mov_b32 exec_hi, 0
    s_mov_b32 exec_lo, 0x3ffff
    s_waitcnt lgkmcnt(0)
    v_fmac_f32 v112, v39, v88
    v_fmac_f32 v113, v39, v89
    v_fmac_f32 v114, v39, v90
    v_fmac_f32 v115, v39, v91
    s_mov_b32 s46, 34560
    buffer_store_dwordx4 v[112:115], v18, s[24:27], s46 offen sc1
    s_endpgm
K3_L2:
    s_mul_i32 s30, s6, 147456
    s_add_u32 s30, s30, 7217152
    s_mul_i32 s31, s6, 73728
    s_add_u32 s31, s31, 13875200
    v_add_u32 v15, 124928, v7
    s_waitcnt lgkmcnt(0)
    s_mov_b32 s47, 497664
    buffer_load_dwordx4 v[16:19], v8, s[12:15], s47 offen
    buffer_load_dwordx4 v[20:23], v9, s[12:15], s47 offen
    s_mov_b32 s47, 580608
    buffer_load_dwordx4 v[24:27], v8, s[12:15], s47 offen
    buffer_load_dwordx4 v[28:31], v9, s[12:15], s47 offen
    s_mov_b32 s47, 0
    buffer_load_dwordx4 v[32:35], v156, s[12:15], s47 offen
    buffer_load_dwordx4 v[36:39], v157, s[12:15], s47 offen
    s_mov_b32 s35, 65536
K23_PWr2:
    ds_read_b32 v163, v162 offset:44
    s_waitcnt lgkmcnt(0)
    v_cmp_eq_u32 vcc, 8, v163
    s_cbranch_vccnz K23_QWr2
    s_sleep 4
    s_sub_u32 s35, s35, 1
    s_cmp_lg_u32 s35, 0
    s_cbranch_scc1 K23_PWr2
K23_QWr2:
    s_mov_b32 s35, 65536
K23_PWg2:
    ds_read_b32 v163, v162 offset:0
    s_waitcnt lgkmcnt(0)
    v_cmp_eq_u32 vcc, 1, v163
    s_cbranch_vccnz K23_QWg2
    s_sleep 8
    s_sub_u32 s35, s35, 1
    s_cmp_lg_u32 s35, 0
    s_cbranch_scc1 K23_PWg2
K23_QWg2:
    s_lshl_b32 s46, s41, 13
    s_add_u32 s46, s46, s30
    s_lshl_b32 s47, s41, 7
    s_cmp_ge_u32 s41, 9
    s_cselect_b32 s48, 662400, 0
    s_add_u32 s47, s47, s48
    s_add_u32 s47, s47, 12544000
    s_add_u32 s41, s41, 1
    s_cmp_eq_u32 s41, 18
    s_cselect_b32 s41, 0, s41
    s_mov_b32 m0, 4096
    s_nop 0
    buffer_load_dwordx4 v2, s[8:11], s46 offen sc1 lds
    s_mov_b32 m0, 5120
    s_nop 0
    buffer_load_dwordx4 v3, s[8:11], s46 offen sc1 lds
    s_mov_b32 m0, 12288
    s_nop 0
    buffer_load_dwordx4 v4, s[8:11], s47 offen sc1 lds
    s_mov_b32 m0, 13312
    s_nop 0
    buffer_load_dwordx4 v5, s[8:11], s47 offen sc1 lds
    s_lshl_b32 s46, s41, 13
    s_add_u32 s46, s46, s30
    s_lshl_b32 s47, s41, 7
    s_cmp_ge_u32 s41, 9
    s_cselect_b32 s48, 662400, 0
    s_add_u32 s47, s47, s48
    s_add_u32 s47, s47, 12544000
    s_add_u32 s41, s41, 1
    s_cmp_eq_u32 s41, 18
    s_cselect_b32 s41, 0, s41
    s_mov_b32 m0, 21504
    s_nop 0
    buffer_load_dwordx4 v2, s[8:11], s46 offen sc1 lds
    s_mov_b32 m0, 22528
    s_nop 0
    buffer_load_dwordx4 v3, s[8:11], s46 offen sc1 lds
    s_mov_b32 m0, 29696
    s_nop 0
    buffer_load_dwordx4 v4, s[8:11], s47 offen sc1 lds
    s_mov_b32 m0, 30720
    s_nop 0
    buffer_load_dwordx4 v5, s[8:11], s47 offen sc1 lds
    s_lshl_b32 s46, s41, 13
    s_add_u32 s46, s46, s30
    s_lshl_b32 s47, s41, 7
    s_cmp_ge_u32 s41, 9
    s_cselect_b32 s48, 662400, 0
    s_add_u32 s47, s47, s48
    s_add_u32 s47, s47, 12544000
    s_add_u32 s41, s41, 1
    s_cmp_eq_u32 s41, 18
    s_cselect_b32 s41, 0, s41
    s_mov_b32 m0, 38912
    s_nop 0
    buffer_load_dwordx4 v2, s[8:11], s46 offen sc1 lds
    s_mov_b32 m0, 39936
    s_nop 0
    buffer_load_dwordx4 v3, s[8:11], s46 offen sc1 lds
    s_mov_b32 m0, 47104
    s_nop 0
    buffer_load_dwordx4 v4, s[8:11], s47 offen sc1 lds
    s_mov_b32 m0, 48128
    s_nop 0
    buffer_load_dwordx4 v5, s[8:11], s47 offen sc1 lds
    s_lshl_b32 s46, s41, 13
    s_add_u32 s46, s46, s30
    s_lshl_b32 s47, s41, 7
    s_cmp_ge_u32 s41, 9
    s_cselect_b32 s48, 662400, 0
    s_add_u32 s47, s47, s48
    s_add_u32 s47, s47, 12544000
    s_add_u32 s41, s41, 1
    s_cmp_eq_u32 s41, 18
    s_cselect_b32 s41, 0, s41
    s_mov_b32 m0, 56320
    s_nop 0
    buffer_load_dwordx4 v2, s[8:11], s46 offen sc1 lds
    s_mov_b32 m0, 57344
    s_nop 0
    buffer_load_dwordx4 v3, s[8:11], s46 offen sc1 lds
    s_mov_b32 m0, 64512
    s_nop 0
    buffer_load_dwordx4 v4, s[8:11], s47 offen sc1 lds
    s_mov_b32 m0, 65536
    s_nop 0
    buffer_load_dwordx4 v5, s[8:11], s47 offen sc1 lds
    s_lshl_b32 s46, s41, 13
    s_add_u32 s46, s46, s30
    s_lshl_b32 s47, s41, 7
    s_cmp_ge_u32 s41, 9
    s_cselect_b32 s48, 662400, 0
    s_add_u32 s47, s47, s48
    s_add_u32 s47, s47, 12544000
    s_add_u32 s41, s41, 1
    s_cmp_eq_u32 s41, 18
    s_cselect_b32 s41, 0, s41
    buffer_load_dwordx4 v[40:43], v2, s[8:11], s46 offen sc1
    buffer_load_dwordx4 v[44:47], v3, s[8:11], s46 offen sc1
    buffer_load_dwordx4 v[48:51], v4, s[8:11], s47 offen sc1
    buffer_load_dwordx4 v[52:55], v5, s[8:11], s47 offen sc1
    s_lshl_b32 s46, s41, 13
    s_add_u32 s46, s46, s30
    s_lshl_b32 s47, s41, 7
    s_cmp_ge_u32 s41, 9
    s_cselect_b32 s48, 662400, 0
    s_add_u32 s47, s47, s48
    s_add_u32 s47, s47, 12544000
    s_add_u32 s41, s41, 1
    s_cmp_eq_u32 s41, 18
    s_cselect_b32 s41, 0, s41
    buffer_load_dwordx4 v[56:59], v2, s[8:11], s46 offen sc1
    buffer_load_dwordx4 v[60:63], v3, s[8:11], s46 offen sc1
    buffer_load_dwordx4 v[64:67], v4, s[8:11], s47 offen sc1
    buffer_load_dwordx4 v[68:71], v5, s[8:11], s47 offen sc1
    s_lshl_b32 s46, s41, 13
    s_add_u32 s46, s46, s30
    s_lshl_b32 s47, s41, 7
    s_cmp_ge_u32 s41, 9
    s_cselect_b32 s48, 662400, 0
    s_add_u32 s47, s47, s48
    s_add_u32 s47, s47, 12544000
    s_add_u32 s41, s41, 1
    s_cmp_eq_u32 s41, 18
    s_cselect_b32 s41, 0, s41
    buffer_load_dwordx4 v[72:75], v2, s[8:11], s46 offen sc1
    buffer_load_dwordx4 v[76:79], v3, s[8:11], s46 offen sc1
    buffer_load_dwordx4 v[80:83], v4, s[8:11], s47 offen sc1
    buffer_load_dwordx4 v[84:87], v5, s[8:11], s47 offen sc1
    s_lshl_b32 s46, s41, 13
    s_add_u32 s46, s46, s30
    s_lshl_b32 s47, s41, 7
    s_cmp_ge_u32 s41, 9
    s_cselect_b32 s48, 662400, 0
    s_add_u32 s47, s47, s48
    s_add_u32 s47, s47, 12544000
    s_add_u32 s41, s41, 1
    s_cmp_eq_u32 s41, 18
    s_cselect_b32 s41, 0, s41
    buffer_load_dwordx4 v[88:91], v2, s[8:11], s46 offen sc1
    buffer_load_dwordx4 v[92:95], v3, s[8:11], s46 offen sc1
    buffer_load_dwordx4 v[96:99], v4, s[8:11], s47 offen sc1
    buffer_load_dwordx4 v[100:103], v5, s[8:11], s47 offen sc1
    s_lshl_b32 s46, s41, 13
    s_add_u32 s46, s46, s30
    s_lshl_b32 s47, s41, 7
    s_cmp_ge_u32 s41, 9
    s_cselect_b32 s48, 662400, 0
    s_add_u32 s47, s47, s48
    s_add_u32 s47, s47, 12544000
    s_add_u32 s41, s41, 1
    s_cmp_eq_u32 s41, 18
    s_cselect_b32 s41, 0, s41
    buffer_load_dwordx4 v[104:107], v2, s[8:11], s46 offen sc1
    buffer_load_dwordx4 v[108:111], v3, s[8:11], s46 offen sc1
    buffer_load_dwordx4 v[112:115], v4, s[8:11], s47 offen sc1
    buffer_load_dwordx4 v[116:119], v5, s[8:11], s47 offen sc1
    s_lshl_b32 s46, s41, 13
    s_add_u32 s46, s46, s30
    s_lshl_b32 s47, s41, 7
    s_cmp_ge_u32 s41, 9
    s_cselect_b32 s48, 662400, 0
    s_add_u32 s47, s47, s48
    s_add_u32 s47, s47, 12544000
    s_add_u32 s41, s41, 1
    s_cmp_eq_u32 s41, 18
    s_cselect_b32 s41, 0, s41
    buffer_load_dwordx4 v[120:123], v2, s[8:11], s46 offen sc1
    buffer_load_dwordx4 v[124:127], v3, s[8:11], s46 offen sc1
    buffer_load_dwordx4 v[128:131], v4, s[8:11], s47 offen sc1
    buffer_load_dwordx4 v[132:135], v5, s[8:11], s47 offen sc1
    s_mov_b32 s35, 65536
K23_PWa2:
    ds_read_b32 v163, v162 offset:52
    s_waitcnt lgkmcnt(0)
    v_cmp_eq_u32 vcc, 8, v163
    s_cbranch_vccnz K23_QWa2
    s_sleep 4
    s_sub_u32 s35, s35, 1
    s_cmp_lg_u32 s35, 0
    s_cbranch_scc1 K23_PWa2
K23_QWa2:
    s_waitcnt vmcnt(24)
    s_mov_b32 s47, 0
    s_mov_b32 m0, 73728
    s_nop 0
    buffer_load_dwordx4 v8, s[12:15], s47 offen lds
    s_mov_b32 m0, 74752
    s_nop 0
    buffer_load_dwordx4 v9, s[12:15], s47 offen lds
    s_mov_b32 s47, 82944
    s_mov_b32 m0, 82944
    s_nop 0
    buffer_load_dwordx4 v8, s[12:15], s47 offen lds
    s_mov_b32 m0, 83968
    s_nop 0
    buffer_load_dwordx4 v9, s[12:15], s47 offen lds
    s_mov_b32 s47, 165888
    s_mov_b32 m0, 92160
    s_nop 0
    buffer_load_dwordx4 v8, s[12:15], s47 offen lds
    s_mov_b32 m0, 93184
    s_nop 0
    buffer_load_dwordx4 v9, s[12:15], s47 offen lds
    s_mov_b32 s47, 248832
    s_mov_b32 m0, 101376
    s_nop 0
    buffer_load_dwordx4 v8, s[12:15], s47 offen lds
    s_mov_b32 m0, 102400
    s_nop 0
    buffer_load_dwordx4 v9, s[12:15], s47 offen lds
    s_mov_b32 s35, 65536
K23_PWb2:
    ds_read_b32 v163, v162 offset:56
    s_waitcnt lgkmcnt(0)
    v_cmp_eq_u32 vcc, 8, v163
    s_cbranch_vccnz K23_QWb2
    s_sleep 4
    s_sub_u32 s35, s35, 1
    s_cmp_lg_u32 s35, 0
    s_cbranch_scc1 K23_PWb2
K23_QWb2:
    s_mov_b32 s47, 331776
    s_mov_b32 m0, 110592
    s_nop 0
    buffer_load_dwordx4 v8, s[12:15], s47 offen lds
    s_mov_b32 m0, 111616
    s_nop 0
    buffer_load_dwordx4 v9, s[12:15], s47 offen lds
    s_mov_b32 s47, 414720
    s_mov_b32 m0, 119808
    s_nop 0
    buffer_load_dwordx4 v8, s[12:15], s47 offen lds
    s_mov_b32 m0, 120832
    s_nop 0
    buffer_load_dwordx4 v9, s[12:15], s47 offen lds
    s_mov_b32 s34, 0
    s_mov_b32 s35, 0
    s_mov_b32 s36, 4096
    s_mov_b32 s37, 8192
    s_mov_b32 s38, 12288
    s_mov_b32 s39, 16384
    s_barrier
    ds_write_b128 v15, v[16:19] offset:4096
    ds_write_b128 v15, v[20:23] offset:5120
    s_barrier
    ds_write_b128 v15, v[24:27] offset:13312
    ds_write_b128 v15, v[28:31] offset:14336
    s_waitcnt vmcnt(32)
    s_waitcnt lgkmcnt(2)
    ds_write_b128 v7, v[40:43] offset:4096
    ds_write_b128 v7, v[44:47] offset:5120
    ds_write_b128 v7, v[48:51] offset:12288
    ds_write_b128 v7, v[52:55] offset:13312
    s_barrier
    ds_write_b128 v15, v[32:35] offset:22528
    ds_write_b128 v15, v[36:39] offset:23552
    s_waitcnt vmcnt(28)
    s_waitcnt lgkmcnt(2)
    s_lshl_b32 s46, s41, 13
    s_add_u32 s46, s46, s30
    s_lshl_b32 s47, s41, 7
    s_cmp_ge_u32 s41, 9
    s_cselect_b32 s48, 662400, 0
    s_add_u32 s47, s47, s48
    s_add_u32 s47, s47, 12544000
    s_add_u32 s41, s41, 1
    s_cmp_eq_u32 s41, 18
    s_cselect_b32 s41, 0, s41
    buffer_load_dwordx4 v[40:43], v2, s[8:11], s46 offen sc1
    ds_write_b128 v7, v[56:59] offset:21504
    buffer_load_dwordx4 v[44:47], v3, s[8:11], s46 offen sc1
    ds_write_b128 v7, v[60:63] offset:22528
    buffer_load_dwordx4 v[48:51], v4, s[8:11], s47 offen sc1
    ds_write_b128 v7, v[64:67] offset:29696
    buffer_load_dwordx4 v[52:55], v5, s[8:11], s47 offen sc1
    ds_write_b128 v7, v[68:71] offset:30720
    s_barrier
    s_waitcnt vmcnt(28)
    s_waitcnt lgkmcnt(0)
    s_lshl_b32 s46, s41, 13
    s_add_u32 s46, s46, s30
    s_lshl_b32 s47, s41, 7
    s_cmp_ge_u32 s41, 9
    s_cselect_b32 s48, 662400, 0
    s_add_u32 s47, s47, s48
    s_add_u32 s47, s47, 12544000
    s_add_u32 s41, s41, 1
    s_cmp_eq_u32 s41, 18
    s_cselect_b32 s41, 0, s41
    buffer_load_dwordx4 v[56:59], v2, s[8:11], s46 offen sc1
    ds_write_b128 v7, v[72:75] offset:38912
    buffer_load_dwordx4 v[60:63], v3, s[8:11], s46 offen sc1
    ds_write_b128 v7, v[76:79] offset:39936
    buffer_load_dwordx4 v[64:67], v4, s[8:11], s47 offen sc1
    ds_write_b128 v7, v[80:83] offset:47104
    buffer_load_dwordx4 v[68:71], v5, s[8:11], s47 offen sc1
    ds_write_b128 v7, v[84:87] offset:48128
    s_barrier
    s_waitcnt vmcnt(28)
    s_waitcnt lgkmcnt(0)
    s_lshl_b32 s46, s41, 13
    s_add_u32 s46, s46, s30
    s_lshl_b32 s47, s41, 7
    s_cmp_ge_u32 s41, 9
    s_cselect_b32 s48, 662400, 0
    s_add_u32 s47, s47, s48
    s_add_u32 s47, s47, 12544000
    s_add_u32 s41, s41, 1
    s_cmp_eq_u32 s41, 18
    s_cselect_b32 s41, 0, s41
    buffer_load_dwordx4 v[72:75], v2, s[8:11], s46 offen sc1
    ds_write_b128 v7, v[88:91] offset:56320
    buffer_load_dwordx4 v[76:79], v3, s[8:11], s46 offen sc1
    ds_write_b128 v7, v[92:95] offset:57344
    buffer_load_dwordx4 v[80:83], v4, s[8:11], s47 offen sc1
    ds_write_b128 v7, v[96:99] offset:64512
    buffer_load_dwordx4 v[84:87], v5, s[8:11], s47 offen sc1
    ds_write_b128 v167, v[100:103] offset:32768
    s_barrier
    s_waitcnt vmcnt(28)
    s_waitcnt lgkmcnt(0)
    s_lshl_b32 s46, s41, 13
    s_add_u32 s46, s46, s30
    s_lshl_b32 s47, s41, 7
    s_cmp_ge_u32 s41, 9
    s_cselect_b32 s48, 662400, 0
    s_add_u32 s47, s47, s48
    s_add_u32 s47, s47, 12544000
    s_add_u32 s41, s41, 1
    s_cmp_eq_u32 s41, 18
    s_cselect_b32 s41, 0, s41
    buffer_load_dwordx4 v[88:91], v2, s[8:11], s46 offen sc1
    ds_write_b128 v7, v[104:107] offset:4096
    buffer_load_dwordx4 v[92:95], v3, s[8:11], s46 offen sc1
    ds_write_b128 v7, v[108:111] offset:5120
    buffer_load_dwordx4 v[96:99], v4, s[8:11], s47 offen sc1
    ds_write_b128 v7, v[112:115] offset:12288
    buffer_load_dwordx4 v[100:103], v5, s[8:11], s47 offen sc1
    ds_write_b128 v7, v[116:119] offset:13312
    s_barrier
    s_waitcnt vmcnt(28)
    s_waitcnt lgkmcnt(0)
    s_lshl_b32 s46, s41, 13
    s_add_u32 s46, s46, s30
    s_lshl_b32 s47, s41, 7
    s_cmp_ge_u32 s41, 9
    s_cselect_b32 s48, 662400, 0
    s_add_u32 s47, s47, s48
    s_add_u32 s47, s47, 12544000
    s_add_u32 s41, s41, 1
    s_cmp_eq_u32 s41, 18
    s_cselect_b32 s41, 0, s41
    buffer_load_dwordx4 v[104:107], v2, s[8:11], s46 offen sc1
    ds_write_b128 v7, v[120:123] offset:21504
    buffer_load_dwordx4 v[108:111], v3, s[8:11], s46 offen sc1
    ds_write_b128 v7, v[124:127] offset:22528
    buffer_load_dwordx4 v[112:115], v4, s[8:11], s47 offen sc1
    ds_write_b128 v7, v[128:131] offset:29696
    buffer_load_dwordx4 v[116:119], v5, s[8:11], s47 offen sc1
    ds_write_b128 v7, v[132:135] offset:30720
    s_barrier
    s_waitcnt lgkmcnt(0)
    s_lshl_b32 s46, s41, 13
    s_add_u32 s46, s46, s30
    s_lshl_b32 s47, s41, 7
    s_cmp_ge_u32 s41, 9
    s_cselect_b32 s48, 662400, 0
    s_add_u32 s47, s47, s48
    s_add_u32 s47, s47, 12544000
    s_add_u32 s41, s41, 1
    s_cmp_eq_u32 s41, 18
    s_cselect_b32 s41, 0, s41
    buffer_load_dwordx4 v[120:123], v2, s[8:11], s46 offen sc1
    buffer_load_dwordx4 v[124:127], v3, s[8:11], s46 offen sc1
    buffer_load_dwordx4 v[128:131], v4, s[8:11], s47 offen sc1
    buffer_load_dwordx4 v[132:135], v5, s[8:11], s47 offen sc1
    s_barrier
    s_waitcnt vmcnt(20)
    ds_write_b128 v7, v[40:43] offset:38912
    ds_write_b128 v7, v[44:47] offset:39936
    ds_write_b128 v7, v[48:51] offset:47104
    ds_write_b128 v7, v[52:55] offset:48128
    s_barrier
    s_waitcnt vmcnt(16)
    s_waitcnt lgkmcnt(0)
    s_lshl_b32 s46, s41, 13
    s_add_u32 s46, s46, s30
    s_lshl_b32 s47, s41, 7
    s_cmp_ge_u32 s41, 9
    s_cselect_b32 s48, 662400, 0
    s_add_u32 s47, s47, s48
    s_add_u32 s47, s47, 12544000
    s_add_u32 s41, s41, 1
    s_cmp_eq_u32 s41, 18
    s_cselect_b32 s41, 0, s41
    buffer_load_dwordx4 v[40:43], v2, s[8:11], s46 offen sc1
    ds_write_b128 v7, v[56:59] offset:56320
    buffer_load_dwordx4 v[44:47], v3, s[8:11], s46 offen sc1
    ds_write_b128 v7, v[60:63] offset:57344
    buffer_load_dwordx4 v[48:51], v4, s[8:11], s47 offen sc1
    ds_write_b128 v7, v[64:67] offset:64512
    buffer_load_dwordx4 v[52:55], v5, s[8:11], s47 offen sc1
    ds_write_b128 v167, v[68:71] offset:32768
    s_barrier
    s_waitcnt vmcnt(16)
    s_waitcnt lgkmcnt(0)
    s_lshl_b32 s46, s41, 13
    s_add_u32 s46, s46, s30
    s_lshl_b32 s47, s41, 7
    s_cmp_ge_u32 s41, 9
    s_cselect_b32 s48, 662400, 0
    s_add_u32 s47, s47, s48
    s_add_u32 s47, s47, 12544000
    s_add_u32 s41, s41, 1
    s_cmp_eq_u32 s41, 18
    s_cselect_b32 s41, 0, s41
    buffer_load_dwordx4 v[56:59], v2, s[8:11], s46 offen sc1
    ds_write_b128 v7, v[72:75] offset:4096
    buffer_load_dwordx4 v[60:63], v3, s[8:11], s46 offen sc1
    ds_write_b128 v7, v[76:79] offset:5120
    buffer_load_dwordx4 v[64:67], v4, s[8:11], s47 offen sc1
    ds_write_b128 v7, v[80:83] offset:12288
    buffer_load_dwordx4 v[68:71], v5, s[8:11], s47 offen sc1
    ds_write_b128 v7, v[84:87] offset:13312
    s_barrier
    s_waitcnt vmcnt(16)
    s_waitcnt lgkmcnt(0)
    ds_write_b128 v7, v[88:91] offset:21504
    ds_write_b128 v7, v[92:95] offset:22528
    ds_write_b128 v7, v[96:99] offset:29696
    ds_write_b128 v7, v[100:103] offset:30720
    s_lshl_b32 s46, s6, 6
    s_add_u32 s46, s46, 32
    v_add_u32 v20, s46, v160
    v_mul_u32_u24 v16, 1152, v20
    s_mul_i32 s47, s7, 144
    v_lshl_add_u32 v21, v161, 3, s47
    v_add_u32 v16, v16, v21
    v_lshlrev_b32 v17, 2, v20
    v_mul_u32_u24 v18, 2304, v20
    v_lshl_add_u32 v18, v21, 1, v18
    v_mul_u32_u24 v19, 304, v160
    v_lshl_add_u32 v19, v161, 4, v19
    v_add_u32 v19, 9728, v19
    v_mov_b32 v22, v21
    buffer_load_dwordx2 v[20:21], v22, s[20:23], 0 offen
    s_mov_b32 s47, 12525568
    buffer_load_dwordx2 v[22:23], v16, s[16:19], s34 offen offset:0
    buffer_load_dword v34, v17, s[8:11], s47 offen offset:0
    buffer_load_dwordx2 v[24:25], v16, s[16:19], s35 offen offset:3456
    buffer_load_dword v35, v17, s[8:11], s47 offen offset:12
    buffer_load_dwordx2 v[26:27], v16, s[16:19], s36 offen offset:2816
    buffer_load_dword v36, v17, s[8:11], s47 offen offset:24
    buffer_load_dwordx2 v[28:29], v16, s[16:19], s37 offen offset:2176
    buffer_load_dword v37, v17, s[8:11], s47 offen offset:36
    buffer_load_dwordx2 v[30:31], v16, s[16:19], s38 offen offset:1536
    buffer_load_dword v38, v17, s[8:11], s47 offen offset:48
    buffer_load_dwordx2 v[32:33], v16, s[16:19], s39 offen offset:896
    buffer_load_dword v39, v17, s[8:11], s47 offen offset:60
    s_barrier
    s_waitcnt vmcnt(25)
    s_waitcnt lgkmcnt(0)
    s_lshl_b32 s46, s42, 13
    s_add_u32 s46, s46, s31
    buffer_load_dwordx4 v[72:75], v7, s[8:11], s46 offen sc1
    ds_write_b128 v7, v[104:107] offset:38912
    buffer_load_dwordx4 v[76:79], v7, s[8:11], s46 offen offset:1024 sc1
    ds_write_b128 v7, v[108:111] offset:39936
    s_add_u32 s42, s42, 1
    s_cmp_eq_u32 s42, 9
    s_cselect_b32 s42, 0, s42
    s_lshl_b32 s46, s42, 13
    s_add_u32 s46, s46, s31
    buffer_load_dwordx4 v[80:83], v7, s[8:11], s46 offen sc1
    ds_write_b128 v7, v[112:115] offset:47104
    buffer_load_dwordx4 v[84:87], v7, s[8:11], s46 offen offset:1024 sc1
    ds_write_b128 v7, v[116:119] offset:48128
    s_add_u32 s42, s42, 1
    s_cmp_eq_u32 s42, 9
    s_cselect_b32 s42, 0, s42
    s_barrier
    s_waitcnt vmcnt(25)
    s_waitcnt lgkmcnt(0)
    s_lshl_b32 s46, s42, 13
    s_add_u32 s46, s46, s31
    buffer_load_dwordx4 v[88:91], v7, s[8:11], s46 offen sc1
    ds_write_b128 v7, v[120:123] offset:56320
    buffer_load_dwordx4 v[92:95], v7, s[8:11], s46 offen offset:1024 sc1
    ds_write_b128 v7, v[124:127] offset:57344
    s_add_u32 s42, s42, 1
    s_cmp_eq_u32 s42, 9
    s_cselect_b32 s42, 0, s42
    s_lshl_b32 s46, s42, 13
    s_add_u32 s46, s46, s31
    buffer_load_dwordx4 v[96:99], v7, s[8:11], s46 offen sc1
    ds_write_b128 v7, v[128:131] offset:64512
    buffer_load_dwordx4 v[100:103], v7, s[8:11], s46 offen offset:1024 sc1
    ds_write_b128 v167, v[132:135] offset:32768
    s_add_u32 s42, s42, 1
    s_cmp_eq_u32 s42, 9
    s_cselect_b32 s42, 0, s42
    s_barrier
    s_waitcnt vmcnt(25)
    s_waitcnt lgkmcnt(0)
    s_lshl_b32 s46, s42, 13
    s_add_u32 s46, s46, s31
    buffer_load_dwordx4 v[104:107], v7, s[8:11], s46 offen sc1
    ds_write_b128 v7, v[40:43] offset:4096
    buffer_load_dwordx4 v[108:111], v7, s[8:11], s46 offen offset:1024 sc1
    ds_write_b128 v7, v[44:47] offset:5120
    s_add_u32 s42, s42, 1
    s_cmp_eq_u32 s42, 9
    s_cselect_b32 s42, 0, s42
    s_lshl_b32 s46, s42, 13
    s_add_u32 s46, s46, s31
    buffer_load_dwordx4 v[112:115], v7, s[8:11], s46 offen sc1
    ds_write_b128 v7, v[48:51] offset:12288
    buffer_load_dwordx4 v[116:119], v7, s[8:11], s46 offen offset:1024 sc1
    ds_write_b128 v7, v[52:55] offset:13312
    s_add_u32 s42, s42, 1
    s_cmp_eq_u32 s42, 9
    s_cselect_b32 s42, 0, s42
    s_barrier
    s_waitcnt vmcnt(25)
    s_waitcnt lgkmcnt(0)
    s_lshl_b32 s46, s42, 13
    s_add_u32 s46, s46, s31
    buffer_load_dwordx4 v[120:123], v7, s[8:11], s46 offen sc1
    ds_write_b128 v7, v[56:59] offset:21504
    buffer_load_dwordx4 v[124:127], v7, s[8:11], s46 offen offset:1024 sc1
    ds_write_b128 v7, v[60:63] offset:22528
    s_add_u32 s42, s42, 1
    s_cmp_eq_u32 s42, 9
    s_cselect_b32 s42, 0, s42
    s_lshl_b32 s46, s42, 13
    s_add_u32 s46, s46, s31
    buffer_load_dwordx4 v[128:131], v7, s[8:11], s46 offen sc1
    ds_write_b128 v7, v[64:67] offset:29696
    buffer_load_dwordx4 v[132:135], v7, s[8:11], s46 offen offset:1024 sc1
    ds_write_b128 v7, v[68:71] offset:30720
    s_add_u32 s42, s42, 1
    s_cmp_eq_u32 s42, 9
    s_cselect_b32 s42, 0, s42
    s_barrier
    s_waitcnt vmcnt(14)
    s_waitcnt lgkmcnt(0)
    s_lshl_b32 s46, s42, 13
    s_add_u32 s46, s46, s31
    buffer_load_dwordx4 v[40:43], v7, s[8:11], s46 offen sc1
    ds_write_b128 v7, v[72:75] offset:38912
    buffer_load_dwordx4 v[44:47], v7, s[8:11], s46 offen offset:1024 sc1
    ds_write_b128 v7, v[76:79] offset:39936
    s_add_u32 s42, s42, 1
    s_cmp_eq_u32 s42, 9
    s_cselect_b32 s42, 0, s42
    s_barrier
    s_waitcnt vmcnt(14)
    s_waitcnt lgkmcnt(0)
    ds_write_b128 v7, v[80:83] offset:56320
    ds_write_b128 v7, v[84:87] offset:57344
    s_barrier
    s_waitcnt vmcnt(12)
    s_waitcnt lgkmcnt(0)
    ds_write_b128 v7, v[88:91] offset:4096
    ds_write_b128 v7, v[92:95] offset:5120
    s_barrier
    s_waitcnt vmcnt(10)
    s_waitcnt lgkmcnt(0)
    ds_write_b128 v7, v[96:99] offset:21504
    ds_write_b128 v7, v[100:103] offset:22528
    s_barrier
    s_waitcnt vmcnt(8)
    s_waitcnt lgkmcnt(0)
    ds_write_b128 v7, v[104:107] offset:38912
    ds_write_b128 v7, v[108:111] offset:39936
    s_barrier
    s_waitcnt vmcnt(6)
    s_waitcnt lgkmcnt(0)
    ds_write_b128 v7, v[112:115] offset:56320
    ds_write_b128 v7, v[116:119] offset:57344
    s_barrier
    s_waitcnt vmcnt(4)
    s_waitcnt lgkmcnt(0)
    ds_write_b128 v7, v[120:123] offset:4096
    ds_write_b128 v7, v[124:127] offset:5120
    s_barrier
    s_waitcnt vmcnt(2)
    s_waitcnt lgkmcnt(0)
    ds_write_b128 v7, v[128:131] offset:21504
    ds_write_b128 v7, v[132:135] offset:22528
    s_barrier
    s_waitcnt vmcnt(0)
    s_waitcnt lgkmcnt(0)
    ds_write_b128 v7, v[40:43] offset:38912
    ds_write_b128 v7, v[44:47] offset:39936
    s_barrier
    s_waitcnt lgkmcnt(0)
    s_barrier
    s_waitcnt vmcnt(0)
    v_lshlrev_b32 v64, 16, v20
    v_and_b32 v65, 0xffff0000, v20
    v_lshlrev_b32 v66, 16, v21
    v_and_b32 v67, 0xffff0000, v21
    v_lshlrev_b32 v68, 16, v22
    v_and_b32 v69, 0xffff0000, v22
    v_lshlrev_b32 v70, 16, v23
    v_and_b32 v71, 0xffff0000, v23
    v_mul_f32 v68, v68, v64
    v_mul_f32 v69, v69, v65
    v_mul_f32 v70, v70, v66
    v_mul_f32 v71, v71, v67
    v_lshlrev_b32 v72, 16, v24
    v_and_b32 v73, 0xffff0000, v24
    v_lshlrev_b32 v74, 16, v25
    v_and_b32 v75, 0xffff0000, v25
    v_mul_f32 v72, v72, v64
    v_mul_f32 v73, v73, v65
    v_mul_f32 v74, v74, v66
    v_mul_f32 v75, v75, v67
    v_lshlrev_b32 v76, 16, v26
    v_and_b32 v77, 0xffff0000, v26
    v_lshlrev_b32 v78, 16, v27
    v_and_b32 v79, 0xffff0000, v27
    v_mul_f32 v76, v76, v64
    v_mul_f32 v77, v77, v65
    v_mul_f32 v78, v78, v66
    v_mul_f32 v79, v79, v67
    v_lshlrev_b32 v80, 16, v28
    v_and_b32 v81, 0xffff0000, v28
    v_lshlrev_b32 v82, 16, v29
    v_and_b32 v83, 0xffff0000, v29
    v_mul_f32 v80, v80, v64
    v_mul_f32 v81, v81, v65
    v_mul_f32 v82, v82, v66
    v_mul_f32 v83, v83, v67
    v_lshlrev_b32 v84, 16, v30
    v_and_b32 v85, 0xffff0000, v30
    v_lshlrev_b32 v86, 16, v31
    v_and_b32 v87, 0xffff0000, v31
    v_mul_f32 v84, v84, v64
    v_mul_f32 v85, v85, v65
    v_mul_f32 v86, v86, v66
    v_mul_f32 v87, v87, v67
    v_lshlrev_b32 v88, 16, v32
    v_and_b32 v89, 0xffff0000, v32
    v_lshlrev_b32 v90, 16, v33
    v_and_b32 v91, 0xffff0000, v33
    v_mul_f32 v88, v88, v64
    v_mul_f32 v89, v89, v65
    v_mul_f32 v90, v90, v66
    v_mul_f32 v91, v91, v67
    s_barrier
    s_mov_b32 exec_hi, 0x003fffff
    ds_read_b128 v[92:95], v19 offset:0
    ds_read_b128 v[96:99], v19 offset:912
    ds_read_b128 v[100:103], v19 offset:1824
    ds_read_b128 v[104:107], v19 offset:2736
    ds_read_b128 v[108:111], v19 offset:3648
    ds_read_b128 v[112:115], v19 offset:4560
    s_waitcnt lgkmcnt(5)
    v_fmac_f32 v92, v34, v68
    v_fmac_f32 v93, v34, v69
    v_fmac_f32 v94, v34, v70
    v_fmac_f32 v95, v34, v71
    s_mov_b32 s46, 0
    buffer_store_dwordx4 v[92:95], v18, s[24:27], s46 offen sc1
    s_waitcnt lgkmcnt(4)
    v_fmac_f32 v96, v35, v72
    v_fmac_f32 v97, v35, v73
    v_fmac_f32 v98, v35, v74
    v_fmac_f32 v99, v35, v75
    s_mov_b32 s46, 6912
    buffer_store_dwordx4 v[96:99], v18, s[24:27], s46 offen sc1
    s_waitcnt lgkmcnt(3)
    v_fmac_f32 v100, v36, v76
    v_fmac_f32 v101, v36, v77
    v_fmac_f32 v102, v36, v78
    v_fmac_f32 v103, v36, v79
    s_mov_b32 s46, 13824
    buffer_store_dwordx4 v[100:103], v18, s[24:27], s46 offen sc1
    s_waitcnt lgkmcnt(2)
    v_fmac_f32 v104, v37, v80
    v_fmac_f32 v105, v37, v81
    v_fmac_f32 v106, v37, v82
    v_fmac_f32 v107, v37, v83
    s_mov_b32 s46, 20736
    buffer_store_dwordx4 v[104:107], v18, s[24:27], s46 offen sc1
    s_waitcnt lgkmcnt(1)
    v_fmac_f32 v108, v38, v84
    v_fmac_f32 v109, v38, v85
    v_fmac_f32 v110, v38, v86
    v_fmac_f32 v111, v38, v87
    s_mov_b32 s46, 27648
    buffer_store_dwordx4 v[108:111], v18, s[24:27], s46 offen sc1
    s_mov_b32 exec_hi, 0
    s_mov_b32 exec_lo, 0x3ffff
    s_waitcnt lgkmcnt(0)
    v_fmac_f32 v112, v39, v88
    v_fmac_f32 v113, v39, v89
    v_fmac_f32 v114, v39, v90
    v_fmac_f32 v115, v39, v91
    s_mov_b32 s46, 34560
    buffer_store_dwordx4 v[112:115], v18, s[24:27], s46 offen sc1
    s_endpgm
K3_L3:
    s_mul_i32 s30, s6, 147456
    s_add_u32 s30, s30, 7217152
    s_mul_i32 s31, s6, 73728
    s_add_u32 s31, s31, 13877248
    v_add_u32 v15, 124928, v7
    s_waitcnt lgkmcnt(0)
    s_mov_b32 s47, 497664
    buffer_load_dwordx4 v[16:19], v8, s[12:15], s47 offen
    buffer_load_dwordx4 v[20:23], v9, s[12:15], s47 offen
    s_mov_b32 s47, 580608
    buffer_load_dwordx4 v[24:27], v8, s[12:15], s47 offen
    buffer_load_dwordx4 v[28:31], v9, s[12:15], s47 offen
    s_mov_b32 s47, 0
    buffer_load_dwordx4 v[32:35], v156, s[12:15], s47 offen
    buffer_load_dwordx4 v[36:39], v157, s[12:15], s47 offen
    s_mov_b32 s35, 65536
K23_PWr3:
    ds_read_b32 v163, v162 offset:44
    s_waitcnt lgkmcnt(0)
    v_cmp_eq_u32 vcc, 8, v163
    s_cbranch_vccnz K23_QWr3
    s_sleep 4
    s_sub_u32 s35, s35, 1
    s_cmp_lg_u32 s35, 0
    s_cbranch_scc1 K23_PWr3
K23_QWr3:
    s_mov_b32 s35, 65536
K23_PWg3:
    ds_read_b32 v163, v162 offset:0
    s_waitcnt lgkmcnt(0)
    v_cmp_eq_u32 vcc, 1, v163
    s_cbranch_vccnz K23_QWg3
    s_sleep 8
    s_sub_u32 s35, s35, 1
    s_cmp_lg_u32 s35, 0
    s_cbranch_scc1 K23_PWg3
K23_QWg3:
    s_lshl_b32 s46, s41, 13
    s_add_u32 s46, s46, s30
    s_lshl_b32 s47, s41, 7
    s_cmp_ge_u32 s41, 9
    s_cselect_b32 s48, 662400, 0
    s_add_u32 s47, s47, s48
    s_add_u32 s47, s47, 12544000
    s_add_u32 s41, s41, 1
    s_cmp_eq_u32 s41, 18
    s_cselect_b32 s41, 0, s41
    s_mov_b32 m0, 6144
    s_nop 0
    buffer_load_dwordx4 v2, s[8:11], s46 offen sc1 lds
    s_mov_b32 m0, 7168
    s_nop 0
    buffer_load_dwordx4 v3, s[8:11], s46 offen sc1 lds
    s_mov_b32 m0, 14336
    s_nop 0
    buffer_load_dwordx4 v4, s[8:11], s47 offen sc1 lds
    s_mov_b32 m0, 15360
    s_nop 0
    buffer_load_dwordx4 v5, s[8:11], s47 offen sc1 lds
    s_mov_b32 m0, 16384
    s_nop 0
    buffer_load_dwordx4 v6, s[8:11], s47 offen sc1 lds
    s_lshl_b32 s46, s41, 13
    s_add_u32 s46, s46, s30
    s_lshl_b32 s47, s41, 7
    s_cmp_ge_u32 s41, 9
    s_cselect_b32 s48, 662400, 0
    s_add_u32 s47, s47, s48
    s_add_u32 s47, s47, 12544000
    s_add_u32 s41, s41, 1
    s_cmp_eq_u32 s41, 18
    s_cselect_b32 s41, 0, s41
    s_mov_b32 m0, 23552
    s_nop 0
    buffer_load_dwordx4 v2, s[8:11], s46 offen sc1 lds
    s_mov_b32 m0, 24576
    s_nop 0
    buffer_load_dwordx4 v3, s[8:11], s46 offen sc1 lds
    s_mov_b32 m0, 31744
    s_nop 0
    buffer_load_dwordx4 v4, s[8:11], s47 offen sc1 lds
    s_mov_b32 m0, 32768
    s_nop 0
    buffer_load_dwordx4 v5, s[8:11], s47 offen sc1 lds
    s_mov_b32 m0, 33792
    s_nop 0
    buffer_load_dwordx4 v6, s[8:11], s47 offen sc1 lds
    s_lshl_b32 s46, s41, 13
    s_add_u32 s46, s46, s30
    s_lshl_b32 s47, s41, 7
    s_cmp_ge_u32 s41, 9
    s_cselect_b32 s48, 662400, 0
    s_add_u32 s47, s47, s48
    s_add_u32 s47, s47, 12544000
    s_add_u32 s41, s41, 1
    s_cmp_eq_u32 s41, 18
    s_cselect_b32 s41, 0, s41
    s_mov_b32 m0, 40960
    s_nop 0
    buffer_load_dwordx4 v2, s[8:11], s46 offen sc1 lds
    s_mov_b32 m0, 41984
    s_nop 0
    buffer_load_dwordx4 v3, s[8:11], s46 offen sc1 lds
    s_mov_b32 m0, 49152
    s_nop 0
    buffer_load_dwordx4 v4, s[8:11], s47 offen sc1 lds
    s_mov_b32 m0, 50176
    s_nop 0
    buffer_load_dwordx4 v5, s[8:11], s47 offen sc1 lds
    s_mov_b32 m0, 51200
    s_nop 0
    buffer_load_dwordx4 v6, s[8:11], s47 offen sc1 lds
    s_lshl_b32 s46, s41, 13
    s_add_u32 s46, s46, s30
    s_lshl_b32 s47, s41, 7
    s_cmp_ge_u32 s41, 9
    s_cselect_b32 s48, 662400, 0
    s_add_u32 s47, s47, s48
    s_add_u32 s47, s47, 12544000
    s_add_u32 s41, s41, 1
    s_cmp_eq_u32 s41, 18
    s_cselect_b32 s41, 0, s41
    s_mov_b32 m0, 58368
    s_nop 0
    buffer_load_dwordx4 v2, s[8:11], s46 offen sc1 lds
    s_mov_b32 m0, 59392
    s_nop 0
    buffer_load_dwordx4 v3, s[8:11], s46 offen sc1 lds
    s_mov_b32 m0, 66560
    s_nop 0
    buffer_load_dwordx4 v4, s[8:11], s47 offen sc1 lds
    s_mov_b32 m0, 67584
    s_nop 0
    buffer_load_dwordx4 v5, s[8:11], s47 offen sc1 lds
    s_mov_b32 m0, 68608
    s_nop 0
    buffer_load_dwordx4 v6, s[8:11], s47 offen sc1 lds
    s_lshl_b32 s46, s41, 13
    s_add_u32 s46, s46, s30
    s_lshl_b32 s47, s41, 7
    s_cmp_ge_u32 s41, 9
    s_cselect_b32 s48, 662400, 0
    s_add_u32 s47, s47, s48
    s_add_u32 s47, s47, 12544000
    s_add_u32 s41, s41, 1
    s_cmp_eq_u32 s41, 18
    s_cselect_b32 s41, 0, s41
    buffer_load_dwordx4 v[40:43], v2, s[8:11], s46 offen sc1
    buffer_load_dwordx4 v[44:47], v3, s[8:11], s46 offen sc1
    buffer_load_dwordx4 v[48:51], v4, s[8:11], s47 offen sc1
    buffer_load_dwordx4 v[52:55], v5, s[8:11], s47 offen sc1
    buffer_load_dwordx4 v[56:59], v6, s[8:11], s47 offen sc1
    s_lshl_b32 s46, s41, 13
    s_add_u32 s46, s46, s30
    s_lshl_b32 s47, s41, 7
    s_cmp_ge_u32 s41, 9
    s_cselect_b32 s48, 662400, 0
    s_add_u32 s47, s47, s48
    s_add_u32 s47, s47, 12544000
    s_add_u32 s41, s41, 1
    s_cmp_eq_u32 s41, 18
    s_cselect_b32 s41, 0, s41
    buffer_load_dwordx4 v[60:63], v2, s[8:11], s46 offen sc1
    buffer_load_dwordx4 v[64:67], v3, s[8:11], s46 offen sc1
    buffer_load_dwordx4 v[68:71], v4, s[8:11], s47 offen sc1
    buffer_load_dwordx4 v[72:75], v5, s[8:11], s47 offen sc1
    buffer_load_dwordx4 v[76:79], v6, s[8:11], s47 offen sc1
    s_lshl_b32 s46, s41, 13
    s_add_u32 s46, s46, s30
    s_lshl_b32 s47, s41, 7
    s_cmp_ge_u32 s41, 9
    s_cselect_b32 s48, 662400, 0
    s_add_u32 s47, s47, s48
    s_add_u32 s47, s47, 12544000
    s_add_u32 s41, s41, 1
    s_cmp_eq_u32 s41, 18
    s_cselect_b32 s41, 0, s41
    buffer_load_dwordx4 v[80:83], v2, s[8:11], s46 offen sc1
    buffer_load_dwordx4 v[84:87], v3, s[8:11], s46 offen sc1
    buffer_load_dwordx4 v[88:91], v4, s[8:11], s47 offen sc1
    buffer_load_dwordx4 v[92:95], v5, s[8:11], s47 offen sc1
    buffer_load_dwordx4 v[96:99], v6, s[8:11], s47 offen sc1
    s_lshl_b32 s46, s41, 13
    s_add_u32 s46, s46, s30
    s_lshl_b32 s47, s41, 7
    s_cmp_ge_u32 s41, 9
    s_cselect_b32 s48, 662400, 0
    s_add_u32 s47, s47, s48
    s_add_u32 s47, s47, 12544000
    s_add_u32 s41, s41, 1
    s_cmp_eq_u32 s41, 18
    s_cselect_b32 s41, 0, s41
    buffer_load_dwordx4 v[100:103], v2, s[8:11], s46 offen sc1
    buffer_load_dwordx4 v[104:107], v3, s[8:11], s46 offen sc1
    buffer_load_dwordx4 v[108:111], v4, s[8:11], s47 offen sc1
    buffer_load_dwordx4 v[112:115], v5, s[8:11], s47 offen sc1
    buffer_load_dwordx4 v[116:119], v6, s[8:11], s47 offen sc1
    s_lshl_b32 s46, s41, 13
    s_add_u32 s46, s46, s30
    s_lshl_b32 s47, s41, 7
    s_cmp_ge_u32 s41, 9
    s_cselect_b32 s48, 662400, 0
    s_add_u32 s47, s47, s48
    s_add_u32 s47, s47, 12544000
    s_add_u32 s41, s41, 1
    s_cmp_eq_u32 s41, 18
    s_cselect_b32 s41, 0, s41
    buffer_load_dwordx4 v[120:123], v2, s[8:11], s46 offen sc1
    buffer_load_dwordx4 v[124:127], v3, s[8:11], s46 offen sc1
    buffer_load_dwordx4 v[128:131], v4, s[8:11], s47 offen sc1
    buffer_load_dwordx4 v[132:135], v5, s[8:11], s47 offen sc1
    buffer_load_dwordx4 v[136:139], v6, s[8:11], s47 offen sc1
    s_lshl_b32 s46, s41, 13
    s_add_u32 s46, s46, s30
    s_lshl_b32 s47, s41, 7
    s_cmp_ge_u32 s41, 9
    s_cselect_b32 s48, 662400, 0
    s_add_u32 s47, s47, s48
    s_add_u32 s47, s47, 12544000
    s_add_u32 s41, s41, 1
    s_cmp_eq_u32 s41, 18
    s_cselect_b32 s41, 0, s41
    buffer_load_dwordx4 v[140:143], v2, s[8:11], s46 offen sc1
    buffer_load_dwordx4 v[144:147], v3, s[8:11], s46 offen sc1
    buffer_load_dwordx4 v[148:151], v4, s[8:11], s47 offen sc1
    buffer_load_dwordx4 v[152:155], v5, s[8:11], s47 offen sc1
    buffer_load_dwordx4 v[156:159], v6, s[8:11], s47 offen sc1
    s_mov_b32 s35, 65536
K23_PWa3:
    ds_read_b32 v163, v162 offset:52
    s_waitcnt lgkmcnt(0)
    v_cmp_eq_u32 vcc, 8, v163
    s_cbranch_vccnz K23_QWa3
    s_sleep 4
    s_sub_u32 s35, s35, 1
    s_cmp_lg_u32 s35, 0
    s_cbranch_scc1 K23_PWa3
K23_QWa3:
    s_waitcnt vmcnt(30)
    s_mov_b32 s47, 0
    s_mov_b32 m0, 75776
    s_nop 0
    buffer_load_dwordx4 v8, s[12:15], s47 offen lds
    s_mov_b32 m0, 76800
    s_nop 0
    buffer_load_dwordx4 v9, s[12:15], s47 offen lds
    s_mov_b32 s47, 82944
    s_mov_b32 m0, 84992
    s_nop 0
    buffer_load_dwordx4 v8, s[12:15], s47 offen lds
    s_mov_b32 m0, 86016
    s_nop 0
    buffer_load_dwordx4 v9, s[12:15], s47 offen lds
    s_mov_b32 s47, 165888
    s_mov_b32 m0, 94208
    s_nop 0
    buffer_load_dwordx4 v8, s[12:15], s47 offen lds
    s_mov_b32 m0, 95232
    s_nop 0
    buffer_load_dwordx4 v9, s[12:15], s47 offen lds
    s_mov_b32 s47, 248832
    s_mov_b32 m0, 103424
    s_nop 0
    buffer_load_dwordx4 v8, s[12:15], s47 offen lds
    s_mov_b32 m0, 104448
    s_nop 0
    buffer_load_dwordx4 v9, s[12:15], s47 offen lds
    s_mov_b32 s35, 65536
K23_PWb3:
    ds_read_b32 v163, v162 offset:56
    s_waitcnt lgkmcnt(0)
    v_cmp_eq_u32 vcc, 8, v163
    s_cbranch_vccnz K23_QWb3
    s_sleep 4
    s_sub_u32 s35, s35, 1
    s_cmp_lg_u32 s35, 0
    s_cbranch_scc1 K23_PWb3
K23_QWb3:
    s_mov_b32 s47, 331776
    s_mov_b32 m0, 112640
    s_nop 0
    buffer_load_dwordx4 v8, s[12:15], s47 offen lds
    s_mov_b32 m0, 113664
    s_nop 0
    buffer_load_dwordx4 v9, s[12:15], s47 offen lds
    s_mov_b32 s47, 414720
    s_mov_b32 m0, 121856
    s_nop 0
    buffer_load_dwordx4 v8, s[12:15], s47 offen lds
    s_mov_b32 m0, 122880
    s_nop 0
    buffer_load_dwordx4 v9, s[12:15], s47 offen lds
    s_mov_b32 s34, 0
    s_mov_b32 s35, 0
    s_mov_b32 s36, 4096
    s_mov_b32 s37, 8192
    s_mov_b32 s38, 12288
    s_mov_b32 s39, 16384
    s_barrier
    ds_write_b128 v15, v[16:19] offset:6144
    ds_write_b128 v15, v[20:23] offset:7168
    s_barrier
    ds_write_b128 v15, v[24:27] offset:15360
    ds_write_b128 v15, v[28:31] offset:16384
    s_waitcnt vmcnt(37)
    s_waitcnt lgkmcnt(2)
    ds_write_b128 v7, v[40:43] offset:6144
    ds_write_b128 v7, v[44:47] offset:7168
    ds_write_b128 v7, v[48:51] offset:14336
    ds_write_b128 v7, v[52:55] offset:15360
    ds_write_b128 v7, v[56:59] offset:16384
    s_barrier
    ds_write_b128 v15, v[32:35] offset:24576
    ds_write_b128 v15, v[36:39] offset:25600
    s_waitcnt vmcnt(32)
    s_waitcnt lgkmcnt(2)
    s_lshl_b32 s46, s41, 13
    s_add_u32 s46, s46, s30
    s_lshl_b32 s47, s41, 7
    s_cmp_ge_u32 s41, 9
    s_cselect_b32 s48, 662400, 0
    s_add_u32 s47, s47, s48
    s_add_u32 s47, s47, 12544000
    s_add_u32 s41, s41, 1
    s_cmp_eq_u32 s41, 18
    s_cselect_b32 s41, 0, s41
    buffer_load_dwordx4 v[40:43], v2, s[8:11], s46 offen sc1
    ds_write_b128 v7, v[60:63] offset:23552
    buffer_load_dwordx4 v[44:47], v3, s[8:11], s46 offen sc1
    ds_write_b128 v7, v[64:67] offset:24576
    buffer_load_dwordx4 v[48:51], v4, s[8:11], s47 offen sc1
    ds_write_b128 v7, v[68:71] offset:31744
    buffer_load_dwordx4 v[52:55], v5, s[8:11], s47 offen sc1
    ds_write_b128 v7, v[72:75] offset:32768
    buffer_load_dwordx4 v[56:59], v6, s[8:11], s47 offen sc1
    ds_write_b128 v7, v[76:79] offset:33792
    s_barrier
    s_waitcnt vmcnt(32)
    s_waitcnt lgkmcnt(0)
    s_lshl_b32 s46, s41, 13
    s_add_u32 s46, s46, s30
    s_lshl_b32 s47, s41, 7
    s_cmp_ge_u32 s41, 9
    s_cselect_b32 s48, 662400, 0
    s_add_u32 s47, s47, s48
    s_add_u32 s47, s47, 12544000
    s_add_u32 s41, s41, 1
    s_cmp_eq_u32 s41, 18
    s_cselect_b32 s41, 0, s41
    buffer_load_dwordx4 v[60:63], v2, s[8:11], s46 offen sc1
    ds_write_b128 v7, v[80:83] offset:40960
    buffer_load_dwordx4 v[64:67], v3, s[8:11], s46 offen sc1
    ds_write_b128 v7, v[84:87] offset:41984
    buffer_load_dwordx4 v[68:71], v4, s[8:11], s47 offen sc1
    ds_write_b128 v7, v[88:91] offset:49152
    buffer_load_dwordx4 v[72:75], v5, s[8:11], s47 offen sc1
    ds_write_b128 v7, v[92:95] offset:50176
    buffer_load_dwordx4 v[76:79], v6, s[8:11], s47 offen sc1
    ds_write_b128 v7, v[96:99] offset:51200
    s_barrier
    s_waitcnt vmcnt(32)
    s_waitcnt lgkmcnt(0)
    s_lshl_b32 s46, s41, 13
    s_add_u32 s46, s46, s30
    s_lshl_b32 s47, s41, 7
    s_cmp_ge_u32 s41, 9
    s_cselect_b32 s48, 662400, 0
    s_add_u32 s47, s47, s48
    s_add_u32 s47, s47, 12544000
    s_add_u32 s41, s41, 1
    s_cmp_eq_u32 s41, 18
    s_cselect_b32 s41, 0, s41
    buffer_load_dwordx4 v[80:83], v2, s[8:11], s46 offen sc1
    ds_write_b128 v7, v[100:103] offset:58368
    buffer_load_dwordx4 v[84:87], v3, s[8:11], s46 offen sc1
    ds_write_b128 v7, v[104:107] offset:59392
    buffer_load_dwordx4 v[88:91], v4, s[8:11], s47 offen sc1
    ds_write_b128 v167, v[108:111] offset:33792
    buffer_load_dwordx4 v[92:95], v5, s[8:11], s47 offen sc1
    ds_write_b128 v167, v[112:115] offset:34816
    buffer_load_dwordx4 v[96:99], v6, s[8:11], s47 offen sc1
    ds_write_b128 v167, v[116:119] offset:35840
    s_barrier
    s_waitcnt vmcnt(32)
    s_waitcnt lgkmcnt(0)
    s_lshl_b32 s46, s41, 13
    s_add_u32 s46, s46, s30
    s_lshl_b32 s47, s41, 7
    s_cmp_ge_u32 s41, 9
    s_cselect_b32 s48, 662400, 0
    s_add_u32 s47, s47, s48
    s_add_u32 s47, s47, 12544000
    s_add_u32 s41, s41, 1
    s_cmp_eq_u32 s41, 18
    s_cselect_b32 s41, 0, s41
    buffer_load_dwordx4 v[100:103], v2, s[8:11], s46 offen sc1
    ds_write_b128 v7, v[120:123] offset:6144
    buffer_load_dwordx4 v[104:107], v3, s[8:11], s46 offen sc1
    ds_write_b128 v7, v[124:127] offset:7168
    buffer_load_dwordx4 v[108:111], v4, s[8:11], s47 offen sc1
    ds_write_b128 v7, v[128:131] offset:14336
    buffer_load_dwordx4 v[112:115], v5, s[8:11], s47 offen sc1
    ds_write_b128 v7, v[132:135] offset:15360
    buffer_load_dwordx4 v[116:119], v6, s[8:11], s47 offen sc1
    ds_write_b128 v7, v[136:139] offset:16384
    s_barrier
    s_waitcnt vmcnt(32)
    s_waitcnt lgkmcnt(0)
    s_lshl_b32 s46, s41, 13
    s_add_u32 s46, s46, s30
    s_lshl_b32 s47, s41, 7
    s_cmp_ge_u32 s41, 9
    s_cselect_b32 s48, 662400, 0
    s_add_u32 s47, s47, s48
    s_add_u32 s47, s47, 12544000
    s_add_u32 s41, s41, 1
    s_cmp_eq_u32 s41, 18
    s_cselect_b32 s41, 0, s41
    buffer_load_dwordx4 v[120:123], v2, s[8:11], s46 offen sc1
    ds_write_b128 v7, v[140:143] offset:23552
    buffer_load_dwordx4 v[124:127], v3, s[8:11], s46 offen sc1
    ds_write_b128 v7, v[144:147] offset:24576
    buffer_load_dwordx4 v[128:131], v4, s[8:11], s47 offen sc1
    ds_write_b128 v7, v[148:151] offset:31744
    buffer_load_dwordx4 v[132:135], v5, s[8:11], s47 offen sc1
    ds_write_b128 v7, v[152:155] offset:32768
    buffer_load_dwordx4 v[136:139], v6, s[8:11], s47 offen sc1
    ds_write_b128 v7, v[156:159] offset:33792
    s_barrier
    s_waitcnt lgkmcnt(0)
    s_lshl_b32 s46, s41, 13
    s_add_u32 s46, s46, s30
    s_lshl_b32 s47, s41, 7
    s_cmp_ge_u32 s41, 9
    s_cselect_b32 s48, 662400, 0
    s_add_u32 s47, s47, s48
    s_add_u32 s47, s47, 12544000
    s_add_u32 s41, s41, 1
    s_cmp_eq_u32 s41, 18
    s_cselect_b32 s41, 0, s41
    buffer_load_dwordx4 v[140:143], v2, s[8:11], s46 offen sc1
    buffer_load_dwordx4 v[144:147], v3, s[8:11], s46 offen sc1
    buffer_load_dwordx4 v[148:151], v4, s[8:11], s47 offen sc1
    buffer_load_dwordx4 v[152:155], v5, s[8:11], s47 offen sc1
    buffer_load_dwordx4 v[156:159], v6, s[8:11], s47 offen sc1
    s_barrier
    s_waitcnt vmcnt(25)
    ds_write_b128 v7, v[40:43] offset:40960
    ds_write_b128 v7, v[44:47] offset:41984
    ds_write_b128 v7, v[48:51] offset:49152
    ds_write_b128 v7, v[52:55] offset:50176
    ds_write_b128 v7, v[56:59] offset:51200
    s_barrier
    s_waitcnt vmcnt(20)
    s_waitcnt lgkmcnt(0)
    s_lshl_b32 s46, s41, 13
    s_add_u32 s46, s46, s30
    s_lshl_b32 s47, s41, 7
    s_cmp_ge_u32 s41, 9
    s_cselect_b32 s48, 662400, 0
    s_add_u32 s47, s47, s48
    s_add_u32 s47, s47, 12544000
    s_add_u32 s41, s41, 1
    s_cmp_eq_u32 s41, 18
    s_cselect_b32 s41, 0, s41
    buffer_load_dwordx4 v[40:43], v2, s[8:11], s46 offen sc1
    ds_write_b128 v7, v[60:63] offset:58368
    buffer_load_dwordx4 v[44:47], v3, s[8:11], s46 offen sc1
    ds_write_b128 v7, v[64:67] offset:59392
    buffer_load_dwordx4 v[48:51], v4, s[8:11], s47 offen sc1
    ds_write_b128 v167, v[68:71] offset:33792
    buffer_load_dwordx4 v[52:55], v5, s[8:11], s47 offen sc1
    ds_write_b128 v167, v[72:75] offset:34816
    buffer_load_dwordx4 v[56:59], v6, s[8:11], s47 offen sc1
    ds_write_b128 v167, v[76:79] offset:35840
    s_barrier
    s_waitcnt vmcnt(20)
    s_waitcnt lgkmcnt(0)
    s_lshl_b32 s46, s41, 13
    s_add_u32 s46, s46, s30
    s_lshl_b32 s47, s41, 7
    s_cmp_ge_u32 s41, 9
    s_cselect_b32 s48, 662400, 0
    s_add_u32 s47, s47, s48
    s_add_u32 s47, s47, 12544000
    s_add_u32 s41, s41, 1
    s_cmp_eq_u32 s41, 18
    s_cselect_b32 s41, 0, s41
    buffer_load_dwordx4 v[60:63], v2, s[8:11], s46 offen sc1
    ds_write_b128 v7, v[80:83] offset:6144
    buffer_load_dwordx4 v[64:67], v3, s[8:11], s46 offen sc1
    ds_write_b128 v7, v[84:87] offset:7168
    buffer_load_dwordx4 v[68:71], v4, s[8:11], s47 offen sc1
    ds_write_b128 v7, v[88:91] offset:14336
    buffer_load_dwordx4 v[72:75], v5, s[8:11], s47 offen sc1
    ds_write_b128 v7, v[92:95] offset:15360
    buffer_load_dwordx4 v[76:79], v6, s[8:11], s47 offen sc1
    ds_write_b128 v7, v[96:99] offset:16384
    s_barrier
    s_waitcnt vmcnt(20)
    s_waitcnt lgkmcnt(0)
    ds_write_b128 v7, v[100:103] offset:23552
    ds_write_b128 v7, v[104:107] offset:24576
    ds_write_b128 v7, v[108:111] offset:31744
    ds_write_b128 v7, v[112:115] offset:32768
    ds_write_b128 v7, v[116:119] offset:33792
    s_lshl_b32 s46, s6, 6
    s_add_u32 s46, s46, 48
    v_add_u32 v20, s46, v160
    v_mul_u32_u24 v16, 1152, v20
    s_mul_i32 s47, s7, 144
    v_lshl_add_u32 v21, v161, 3, s47
    v_add_u32 v16, v16, v21
    v_lshlrev_b32 v17, 2, v20
    v_mul_u32_u24 v18, 2304, v20
    v_lshl_add_u32 v18, v21, 1, v18
    v_mul_u32_u24 v19, 304, v160
    v_lshl_add_u32 v19, v161, 4, v19
    v_add_u32 v19, 14592, v19
    v_mov_b32 v22, v21
    buffer_load_dwordx2 v[20:21], v22, s[20:23], 0 offen
    s_mov_b32 s47, 12525568
    buffer_load_dwordx2 v[22:23], v16, s[16:19], s34 offen offset:0
    buffer_load_dword v34, v17, s[8:11], s47 offen offset:0
    buffer_load_dwordx2 v[24:25], v16, s[16:19], s35 offen offset:3456
    buffer_load_dword v35, v17, s[8:11], s47 offen offset:12
    buffer_load_dwordx2 v[26:27], v16, s[16:19], s36 offen offset:2816
    buffer_load_dword v36, v17, s[8:11], s47 offen offset:24
    buffer_load_dwordx2 v[28:29], v16, s[16:19], s37 offen offset:2176
    buffer_load_dword v37, v17, s[8:11], s47 offen offset:36
    buffer_load_dwordx2 v[30:31], v16, s[16:19], s38 offen offset:1536
    buffer_load_dword v38, v17, s[8:11], s47 offen offset:48
    buffer_load_dwordx2 v[32:33], v16, s[16:19], s39 offen offset:896
    buffer_load_dword v39, v17, s[8:11], s47 offen offset:60
    s_barrier
    s_waitcnt vmcnt(28)
    s_waitcnt lgkmcnt(0)
    s_lshl_b32 s46, s42, 13
    s_add_u32 s46, s46, s31
    buffer_load_dwordx4 v[80:83], v7, s[8:11], s46 offen sc1
    ds_write_b128 v7, v[120:123] offset:40960
    buffer_load_dwordx4 v[84:87], v7, s[8:11], s46 offen offset:1024 sc1
    ds_write_b128 v7, v[124:127] offset:41984
    s_add_u32 s42, s42, 1
    s_cmp_eq_u32 s42, 9
    s_cselect_b32 s42, 0, s42
    s_lshl_b32 s46, s42, 13
    s_add_u32 s46, s46, s31
    buffer_load_dwordx4 v[88:91], v7, s[8:11], s46 offen sc1
    ds_write_b128 v7, v[128:131] offset:49152
    buffer_load_dwordx4 v[92:95], v7, s[8:11], s46 offen offset:1024 sc1
    ds_write_b128 v7, v[132:135] offset:50176
    s_add_u32 s42, s42, 1
    s_cmp_eq_u32 s42, 9
    s_cselect_b32 s42, 0, s42
    ds_write_b128 v7, v[136:139] offset:51200
    s_barrier
    s_waitcnt vmcnt(27)
    s_waitcnt lgkmcnt(0)
    s_lshl_b32 s46, s42, 13
    s_add_u32 s46, s46, s31
    buffer_load_dwordx4 v[100:103], v7, s[8:11], s46 offen sc1
    ds_write_b128 v7, v[140:143] offset:58368
    buffer_load_dwordx4 v[104:107], v7, s[8:11], s46 offen offset:1024 sc1
    ds_write_b128 v7, v[144:147] offset:59392
    s_add_u32 s42, s42, 1
    s_cmp_eq_u32 s42, 9
    s_cselect_b32 s42, 0, s42
    s_lshl_b32 s46, s42, 13
    s_add_u32 s46, s46, s31
    buffer_load_dwordx4 v[108:111], v7, s[8:11], s46 offen sc1
    ds_write_b128 v167, v[148:151] offset:33792
    buffer_load_dwordx4 v[112:115], v7, s[8:11], s46 offen offset:1024 sc1
    ds_write_b128 v167, v[152:155] offset:34816
    s_add_u32 s42, s42, 1
    s_cmp_eq_u32 s42, 9
    s_cselect_b32 s42, 0, s42
    ds_write_b128 v167, v[156:159] offset:35840
    s_barrier
    s_waitcnt vmcnt(26)
    s_waitcnt lgkmcnt(0)
    s_lshl_b32 s46, s42, 13
    s_add_u32 s46, s46, s31
    buffer_load_dwordx4 v[120:123], v7, s[8:11], s46 offen sc1
    ds_write_b128 v7, v[40:43] offset:6144
    buffer_load_dwordx4 v[124:127], v7, s[8:11], s46 offen offset:1024 sc1
    ds_write_b128 v7, v[44:47] offset:7168
    s_add_u32 s42, s42, 1
    s_cmp_eq_u32 s42, 9
    s_cselect_b32 s42, 0, s42
    s_lshl_b32 s46, s42, 13
    s_add_u32 s46, s46, s31
    buffer_load_dwordx4 v[128:131], v7, s[8:11], s46 offen sc1
    ds_write_b128 v7, v[48:51] offset:14336
    buffer_load_dwordx4 v[132:135], v7, s[8:11], s46 offen offset:1024 sc1
    ds_write_b128 v7, v[52:55] offset:15360
    s_add_u32 s42, s42, 1
    s_cmp_eq_u32 s42, 9
    s_cselect_b32 s42, 0, s42
    ds_write_b128 v7, v[56:59] offset:16384
    s_barrier
    s_waitcnt vmcnt(25)
    s_waitcnt lgkmcnt(0)
    s_lshl_b32 s46, s42, 13
    s_add_u32 s46, s46, s31
    buffer_load_dwordx4 v[140:143], v7, s[8:11], s46 offen sc1
    ds_write_b128 v7, v[60:63] offset:23552
    buffer_load_dwordx4 v[144:147], v7, s[8:11], s46 offen offset:1024 sc1
    ds_write_b128 v7, v[64:67] offset:24576
    s_add_u32 s42, s42, 1
    s_cmp_eq_u32 s42, 9
    s_cselect_b32 s42, 0, s42
    s_lshl_b32 s46, s42, 13
    s_add_u32 s46, s46, s31
    buffer_load_dwordx4 v[148:151], v7, s[8:11], s46 offen sc1
    ds_write_b128 v7, v[68:71] offset:31744
    buffer_load_dwordx4 v[152:155], v7, s[8:11], s46 offen offset:1024 sc1
    ds_write_b128 v7, v[72:75] offset:32768
    s_add_u32 s42, s42, 1
    s_cmp_eq_u32 s42, 9
    s_cselect_b32 s42, 0, s42
    ds_write_b128 v7, v[76:79] offset:33792
    s_barrier
    s_waitcnt vmcnt(14)
    s_waitcnt lgkmcnt(0)
    s_lshl_b32 s46, s42, 13
    s_add_u32 s46, s46, s31
    buffer_load_dwordx4 v[40:43], v7, s[8:11], s46 offen sc1
    ds_write_b128 v7, v[80:83] offset:40960
    buffer_load_dwordx4 v[44:47], v7, s[8:11], s46 offen offset:1024 sc1
    ds_write_b128 v7, v[84:87] offset:41984
    s_add_u32 s42, s42, 1
    s_cmp_eq_u32 s42, 9
    s_cselect_b32 s42, 0, s42
    s_barrier
    s_waitcnt vmcnt(14)
    s_waitcnt lgkmcnt(0)
    ds_write_b128 v7, v[88:91] offset:58368
    ds_write_b128 v7, v[92:95] offset:59392
    s_barrier
    s_waitcnt vmcnt(12)
    s_waitcnt lgkmcnt(0)
    ds_write_b128 v7, v[100:103] offset:6144
    ds_write_b128 v7, v[104:107] offset:7168
    s_barrier
    s_waitcnt vmcnt(10)
    s_waitcnt lgkmcnt(0)
    ds_write_b128 v7, v[108:111] offset:23552
    ds_write_b128 v7, v[112:115] offset:24576
    s_barrier
    s_waitcnt vmcnt(8)
    s_waitcnt lgkmcnt(0)
    ds_write_b128 v7, v[120:123] offset:40960
    ds_write_b128 v7, v[124:127] offset:41984
    s_barrier
    s_waitcnt vmcnt(6)
    s_waitcnt lgkmcnt(0)
    ds_write_b128 v7, v[128:131] offset:58368
    ds_write_b128 v7, v[132:135] offset:59392
    s_barrier
    s_waitcnt vmcnt(4)
    s_waitcnt lgkmcnt(0)
    ds_write_b128 v7, v[140:143] offset:6144
    ds_write_b128 v7, v[144:147] offset:7168
    s_barrier
    s_waitcnt vmcnt(2)
    s_waitcnt lgkmcnt(0)
    ds_write_b128 v7, v[148:151] offset:23552
    ds_write_b128 v7, v[152:155] offset:24576
    s_barrier
    s_waitcnt vmcnt(0)
    s_waitcnt lgkmcnt(0)
    ds_write_b128 v7, v[40:43] offset:40960
    ds_write_b128 v7, v[44:47] offset:41984
    s_barrier
    s_waitcnt lgkmcnt(0)
    s_barrier
    s_waitcnt vmcnt(0)
    v_lshlrev_b32 v64, 16, v20
    v_and_b32 v65, 0xffff0000, v20
    v_lshlrev_b32 v66, 16, v21
    v_and_b32 v67, 0xffff0000, v21
    v_lshlrev_b32 v68, 16, v22
    v_and_b32 v69, 0xffff0000, v22
    v_lshlrev_b32 v70, 16, v23
    v_and_b32 v71, 0xffff0000, v23
    v_mul_f32 v68, v68, v64
    v_mul_f32 v69, v69, v65
    v_mul_f32 v70, v70, v66
    v_mul_f32 v71, v71, v67
    v_lshlrev_b32 v72, 16, v24
    v_and_b32 v73, 0xffff0000, v24
    v_lshlrev_b32 v74, 16, v25
    v_and_b32 v75, 0xffff0000, v25
    v_mul_f32 v72, v72, v64
    v_mul_f32 v73, v73, v65
    v_mul_f32 v74, v74, v66
    v_mul_f32 v75, v75, v67
    v_lshlrev_b32 v76, 16, v26
    v_and_b32 v77, 0xffff0000, v26
    v_lshlrev_b32 v78, 16, v27
    v_and_b32 v79, 0xffff0000, v27
    v_mul_f32 v76, v76, v64
    v_mul_f32 v77, v77, v65
    v_mul_f32 v78, v78, v66
    v_mul_f32 v79, v79, v67
    v_lshlrev_b32 v80, 16, v28
    v_and_b32 v81, 0xffff0000, v28
    v_lshlrev_b32 v82, 16, v29
    v_and_b32 v83, 0xffff0000, v29
    v_mul_f32 v80, v80, v64
    v_mul_f32 v81, v81, v65
    v_mul_f32 v82, v82, v66
    v_mul_f32 v83, v83, v67
    v_lshlrev_b32 v84, 16, v30
    v_and_b32 v85, 0xffff0000, v30
    v_lshlrev_b32 v86, 16, v31
    v_and_b32 v87, 0xffff0000, v31
    v_mul_f32 v84, v84, v64
    v_mul_f32 v85, v85, v65
    v_mul_f32 v86, v86, v66
    v_mul_f32 v87, v87, v67
    v_lshlrev_b32 v88, 16, v32
    v_and_b32 v89, 0xffff0000, v32
    v_lshlrev_b32 v90, 16, v33
    v_and_b32 v91, 0xffff0000, v33
    v_mul_f32 v88, v88, v64
    v_mul_f32 v89, v89, v65
    v_mul_f32 v90, v90, v66
    v_mul_f32 v91, v91, v67
    s_barrier
    s_mov_b32 exec_hi, 0x003fffff
    ds_read_b128 v[92:95], v19 offset:0
    ds_read_b128 v[96:99], v19 offset:912
    ds_read_b128 v[100:103], v19 offset:1824
    ds_read_b128 v[104:107], v19 offset:2736
    ds_read_b128 v[108:111], v19 offset:3648
    ds_read_b128 v[112:115], v19 offset:4560
    s_waitcnt lgkmcnt(5)
    v_fmac_f32 v92, v34, v68
    v_fmac_f32 v93, v34, v69
    v_fmac_f32 v94, v34, v70
    v_fmac_f32 v95, v34, v71
    s_mov_b32 s46, 0
    buffer_store_dwordx4 v[92:95], v18, s[24:27], s46 offen sc1
    s_waitcnt lgkmcnt(4)
    v_fmac_f32 v96, v35, v72
    v_fmac_f32 v97, v35, v73
    v_fmac_f32 v98, v35, v74
    v_fmac_f32 v99, v35, v75
    s_mov_b32 s46, 6912
    buffer_store_dwordx4 v[96:99], v18, s[24:27], s46 offen sc1
    s_waitcnt lgkmcnt(3)
    v_fmac_f32 v100, v36, v76
    v_fmac_f32 v101, v36, v77
    v_fmac_f32 v102, v36, v78
    v_fmac_f32 v103, v36, v79
    s_mov_b32 s46, 13824
    buffer_store_dwordx4 v[100:103], v18, s[24:27], s46 offen sc1
    s_waitcnt lgkmcnt(2)
    v_fmac_f32 v104, v37, v80
    v_fmac_f32 v105, v37, v81
    v_fmac_f32 v106, v37, v82
    v_fmac_f32 v107, v37, v83
    s_mov_b32 s46, 20736
    buffer_store_dwordx4 v[104:107], v18, s[24:27], s46 offen sc1
    s_waitcnt lgkmcnt(1)
    v_fmac_f32 v108, v38, v84
    v_fmac_f32 v109, v38, v85
    v_fmac_f32 v110, v38, v86
    v_fmac_f32 v111, v38, v87
    s_mov_b32 s46, 27648
    buffer_store_dwordx4 v[108:111], v18, s[24:27], s46 offen sc1
    s_mov_b32 exec_hi, 0
    s_mov_b32 exec_lo, 0x3ffff
    s_waitcnt lgkmcnt(0)
    v_fmac_f32 v112, v39, v88
    v_fmac_f32 v113, v39, v89
    v_fmac_f32 v114, v39, v90
    v_fmac_f32 v115, v39, v91
    s_mov_b32 s46, 34560
    buffer_store_dwordx4 v[112:115], v18, s[24:27], s46 offen sc1
    s_endpgm
K2_FB:
    v_lshlrev_b32 v1, 4, v0
    v_and_b32 v12, 31, v0
    v_lshlrev_b32 v2, 2, v12
    v_add_u32 v2, 1024, v2
    v_lshlrev_b32 v3, 4, v12
    v_lshrrev_b32 v13, 5, v0
    v_mul_u32_u24 v13, 304, v13
    v_add_u32 v3, v3, v13
    v_add_u32 v3, 1152, v3
    v_mov_b32 v13, 0x4000000
    v_cmp_gt_u32 vcc, 19, v12
    s_nop 1
    v_cndmask_b32 v3, v13, v3, vcc
    v_cmp_gt_u32 vcc, 32, v0
    s_nop 1
    v_cndmask_b32 v2, v13, v2, vcc
    s_mul_i32 s37, s4, 151552
    s_add_u32 s37, s37, 2359296
    v_mov_b32 v15, 0xff800000
    s_mov_b32 s21, 0
K2_MAX:
    buffer_load_dwordx4 v[88:91], v1, s[8:11], s37 offen
    buffer_load_dword v96, v2, s[8:11], s37 offen
    s_waitcnt vmcnt(0)
    v_mfma_f32_32x32x16_bf16 v[32:47], v[88:91], v[4:7], 0
    v_mfma_f32_32x32x8_bf16 v[32:47], v[96:97], v[8:9], v[32:47]
    v_add_u32 v1, 2368, v1
    v_add_u32 v2, 2368, v2
    s_nop 10
    v_max3_f32 v15, v15, v32, v33
    v_max3_f32 v15, v15, v34, v35
    v_max3_f32 v15, v15, v36, v37
    v_max3_f32 v15, v15, v38, v39
    v_max3_f32 v15, v15, v40, v41
    v_max3_f32 v15, v15, v42, v43
    v_max3_f32 v15, v15, v44, v45
    v_max3_f32 v15, v15, v46, v47
    s_add_u32 s21, s21, 1
    s_cmp_lt_u32 s21, 64
    s_cbranch_scc1 K2_MAX
    v_mov_b32 v14, v15
    s_nop 1
    v_permlane32_swap_b32 v14, v15
    v_max_f32 v14, v14, v15
    v_sub_f32 v16, 0, v14
    v_mov_b32 v64, 0
    v_sub_f32 v17, 0, v14
    v_mov_b32 v65, 0
    v_sub_f32 v18, 0, v14
    v_mov_b32 v66, 0
    v_sub_f32 v19, 0, v14
    v_mov_b32 v67, 0
    v_sub_f32 v20, 0, v14
    v_mov_b32 v68, 0
    v_sub_f32 v21, 0, v14
    v_mov_b32 v69, 0
    v_sub_f32 v22, 0, v14
    v_mov_b32 v70, 0
    v_sub_f32 v23, 0, v14
    v_mov_b32 v71, 0
    v_sub_f32 v24, 0, v14
    v_mov_b32 v72, 0
    v_sub_f32 v25, 0, v14
    v_mov_b32 v73, 0
    v_sub_f32 v26, 0, v14
    v_mov_b32 v74, 0
    v_sub_f32 v27, 0, v14
    v_mov_b32 v75, 0
    v_sub_f32 v28, 0, v14
    v_mov_b32 v76, 0
    v_sub_f32 v29, 0, v14
    v_mov_b32 v77, 0
    v_sub_f32 v30, 0, v14
    v_mov_b32 v78, 0
    v_sub_f32 v31, 0, v14
    v_mov_b32 v79, 0
    v_lshlrev_b32 v1, 4, v0
    v_and_b32 v12, 31, v0
    v_lshlrev_b32 v2, 2, v12
    v_add_u32 v2, 1024, v2
    v_lshlrev_b32 v3, 4, v12
    v_lshrrev_b32 v13, 5, v0
    v_mul_u32_u24 v13, 304, v13
    v_add_u32 v3, v3, v13
    v_add_u32 v3, 1152, v3
    v_mov_b32 v13, 0x4000000
    v_cmp_gt_u32 vcc, 19, v12
    s_nop 1
    v_cndmask_b32 v3, v13, v3, vcc
    v_cmp_gt_u32 vcc, 32, v0
    s_nop 1
    v_cndmask_b32 v2, v13, v2, vcc
    s_mov_b32 s21, 0
K2_FB2:
    buffer_load_dwordx4 v[88:91], v1, s[8:11], s37 offen
    buffer_load_dword v96, v2, s[8:11], s37 offen
    buffer_load_dwordx4 v[104:107], v3, s[8:11], s37 offen
    buffer_load_dwordx4 v[108:111], v3, s[8:11], s37 offen offset:608
    s_waitcnt vmcnt(0)
    v_mfma_f32_32x32x16_bf16 v[32:47], v[88:91], v[4:7], v[16:31]
    v_mfma_f32_32x32x8_bf16 v[32:47], v[96:97], v[8:9], v[32:47]
    v_add_u32 v1, 2368, v1
    v_add_u32 v2, 2368, v2
    v_add_u32 v3, 2368, v3
    s_nop 10
    v_exp_f32 v32, v32
    v_exp_f32 v33, v33
    v_exp_f32 v34, v34
    v_exp_f32 v35, v35
    v_exp_f32 v36, v36
    v_exp_f32 v37, v37
    v_exp_f32 v38, v38
    v_exp_f32 v39, v39
    v_exp_f32 v40, v40
    v_exp_f32 v41, v41
    v_exp_f32 v42, v42
    v_exp_f32 v43, v43
    v_exp_f32 v44, v44
    v_exp_f32 v45, v45
    v_exp_f32 v46, v46
    v_exp_f32 v47, v47
    s_nop 0
    v_cvt_pk_bf16_f32 v80, v32, v33
    v_cvt_pk_bf16_f32 v81, v34, v35
    v_cvt_pk_bf16_f32 v82, v36, v37
    v_cvt_pk_bf16_f32 v83, v38, v39
    v_cvt_pk_bf16_f32 v84, v40, v41
    v_cvt_pk_bf16_f32 v85, v42, v43
    v_cvt_pk_bf16_f32 v86, v44, v45
    v_cvt_pk_bf16_f32 v87, v46, v47
    s_nop 1
    v_mfma_f32_32x32x16_bf16 v[64:79], v[104:107], v[80:83], v[64:79]
    v_mfma_f32_32x32x16_bf16 v[64:79], v[108:111], v[84:87], v[64:79]
    s_add_u32 s21, s21, 1
    s_cmp_lt_u32 s21, 64
    s_cbranch_scc1 K2_FB2
    s_nop 10
    v_mov_b32 v12, v74
    v_mov_b32 v13, v74
    s_nop 1
    v_permlane32_swap_b32 v12, v13
    s_branch K2_OUT
K2_END:
    s_endpgm
TEXT_END:
.section .rodata,"a"
.p2align 6
.amdhsa_kernel k1_kernel
  .amdhsa_next_free_vgpr 216
  .amdhsa_next_free_sgpr 80
  .amdhsa_accum_offset 216
  .amdhsa_group_segment_fixed_size 0
  .amdhsa_kernarg_size 128
  .amdhsa_user_sgpr_count 2
  .amdhsa_user_sgpr_kernarg_segment_ptr 1
  .amdhsa_system_sgpr_workgroup_id_x 1
.end_amdhsa_kernel
.p2align 6
.amdhsa_kernel k2_kernel
  .amdhsa_next_free_vgpr 168
  .amdhsa_next_free_sgpr 80
  .amdhsa_accum_offset 168
  .amdhsa_group_segment_fixed_size 0
  .amdhsa_kernarg_size 128
  .amdhsa_user_sgpr_count 2
  .amdhsa_user_sgpr_kernarg_segment_ptr 1
  .amdhsa_system_sgpr_workgroup_id_x 1
.end_amdhsa_kernel
```
